```python
import torch

def _softmax(x, axis=-1):
    return torch.softmax(x, dim=axis)

def _gelu(x):
    return torch.nn.functional.gelu(x, approximate='tanh')

def _silu(x):
    return torch.nn.functional.silu(x)

def _sigmoid(x):
    return torch.sigmoid(x)

def _layernorm(x, axis=-1, eps=1e-05):
    m = x.mean(dim=axis, keepdim=True)
    v = x.var(dim=axis, keepdim=True, unbiased=False)
    return (x - m) / torch.sqrt(v + eps)

def _scatter_add(tgt, idx, src, axis=0):
    return tgt.clone().index_add_(axis, idx, src)

def _segment_sum(src, seg, n):
    out = torch.zeros((n,) + src.shape[1:], dtype=src.dtype)
    return out.index_add_(0, seg, src)

def _pad(x, pw):
    flat = tuple((v for pair in reversed(pw) for v in pair))
    return torch.nn.functional.pad(x, flat)
kernel_name = 'adaLN_cond__ssm_conv_s4d__geglu_ffn__prompt'

def setup_inputs():

    _w = lambda a: (lambda t: t.to(torch.bfloat16) if t.is_floating_point() else t)(torch.as_tensor(a))

    def _A_setup():
        Bsz, L, D, N = (1, 2048, 640, 128)
        return {'u': _w((lambda *s: torch.randn(*s, dtype=torch.bfloat16) * 0.05)(Bsz, L, D)), 'log_A_real': _w((lambda *s: torch.randn(*s, dtype=torch.bfloat16) * 3.2)(D, N) * 0.5), 'A_imag': _w((lambda *s: torch.randn(*s, dtype=torch.bfloat16) * 0.1)(D, N) * 3.14), 'C_real': _w((lambda *s: torch.randn(*s, dtype=torch.bfloat16) * 0.4)(D, N) / N ** 0.5), 'C_imag': _w((lambda *s: torch.randn(*s, dtype=torch.bfloat16) * 0.4)(D, N) / N ** 0.5), 'log_dt': _w((lambda *s: torch.randn(*s, dtype=torch.bfloat16) * 0.1)(D) * 0.5 - 4.0), 'D_skip': _w((lambda *s: torch.randn(*s, dtype=torch.bfloat16) * 0.1)(D))}
    _A_in = _A_setup()

    def _B_setup():
        B, S, D, F = (1, 2048, 640, 1728)
        return {'x': _w((lambda *s: torch.randn(*s, dtype=torch.bfloat16) * 0.05)(B, S, D)), 'w_gate': _w((lambda *s: torch.randn(*s, dtype=torch.bfloat16) * 0.05)(D, F)), 'w_up': _w((lambda *s: torch.randn(*s, dtype=torch.bfloat16) * 0.05)(D, F)), 'w_down': _w((lambda *s: torch.randn(*s, dtype=torch.bfloat16) * 0.05)(F, D))}
    _B_in = _B_setup()
    return {'A_u': _A_in['u'], 'A_log_A_real': _A_in['log_A_real'], 'A_A_imag': _A_in['A_imag'], 'A_C_real': _A_in['C_real'], 'A_C_imag': _A_in['C_imag'], 'A_log_dt': _A_in['log_dt'], 'A_D_skip': _A_in['D_skip'], 'B_x': _B_in['x'], 'B_w_gate': _B_in['w_gate'], 'B_w_up': _B_in['w_up'], 'B_w_down': _B_in['w_down'], 'c': _w((lambda *s: torch.randn(*s, dtype=torch.bfloat16) * 0.1)(1, 640) * 8.0), 'w_mod': _w((lambda *s: torch.randn(*s, dtype=torch.bfloat16) * 0.1)(640, 6 * 640) * 640 ** (-0.5) * 8.0)}

def reference(A_u, A_log_A_real, A_A_imag, A_C_real, A_C_imag, A_log_dt, A_D_skip, B_x, B_w_gate, B_w_up, B_w_down, c, w_mod):

    def _A_ref(u, log_A_real, A_imag, C_real, C_imag, log_dt, D_skip):
        L = u.shape[1]
        dt = torch.exp(log_dt)
        A = -torch.exp(log_A_real) + 1j * A_imag
        C = (C_real + 1j * C_imag) * dt[:, None]
        pos = (lambda x, dt: x.to(dt))(torch.arange(L), log_dt.dtype)
        P = torch.exp((A * dt[:, None])[:, :, None] * pos[None, None, :])
        K = 2.0 * torch.einsum('dn,dnl->dl', C, P).real
        L2 = 2 * L
        u_t = (lambda x, *d: x.permute(*d))(u, 0, 2, 1)
        Kf = (lambda x, *a, **k: torch.fft.rfft(x.float(), *a, **k))(K, L2)
        Uf = (lambda x, *a, **k: torch.fft.rfft(x.float(), *a, **k))(u_t, L2)
        y = (lambda x, *a, **k: torch.fft.irfft(x, *a, **k).to(torch.bfloat16))(Uf * Kf[None, :, :], L2)[:, :, :L]
        y = (lambda x, *d: x.permute(*d))(y, 0, 2, 1)
        return y + u * D_skip[None, None, :]

    def _B_ref(x, w_gate, w_up, w_down):
        return _gelu(x @ w_gate) * (x @ w_up) @ w_down
    x = A_u
    mod = (_silu(c) @ w_mod).reshape(c.shape[0], 6, 1, -1)
    sa, ca, ga, sb, cb, gb = (mod[:, 0].clone(), mod[:, 1].clone(), mod[:, 2].clone(), mod[:, 3].clone(), mod[:, 4].clone(), mod[:, 5].clone())
    h = _layernorm(x, axis=-1) * (1 + ca) + sa
    x = x + ga * _A_ref(h, A_log_A_real, A_A_imag, A_C_real, A_C_imag, A_log_dt, A_D_skip)
    h = _layernorm(x, axis=-1) * (1 + cb) + sb
    x = x + gb * _B_ref(h, B_w_gate, B_w_up, B_w_down)
    return x
```

```asm
; @launch grid=(256,1,1) block=(256,1,1) lds=163840
.amdgcn_target "amdgcn-amd-amdhsa--gfx950"
.text
.globl adaLN_cond__ssm_conv_s4d__geglu_ffn__prompt_kernel
.p2align 8
.type adaLN_cond__ssm_conv_s4d__geglu_ffn__prompt_kernel,@function
adaLN_cond__ssm_conv_s4d__geglu_ffn__prompt_kernel:
    s_cmp_ge_u32 s2, 256
    s_cbranch_scc0 start
    s_endpgm
start:
    s_load_dwordx16 s[16:31], s[0:1], 0
    s_load_dwordx16 s[32:47], s[0:1], 64
    s_getpc_b64 s[62:63]
    v_lshrrev_b32 v2, 6, v0
    v_and_b32 v1, 63, v0
    v_readfirstlane_b32 s3, v2
    v_lshlrev_b32 v148, 6, v1
    global_load_dword v247, v148, s[62:63]
    s_mul_hi_u32 s56, s2, 0x4444445
    s_mul_i32 s57, s56, 60
    s_sub_u32 s57, s2, s57
    s_lshl_b32 s60, s56, 2
    s_add_u32 s60, s60, s3
    s_mul_i32 s60, s60, 307200
    s_lshl_b32 s61, s57, 7
    s_add_u32 s60, s60, s61
    v_lshrrev_b32 v147, 3, v1
    v_mul_u32_u24 v147, 7680, v147
    v_lshrrev_b32 v148, 4, v1
    v_lshlrev_b32 v148, 1, v148
    v_and_b32 v149, 7, v1
    v_xor_b32 v148, v148, v149
    v_lshl_add_u32 v147, v148, 4, v147
    s_mul_i32 s61, s3, 5120
    s_add_u32 m0, s61, 141568
    s_bfe_u32 s48, s2, 0x10003
    s_and_b32 s58, s2, 7
    s_lshr_b32 s59, s2, 4
    s_lshl_b32 s50, s58, 4
    s_add_u32 s50, s50, s59
    s_mul_i32 s50, s50, 5
    s_mul_i32 s58, s48, 3
    s_add_u32 s50, s50, s58
    s_add_u32 s50, s50, s3
    v_lshlrev_b32 v4, 4, v1
    v_lshlrev_b32 v5, 2, v1
    s_min_u32 s58, s50, 639
    s_lshl_b32 s59, s58, 8
    v_add_u32 v148, s59, v5
    s_lshl_b32 s59, s58, 1
    v_mov_b32 v149, s59
    s_lshl_b32 s61, s2, 2
    s_add_u32 s61, s61, s3
    s_mul_i32 s58, s61, 2560
    s_mov_b32 s10, 4915200
    s_mov_b32 s11, 0x20000
    v_mov_b32 v3, 0
    s_cmp_eq_u32 s61, 1023
    s_cselect_b32 s96, 0, 0x7f000000
    s_waitcnt lgkmcnt(0)
    s_cbranch_scc0 noinit
    s_mov_b32 s4, s46
    s_mov_b32 s5, s47
    s_mov_b32 s6, 20643840
    s_mov_b32 s7, 0x20000
    v_lshlrev_b32 v8, 9, v1
    buffer_store_dword v3, v8, s[4:7], s96 offen offset:0 sc1
    buffer_store_dword v3, v8, s[4:7], s96 offen offset:256 sc1
    buffer_store_dword v3, v8, s[4:7], s96 offen offset:128 sc1
    buffer_store_dword v3, v8, s[4:7], s96 offen offset:384 sc1
noinit:
    s_add_u32 s58, s16, s58
    s_addc_u32 s59, s17, 0
    s_mov_b32 s8, s40
    s_mov_b32 s9, s41
    s_add_u32 s61, s3, s48
    s_cmp_ge_u32 s61, 3
    s_cbranch_scc1 no_par
    global_load_dword v240, v148, s[18:19] nt
    global_load_dword v241, v148, s[20:21] nt
    global_load_dword v242, v148, s[22:23] nt
    global_load_dword v243, v148, s[24:25] nt
    global_load_ushort v244, v149, s[26:27]
    global_load_ushort v245, v149, s[28:29]
no_par:
    s_mul_i32 s61, s56, 160
    v_add_u32 v146, s61, v0
    v_min_u32 v146, 639, v146
    v_lshlrev_b32 v146, 1, v146
    global_load_ushort v161, v146, s[38:39]
    buffer_load_dwordx4 v147, s[8:11], s60 offen nt lds
    s_add_u32 m0, m0, 1024
    s_add_u32 s60, s60, 61440
    buffer_load_dwordx4 v147, s[8:11], s60 offen nt lds
    s_add_u32 m0, m0, 1024
    s_add_u32 s60, s60, 61440
    buffer_load_dwordx4 v147, s[8:11], s60 offen nt lds
    s_add_u32 m0, m0, 1024
    s_add_u32 s60, s60, 61440
    buffer_load_dwordx4 v147, s[8:11], s60 offen nt lds
    s_add_u32 m0, m0, 1024
    s_add_u32 s60, s60, 61440
    buffer_load_dwordx4 v147, s[8:11], s60 offen nt lds
    global_load_dwordx4 v[150:153], v4, s[58:59] nt
    global_load_dword v154, v5, s[58:59] offset:1024 nt
    global_load_dwordx4 v[156:159], v4, s[58:59] offset:1280 nt
    global_load_dword v160, v5, s[58:59] offset:2304 nt
    s_lshr_b32 s58, s2, 3
    s_lshl_b32 s58, s58, 2
    s_add_u32 s58, s58, s3
    s_lshl_b32 s58, s58, 9
    v_and_b32 v148, 7, v1
    v_lshl_add_u32 v148, v148, 6, s58
    global_load_dword v246, v148, s[62:63]
    s_mov_b32 s100, s62
    s_mov_b32 s101, s63
    s_mov_b32 s99, s58
    s_mov_b32 s4, s46
    s_mov_b32 s5, s47
    s_mov_b32 s6, 20643840
    s_mov_b32 s7, 0x20000
    s_mul_i32 s63, s56, 15360
    s_lshl_b32 s62, s57, 8
    s_add_u32 s63, s63, s62
    s_lshl_b32 s62, s3, 6
    s_add_u32 s63, s63, s62
    s_add_u32 s63, s63, 32768
    s_cmp_lt_u32 s2, 240
    s_cselect_b32 s97, s63, 0x7f000000
    v_lshlrev_b32 v146, 1, v0
    s_sub_u32 s49, 3, s48
    s_and_b32 s56, s2, 7
    s_lshr_b32 s57, s2, 4
    s_lshl_b32 s57, s57, 3
    s_add_u32 s57, s57, s56
    s_add_u32 s58, s57, 270
    s_add_u32 s59, s57, 144
    s_cmp_lt_u32 s57, 112
    s_cselect_b32 s59, s58, s59
    s_cmp_ge_u32 s57, 126
    s_cselect_b32 s59, s58, s59
    s_cmp_eq_u32 s3, 3
    s_cselect_b32 s51, s2, s59
    s_lshr_b32 s57, s56, 2
    s_lshl_b32 s57, s57, 3
    s_lshr_b32 s58, s2, 5
    s_add_u32 s52, s57, s58
    s_and_b32 s57, s56, 3
    s_bfe_u32 s58, s2, 0x20003
    s_lshl_b32 s53, s57, 2
    s_add_u32 s53, s53, s58
    s_lshr_b32 s54, s57, 1
    s_and_b32 s55, s53, 7
    s_mov_b32 s98, s52
    s_mov_b32 s12, s44
    s_mov_b32 s13, s45
    s_mov_b32 s14, 256
    s_mov_b32 s15, 0x20000
    v_mov_b32 v164, 0
    v_mov_b32 v165, 0
    v_mov_b32 v148, 25344
    ds_write_b64 v148, v[164:165]
    ds_write_b64 v148, v[164:165] offset:8
    ds_write_b64 v148, v[164:165] offset:16
    s_mul_i32 s56, s3, 1344
    s_add_u32 s56, s56, 130048
    v_add_u32 v168, s56, v4
    v_add_u32 v169, s56, v5
    v_bfe_u32 v162, v1, 2, 2
    v_and_b32 v163, 3, v1
    v_lshrrev_b32 v164, 4, v1
    v_mul_u32_u24 v165, 1344, v162
    v_lshl_add_u32 v165, v164, 5, v165
    v_lshl_add_u32 v165, v163, 3, v165
    s_lshl_b32 s58, s3, 7
    s_add_u32 s58, s58, 130048
    v_add_u32 v165, s58, v165
    s_lshl_b32 s58, s3, 10
    s_mul_i32 s59, s2, 10240
    s_add_u32 s58, s58, s59
    s_add_u32 s16, s58, 1048576
    s_add_u32 s17, s16, 4096
    s_add_u32 s18, s16, 8192
    s_cmp_lt_u32 s3, 2
    s_cselect_b32 s18, s18, 0x7f000000
    v_lshl_add_u32 v166, v164, 2, v162
    v_lshlrev_b32 v167, 7, v166
    v_bfe_u32 v166, v166, 1, 2
    v_lshlrev_b32 v166, 1, v166
    v_lshrrev_b32 v171, 1, v163
    s_lshl_b32 s56, s3, 1
    v_add_u32 v171, s56, v171
    v_xor_b32 v166, v166, v171
    v_lshl_add_u32 v167, v166, 4, v167
    v_and_b32 v171, 1, v163
    v_lshl_add_u32 v167, v171, 3, v167
    v_add_u32 v167, 141568, v167
    v_lshlrev_b32 v166, 3, v164
    v_add_u32 v166, 140800, v166
    s_lshr_b32 s56, s3, 1
    s_lshl_b32 s56, s56, 4
    s_and_b32 s57, s3, 1
    s_lshl_b32 s57, s57, 2
    s_add_u32 s56, s56, s57
    s_add_u32 s56, s56, 141312
    v_lshl_add_u32 v188, v164, 5, s56
    v_lshlrev_b32 v189, 4, v163
    v_add_u32 v190, 141312, v189
    v_lshlrev_b32 v191, 4, v164
    s_lshl_b32 s63, s2, 6
    s_add_u32 s63, s63, 237568
    s_cmp_eq_u32 s3, 3
    s_cselect_b32 s19, s63, 0x7f000000
    v_mov_b32 v149, 0x3f803f80
    v_mov_b32 v148, 1
    s_waitcnt vmcnt(10)
    v_lshlrev_b32 v161, 16, v161
    v_mul_f32 v170, 0xbfb8aa3b, v161
    v_exp_f32 v170, v170
    s_nop 0
    v_add_f32 v170, 1.0, v170
    v_rcp_f32 v170, v170
    s_nop 0
    v_mul_f32 v161, v161, v170
    v_cvt_pk_bf16_f32 v161, v161, v161
    v_add_u32 v170, 140800, v146
    ds_write_b16 v170, v161
    s_mov_b64 exec, 1
    buffer_store_dword v148, v3, s[12:15], s96 offen sc1
    s_mov_b64 exec, -1
    s_cmp_ge_u32 s3, s49
    s_cbranch_scc1 a_rest
    v_lshlrev_b32 v244, 16, v244
    v_lshlrev_b32 v245, 16, v245
    v_mul_f32 v244, 0x3fb8aa3b, v244
    v_exp_f32 v244, v244
    v_lshlrev_b32 v10, 16, v240
    v_and_b32 v11, 0xffff0000, v240
    v_lshlrev_b32 v12, 16, v241
    v_and_b32 v13, 0xffff0000, v241
    v_lshlrev_b32 v14, 16, v242
    v_and_b32 v15, 0xffff0000, v242
    v_lshlrev_b32 v16, 16, v243
    v_and_b32 v17, 0xffff0000, v243
    v_cvt_pk_bf16_f32 v244, v244, v244
    v_lshlrev_b32 v244, 16, v244
    v_mul_f32 v10, 0x3fb8aa3b, v10
    v_exp_f32 v10, v10
    v_mul_f32 v11, 0x3fb8aa3b, v11
    v_exp_f32 v11, v11
    s_nop 0
    v_cvt_pk_bf16_f32 v10, v10, v11
    v_and_b32 v11, 0xffff0000, v10
    v_lshlrev_b32 v10, 16, v10
    v_add_f32 v9, v244, v244
    v_mul_f32 v10, v10, v244
    v_mul_f32 v12, v12, v244
    v_mul_f32 v10, 0xbfb8aa3b, v10
    v_mul_f32 v12, 0.15915494, v12
    v_mul_f32 v40, v14, v9
    v_mul_f32 v41, v16, v9
    v_mul_f32 v11, v11, v244
    v_mul_f32 v13, v13, v244
    v_mul_f32 v11, 0xbfb8aa3b, v11
    v_mul_f32 v13, 0.15915494, v13
    v_mul_f32 v80, v15, v9
    v_mul_f32 v81, v17, v9
    v_mul_f32 v120, 1.0, v10
    v_mul_f32 v122, 1.0, v12
    v_exp_f32 v120, v120
    v_fract_f32 v122, v122
    v_cos_f32 v20, v122
    v_sin_f32 v21, v122
    v_mul_f32 v121, 1.0, v11
    v_mul_f32 v123, 1.0, v13
    v_exp_f32 v121, v121
    v_fract_f32 v123, v123
    v_cos_f32 v28, v123
    v_sin_f32 v29, v123
    v_mul_f32 v20, v20, v120
    v_mul_f32 v21, v21, v120
    v_mul_f32 v28, v28, v121
    v_mul_f32 v29, v29, v121
    v_mul_f32 v120, 0x41000000, v10
    v_mul_f32 v122, 0x41000000, v12
    v_exp_f32 v120, v120
    v_fract_f32 v122, v122
    v_cos_f32 v22, v122
    v_sin_f32 v23, v122
    v_mul_f32 v121, 0x41000000, v11
    v_mul_f32 v123, 0x41000000, v13
    v_exp_f32 v121, v121
    v_fract_f32 v123, v123
    v_cos_f32 v30, v123
    v_sin_f32 v31, v123
    v_mul_f32 v22, v22, v120
    v_mul_f32 v23, v23, v120
    v_mul_f32 v30, v30, v121
    v_mul_f32 v31, v31, v121
    v_mul_f32 v120, 0x43000000, v10
    v_mul_f32 v122, 0x43000000, v12
    v_exp_f32 v120, v120
    v_fract_f32 v122, v122
    v_cos_f32 v24, v122
    v_sin_f32 v25, v122
    v_mul_f32 v121, 0x43000000, v11
    v_mul_f32 v123, 0x43000000, v13
    v_exp_f32 v121, v121
    v_fract_f32 v123, v123
    v_cos_f32 v32, v123
    v_sin_f32 v33, v123
    v_mul_f32 v24, v24, v120
    v_mul_f32 v25, v25, v120
    v_mul_f32 v32, v32, v121
    v_mul_f32 v33, v33, v121
    s_mul_i32 s56, s3, 34816
    s_add_u32 s56, s56, 25600
    v_lshl_add_u32 v8, v1, 3, s56
    v_mov_b32 v124, 0x3f80
    v_mov_b32 v125, 0x3f80
    ds_write_b64 v8, v[124:125]
    v_cvt_pk_bf16_f32 v126, v22, v23
    v_cvt_pk_bf16_f32 v127, v30, v31
    ds_write_b64 v8, v[126:127] offset:544
    v_pk_mul_f32 v[132:133], v[22:23], v[22:23] op_sel_hi:[0,1]
    v_pk_fma_f32 v[132:133], v[22:23], v[22:23], v[132:133] op_sel:[1,1,0] op_sel_hi:[1,0,1] neg_lo:[0,1,0]
    v_pk_mul_f32 v[134:135], v[30:31], v[30:31] op_sel_hi:[0,1]
    v_pk_fma_f32 v[134:135], v[30:31], v[30:31], v[134:135] op_sel:[1,1,0] op_sel_hi:[1,0,1] neg_lo:[0,1,0]
    v_cvt_pk_bf16_f32 v128, v132, v133
    v_cvt_pk_bf16_f32 v129, v134, v135
    ds_write_b64 v8, v[128:129] offset:1088
    v_pk_mul_f32 v[136:137], v[132:133], v[22:23] op_sel_hi:[0,1]
    v_pk_fma_f32 v[136:137], v[132:133], v[22:23], v[136:137] op_sel:[1,1,0] op_sel_hi:[1,0,1] neg_lo:[0,1,0]
    v_pk_mul_f32 v[138:139], v[134:135], v[30:31] op_sel_hi:[0,1]
    v_pk_fma_f32 v[138:139], v[134:135], v[30:31], v[138:139] op_sel:[1,1,0] op_sel_hi:[1,0,1] neg_lo:[0,1,0]
    v_cvt_pk_bf16_f32 v130, v136, v137
    v_cvt_pk_bf16_f32 v131, v138, v139
    ds_write_b64 v8, v[130:131] offset:1632
    v_pk_mul_f32 v[132:133], v[136:137], v[22:23] op_sel_hi:[0,1]
    v_pk_fma_f32 v[132:133], v[136:137], v[22:23], v[132:133] op_sel:[1,1,0] op_sel_hi:[1,0,1] neg_lo:[0,1,0]
    v_pk_mul_f32 v[134:135], v[138:139], v[30:31] op_sel_hi:[0,1]
    v_pk_fma_f32 v[134:135], v[138:139], v[30:31], v[134:135] op_sel:[1,1,0] op_sel_hi:[1,0,1] neg_lo:[0,1,0]
    v_cvt_pk_bf16_f32 v124, v132, v133
    v_cvt_pk_bf16_f32 v125, v134, v135
    ds_write_b64 v8, v[124:125] offset:2176
    v_pk_mul_f32 v[136:137], v[132:133], v[22:23] op_sel_hi:[0,1]
    v_pk_fma_f32 v[136:137], v[132:133], v[22:23], v[136:137] op_sel:[1,1,0] op_sel_hi:[1,0,1] neg_lo:[0,1,0]
    v_pk_mul_f32 v[138:139], v[134:135], v[30:31] op_sel_hi:[0,1]
    v_pk_fma_f32 v[138:139], v[134:135], v[30:31], v[138:139] op_sel:[1,1,0] op_sel_hi:[1,0,1] neg_lo:[0,1,0]
    v_cvt_pk_bf16_f32 v126, v136, v137
    v_cvt_pk_bf16_f32 v127, v138, v139
    ds_write_b64 v8, v[126:127] offset:2720
    v_pk_mul_f32 v[132:133], v[136:137], v[22:23] op_sel_hi:[0,1]
    v_pk_fma_f32 v[132:133], v[136:137], v[22:23], v[132:133] op_sel:[1,1,0] op_sel_hi:[1,0,1] neg_lo:[0,1,0]
    v_pk_mul_f32 v[134:135], v[138:139], v[30:31] op_sel_hi:[0,1]
    v_pk_fma_f32 v[134:135], v[138:139], v[30:31], v[134:135] op_sel:[1,1,0] op_sel_hi:[1,0,1] neg_lo:[0,1,0]
    v_cvt_pk_bf16_f32 v128, v132, v133
    v_cvt_pk_bf16_f32 v129, v134, v135
    ds_write_b64 v8, v[128:129] offset:3264
    v_pk_mul_f32 v[136:137], v[132:133], v[22:23] op_sel_hi:[0,1]
    v_pk_fma_f32 v[136:137], v[132:133], v[22:23], v[136:137] op_sel:[1,1,0] op_sel_hi:[1,0,1] neg_lo:[0,1,0]
    v_pk_mul_f32 v[138:139], v[134:135], v[30:31] op_sel_hi:[0,1]
    v_pk_fma_f32 v[138:139], v[134:135], v[30:31], v[138:139] op_sel:[1,1,0] op_sel_hi:[1,0,1] neg_lo:[0,1,0]
    v_cvt_pk_bf16_f32 v130, v136, v137
    v_cvt_pk_bf16_f32 v131, v138, v139
    ds_write_b64 v8, v[130:131] offset:3808
    v_pk_mul_f32 v[132:133], v[136:137], v[22:23] op_sel_hi:[0,1]
    v_pk_fma_f32 v[132:133], v[136:137], v[22:23], v[132:133] op_sel:[1,1,0] op_sel_hi:[1,0,1] neg_lo:[0,1,0]
    v_pk_mul_f32 v[134:135], v[138:139], v[30:31] op_sel_hi:[0,1]
    v_pk_fma_f32 v[134:135], v[138:139], v[30:31], v[134:135] op_sel:[1,1,0] op_sel_hi:[1,0,1] neg_lo:[0,1,0]
    v_cvt_pk_bf16_f32 v124, v132, v133
    v_cvt_pk_bf16_f32 v125, v134, v135
    ds_write_b64 v8, v[124:125] offset:4352
    v_pk_mul_f32 v[136:137], v[132:133], v[22:23] op_sel_hi:[0,1]
    v_pk_fma_f32 v[136:137], v[132:133], v[22:23], v[136:137] op_sel:[1,1,0] op_sel_hi:[1,0,1] neg_lo:[0,1,0]
    v_pk_mul_f32 v[138:139], v[134:135], v[30:31] op_sel_hi:[0,1]
    v_pk_fma_f32 v[138:139], v[134:135], v[30:31], v[138:139] op_sel:[1,1,0] op_sel_hi:[1,0,1] neg_lo:[0,1,0]
    v_cvt_pk_bf16_f32 v126, v136, v137
    v_cvt_pk_bf16_f32 v127, v138, v139
    ds_write_b64 v8, v[126:127] offset:4896
    v_pk_mul_f32 v[132:133], v[136:137], v[22:23] op_sel_hi:[0,1]
    v_pk_fma_f32 v[132:133], v[136:137], v[22:23], v[132:133] op_sel:[1,1,0] op_sel_hi:[1,0,1] neg_lo:[0,1,0]
    v_pk_mul_f32 v[134:135], v[138:139], v[30:31] op_sel_hi:[0,1]
    v_pk_fma_f32 v[134:135], v[138:139], v[30:31], v[134:135] op_sel:[1,1,0] op_sel_hi:[1,0,1] neg_lo:[0,1,0]
    v_cvt_pk_bf16_f32 v128, v132, v133
    v_cvt_pk_bf16_f32 v129, v134, v135
    ds_write_b64 v8, v[128:129] offset:5440
    v_pk_mul_f32 v[136:137], v[132:133], v[22:23] op_sel_hi:[0,1]
    v_pk_fma_f32 v[136:137], v[132:133], v[22:23], v[136:137] op_sel:[1,1,0] op_sel_hi:[1,0,1] neg_lo:[0,1,0]
    v_pk_mul_f32 v[138:139], v[134:135], v[30:31] op_sel_hi:[0,1]
    v_pk_fma_f32 v[138:139], v[134:135], v[30:31], v[138:139] op_sel:[1,1,0] op_sel_hi:[1,0,1] neg_lo:[0,1,0]
    v_cvt_pk_bf16_f32 v130, v136, v137
    v_cvt_pk_bf16_f32 v131, v138, v139
    ds_write_b64 v8, v[130:131] offset:5984
    v_pk_mul_f32 v[132:133], v[136:137], v[22:23] op_sel_hi:[0,1]
    v_pk_fma_f32 v[132:133], v[136:137], v[22:23], v[132:133] op_sel:[1,1,0] op_sel_hi:[1,0,1] neg_lo:[0,1,0]
    v_pk_mul_f32 v[134:135], v[138:139], v[30:31] op_sel_hi:[0,1]
    v_pk_fma_f32 v[134:135], v[138:139], v[30:31], v[134:135] op_sel:[1,1,0] op_sel_hi:[1,0,1] neg_lo:[0,1,0]
    v_cvt_pk_bf16_f32 v124, v132, v133
    v_cvt_pk_bf16_f32 v125, v134, v135
    ds_write_b64 v8, v[124:125] offset:6528
    v_pk_mul_f32 v[136:137], v[132:133], v[22:23] op_sel_hi:[0,1]
    v_pk_fma_f32 v[136:137], v[132:133], v[22:23], v[136:137] op_sel:[1,1,0] op_sel_hi:[1,0,1] neg_lo:[0,1,0]
    v_pk_mul_f32 v[138:139], v[134:135], v[30:31] op_sel_hi:[0,1]
    v_pk_fma_f32 v[138:139], v[134:135], v[30:31], v[138:139] op_sel:[1,1,0] op_sel_hi:[1,0,1] neg_lo:[0,1,0]
    v_cvt_pk_bf16_f32 v126, v136, v137
    v_cvt_pk_bf16_f32 v127, v138, v139
    ds_write_b64 v8, v[126:127] offset:7072
    v_pk_mul_f32 v[132:133], v[136:137], v[22:23] op_sel_hi:[0,1]
    v_pk_fma_f32 v[132:133], v[136:137], v[22:23], v[132:133] op_sel:[1,1,0] op_sel_hi:[1,0,1] neg_lo:[0,1,0]
    v_pk_mul_f32 v[134:135], v[138:139], v[30:31] op_sel_hi:[0,1]
    v_pk_fma_f32 v[134:135], v[138:139], v[30:31], v[134:135] op_sel:[1,1,0] op_sel_hi:[1,0,1] neg_lo:[0,1,0]
    v_cvt_pk_bf16_f32 v128, v132, v133
    v_cvt_pk_bf16_f32 v129, v134, v135
    ds_write_b64 v8, v[128:129] offset:7616
    v_pk_mul_f32 v[136:137], v[132:133], v[22:23] op_sel_hi:[0,1]
    v_pk_fma_f32 v[136:137], v[132:133], v[22:23], v[136:137] op_sel:[1,1,0] op_sel_hi:[1,0,1] neg_lo:[0,1,0]
    v_pk_mul_f32 v[138:139], v[134:135], v[30:31] op_sel_hi:[0,1]
    v_pk_fma_f32 v[138:139], v[134:135], v[30:31], v[138:139] op_sel:[1,1,0] op_sel_hi:[1,0,1] neg_lo:[0,1,0]
    v_cvt_pk_bf16_f32 v130, v136, v137
    v_cvt_pk_bf16_f32 v131, v138, v139
    ds_write_b64 v8, v[130:131] offset:8160
    v_cvt_pk_bf16_f32 v124, v40, -v41
    v_cvt_pk_bf16_f32 v125, v80, -v81
    ds_write_b64 v8, v[124:125] offset:8704
    v_pk_mul_f32 v[42:43], v[40:41], v[20:21] op_sel_hi:[0,1]
    v_pk_fma_f32 v[42:43], v[40:41], v[20:21], v[42:43] op_sel:[1,1,0] op_sel_hi:[1,0,1] neg_lo:[0,1,0]
    v_pk_mul_f32 v[82:83], v[80:81], v[28:29] op_sel_hi:[0,1]
    v_pk_fma_f32 v[82:83], v[80:81], v[28:29], v[82:83] op_sel:[1,1,0] op_sel_hi:[1,0,1] neg_lo:[0,1,0]
    v_cvt_pk_bf16_f32 v126, v42, -v43
    v_cvt_pk_bf16_f32 v127, v82, -v83
    ds_write_b64 v8, v[126:127] offset:9248
    v_pk_mul_f32 v[44:45], v[42:43], v[20:21] op_sel_hi:[0,1]
    v_pk_fma_f32 v[44:45], v[42:43], v[20:21], v[44:45] op_sel:[1,1,0] op_sel_hi:[1,0,1] neg_lo:[0,1,0]
    v_pk_mul_f32 v[84:85], v[82:83], v[28:29] op_sel_hi:[0,1]
    v_pk_fma_f32 v[84:85], v[82:83], v[28:29], v[84:85] op_sel:[1,1,0] op_sel_hi:[1,0,1] neg_lo:[0,1,0]
    v_cvt_pk_bf16_f32 v128, v44, -v45
    v_cvt_pk_bf16_f32 v129, v84, -v85
    ds_write_b64 v8, v[128:129] offset:9792
a_rest:
    s_waitcnt vmcnt(2)
    ds_write_b128 v168, v[150:153]
    ds_write_b32 v169, v154 offset:1024
    ds_write_b128 v168, v[156:159] offset:5376
    ds_write_b32 v169, v160 offset:6400
    v_dot2_f32_bf16 v184, v150, v149, 0
    v_dot2_f32_bf16 v185, v150, v150, 0
    v_dot2_f32_bf16 v186, v156, v149, 0
    v_dot2_f32_bf16 v187, v156, v156, 0
    v_dot2_f32_bf16 v184, v151, v149, v184
    v_dot2_f32_bf16 v185, v151, v151, v185
    v_dot2_f32_bf16 v186, v157, v149, v186
    v_dot2_f32_bf16 v187, v157, v157, v187
    v_dot2_f32_bf16 v184, v152, v149, v184
    v_dot2_f32_bf16 v185, v152, v152, v185
    v_dot2_f32_bf16 v186, v158, v149, v186
    v_dot2_f32_bf16 v187, v158, v158, v187
    v_dot2_f32_bf16 v184, v153, v149, v184
    v_dot2_f32_bf16 v185, v153, v153, v185
    v_dot2_f32_bf16 v186, v159, v149, v186
    v_dot2_f32_bf16 v187, v159, v159, v187
    v_dot2_f32_bf16 v184, v154, v149, v184
    v_dot2_f32_bf16 v185, v154, v154, v185
    v_dot2_f32_bf16 v186, v160, v149, v186
    v_dot2_f32_bf16 v187, v160, v160, v187
    s_nop 0
    v_permlane32_swap_b32 v184, v185
    s_nop 0
    v_permlane32_swap_b32 v186, v187
    v_add_f32 v184, v184, v185
    v_add_f32 v186, v186, v187
    s_nop 1
    v_permlane16_swap_b32 v184, v186
    v_add_f32 v184, v184, v186
    s_nop 1
    v_add_f32_dpp v184, v184, v184 quad_perm:[1,0,3,2] row_mask:0xf bank_mask:0xf
    s_nop 1
    v_add_f32_dpp v184, v184, v184 quad_perm:[2,3,0,1] row_mask:0xf bank_mask:0xf
    s_nop 1
    v_add_f32_dpp v184, v184, v184 row_half_mirror row_mask:0xf bank_mask:0xf
    s_nop 1
    v_add_f32_dpp v184, v184, v184 row_mirror row_mask:0xf bank_mask:0xf
    v_mul_f32 v184, 0x3acccccd, v184
    v_mov_b32 v185, v184
    s_nop 1
    v_permlane32_swap_b32 v185, v184
    v_fma_f32 v184, -v185, v185, v184
    v_max_f32 v184, 0, v184
    v_cvt_pk_bf16_f32 v184, v184, v185
    v_and_b32 v185, 0xffff0000, v184
    v_lshlrev_b32 v184, 16, v184
    v_add_f32 v184, 0x3727c5ac, v184
    v_cvt_pk_bf16_f32 v184, v184, v184
    v_lshlrev_b32 v184, 16, v184
    v_sqrt_f32 v184, v184
    s_nop 0
    v_cvt_pk_bf16_f32 v184, v184, v184
    v_lshlrev_b32 v184, 16, v184
    v_rcp_f32 v184, v184
    s_nop 0
    v_mul_f32 v185, v184, v185
    s_mov_b64 exec, 0x10001
    ds_write2_b32 v188, v184, v185 offset0:0 offset1:2
    s_mov_b64 exec, -1
    s_waitcnt lgkmcnt(0)
    s_barrier
    ds_read_b64_tr_b16 v[200:201], v167 offset:0
    ds_read_b64_tr_b16 v[202:203], v167 offset:2048
    ds_read_b64 v[204:205], v166 offset:0
    ds_read_b64 v[206:207], v166 offset:32
    ds_read_b64_tr_b16 v[208:209], v167 offset:4096
    ds_read_b64_tr_b16 v[210:211], v167 offset:6144
    ds_read_b64 v[212:213], v166 offset:64
    ds_read_b64 v[214:215], v166 offset:96
    ds_read_b64_tr_b16 v[216:217], v167 offset:8192
    ds_read_b64_tr_b16 v[218:219], v167 offset:10240
    ds_read_b64 v[220:221], v166 offset:128
    ds_read_b64 v[222:223], v166 offset:160
    ds_read_b64_tr_b16 v[224:225], v167 offset:12288
    ds_read_b64_tr_b16 v[226:227], v167 offset:14336
    ds_read_b64 v[228:229], v166 offset:192
    ds_read_b64 v[230:231], v166 offset:224
    s_waitcnt lgkmcnt(12)
    v_mfma_f32_16x16x32_bf16 v[192:195], v[200:203], v[204:207], 0
    ds_read_b64_tr_b16 v[232:233], v167 offset:16384
    ds_read_b64_tr_b16 v[234:235], v167 offset:18432
    ds_read_b64 v[236:237], v166 offset:256
    ds_read_b64 v[238:239], v166 offset:288
    s_waitcnt lgkmcnt(12)
    v_mfma_f32_16x16x32_bf16 v[192:195], v[208:211], v[212:215], v[192:195]
    ds_read_b128 v[196:199], v190
    ds_read_b64_tr_b16 v[172:173], v165 offset:0
    ds_read_b64_tr_b16 v[174:175], v165 offset:5376
    s_waitcnt lgkmcnt(11)
    v_mfma_f32_16x16x32_bf16 v[192:195], v[216:219], v[220:223], v[192:195]
    ds_read_b64_tr_b16 v[176:177], v165 offset:512
    ds_read_b64_tr_b16 v[178:179], v165 offset:5888
    s_waitcnt lgkmcnt(9)
    v_mfma_f32_16x16x32_bf16 v[192:195], v[224:227], v[228:231], v[192:195]
    ds_read_b64_tr_b16 v[180:181], v165 offset:1024
    ds_read_b64_tr_b16 v[182:183], v165 offset:6400
    s_waitcnt lgkmcnt(7)
    v_mfma_f32_16x16x32_bf16 v[192:195], v[232:235], v[236:239], v[192:195]
    s_waitcnt lgkmcnt(4)
    buffer_store_dwordx4 v[172:175], v4, s[4:7], s16 offen sc1
    s_waitcnt lgkmcnt(2)
    buffer_store_dwordx4 v[176:179], v4, s[4:7], s17 offen sc1
    s_waitcnt lgkmcnt(0)
    buffer_store_dwordx4 v[180:183], v4, s[4:7], s18 offen sc1
    s_mov_b32 exec_lo, 0x00010001
    s_mov_b32 exec_hi, 0x00010001
    buffer_store_dwordx4 v[192:195], v191, s[4:7], s97 offen sc1
    s_mov_b64 exec, 15
    buffer_store_dwordx4 v[196:199], v189, s[4:7], s19 offen sc1
    s_mov_b64 exec, -1
    global_load_dword v253, v3, s[44:45] sc1
    s_cmp_ge_u32 s3, s49
    s_cbranch_scc1 helper
    v_pk_mul_f32 v[46:47], v[44:45], v[20:21] op_sel_hi:[0,1]
    v_pk_fma_f32 v[46:47], v[44:45], v[20:21], v[46:47] op_sel:[1,1,0] op_sel_hi:[1,0,1] neg_lo:[0,1,0]
    v_pk_mul_f32 v[86:87], v[84:85], v[28:29] op_sel_hi:[0,1]
    v_pk_fma_f32 v[86:87], v[84:85], v[28:29], v[86:87] op_sel:[1,1,0] op_sel_hi:[1,0,1] neg_lo:[0,1,0]
    v_cvt_pk_bf16_f32 v130, v46, -v47
    v_cvt_pk_bf16_f32 v131, v86, -v87
    ds_write_b64 v8, v[130:131] offset:10336
    v_pk_mul_f32 v[48:49], v[46:47], v[20:21] op_sel_hi:[0,1]
    v_pk_fma_f32 v[48:49], v[46:47], v[20:21], v[48:49] op_sel:[1,1,0] op_sel_hi:[1,0,1] neg_lo:[0,1,0]
    v_pk_mul_f32 v[88:89], v[86:87], v[28:29] op_sel_hi:[0,1]
    v_pk_fma_f32 v[88:89], v[86:87], v[28:29], v[88:89] op_sel:[1,1,0] op_sel_hi:[1,0,1] neg_lo:[0,1,0]
    v_cvt_pk_bf16_f32 v124, v48, -v49
    v_cvt_pk_bf16_f32 v125, v88, -v89
    ds_write_b64 v8, v[124:125] offset:10880
    v_pk_mul_f32 v[50:51], v[48:49], v[20:21] op_sel_hi:[0,1]
    v_pk_fma_f32 v[50:51], v[48:49], v[20:21], v[50:51] op_sel:[1,1,0] op_sel_hi:[1,0,1] neg_lo:[0,1,0]
    v_pk_mul_f32 v[90:91], v[88:89], v[28:29] op_sel_hi:[0,1]
    v_pk_fma_f32 v[90:91], v[88:89], v[28:29], v[90:91] op_sel:[1,1,0] op_sel_hi:[1,0,1] neg_lo:[0,1,0]
    v_cvt_pk_bf16_f32 v126, v50, -v51
    v_cvt_pk_bf16_f32 v127, v90, -v91
    ds_write_b64 v8, v[126:127] offset:11424
    v_pk_mul_f32 v[52:53], v[50:51], v[20:21] op_sel_hi:[0,1]
    v_pk_fma_f32 v[52:53], v[50:51], v[20:21], v[52:53] op_sel:[1,1,0] op_sel_hi:[1,0,1] neg_lo:[0,1,0]
    v_pk_mul_f32 v[92:93], v[90:91], v[28:29] op_sel_hi:[0,1]
    v_pk_fma_f32 v[92:93], v[90:91], v[28:29], v[92:93] op_sel:[1,1,0] op_sel_hi:[1,0,1] neg_lo:[0,1,0]
    v_cvt_pk_bf16_f32 v128, v52, -v53
    v_cvt_pk_bf16_f32 v129, v92, -v93
    ds_write_b64 v8, v[128:129] offset:11968
    v_pk_mul_f32 v[54:55], v[52:53], v[20:21] op_sel_hi:[0,1]
    v_pk_fma_f32 v[54:55], v[52:53], v[20:21], v[54:55] op_sel:[1,1,0] op_sel_hi:[1,0,1] neg_lo:[0,1,0]
    v_pk_mul_f32 v[94:95], v[92:93], v[28:29] op_sel_hi:[0,1]
    v_pk_fma_f32 v[94:95], v[92:93], v[28:29], v[94:95] op_sel:[1,1,0] op_sel_hi:[1,0,1] neg_lo:[0,1,0]
    v_cvt_pk_bf16_f32 v130, v54, -v55
    v_cvt_pk_bf16_f32 v131, v94, -v95
    ds_write_b64 v8, v[130:131] offset:12512
    v_pk_mul_f32 v[56:57], v[54:55], v[20:21] op_sel_hi:[0,1]
    v_pk_fma_f32 v[56:57], v[54:55], v[20:21], v[56:57] op_sel:[1,1,0] op_sel_hi:[1,0,1] neg_lo:[0,1,0]
    v_pk_mul_f32 v[96:97], v[94:95], v[28:29] op_sel_hi:[0,1]
    v_pk_fma_f32 v[96:97], v[94:95], v[28:29], v[96:97] op_sel:[1,1,0] op_sel_hi:[1,0,1] neg_lo:[0,1,0]
    v_pk_mul_f32 v[58:59], v[40:41], v[24:25] op_sel_hi:[0,1]
    v_pk_fma_f32 v[58:59], v[40:41], v[24:25], v[58:59] op_sel:[1,1,0] op_sel_hi:[1,0,1] neg_lo:[0,1,0]
    v_pk_mul_f32 v[98:99], v[80:81], v[32:33] op_sel_hi:[0,1]
    v_pk_fma_f32 v[98:99], v[80:81], v[32:33], v[98:99] op_sel:[1,1,0] op_sel_hi:[1,0,1] neg_lo:[0,1,0]
    v_cvt_pk_bf16_f32 v124, v58, -v59
    v_cvt_pk_bf16_f32 v125, v98, -v99
    ds_write_b64 v8, v[124:125] offset:13056
    v_pk_mul_f32 v[60:61], v[42:43], v[24:25] op_sel_hi:[0,1]
    v_pk_fma_f32 v[60:61], v[42:43], v[24:25], v[60:61] op_sel:[1,1,0] op_sel_hi:[1,0,1] neg_lo:[0,1,0]
    v_pk_mul_f32 v[100:101], v[82:83], v[32:33] op_sel_hi:[0,1]
    v_pk_fma_f32 v[100:101], v[82:83], v[32:33], v[100:101] op_sel:[1,1,0] op_sel_hi:[1,0,1] neg_lo:[0,1,0]
    v_cvt_pk_bf16_f32 v126, v60, -v61
    v_cvt_pk_bf16_f32 v127, v100, -v101
    ds_write_b64 v8, v[126:127] offset:13600
    v_pk_mul_f32 v[62:63], v[44:45], v[24:25] op_sel_hi:[0,1]
    v_pk_fma_f32 v[62:63], v[44:45], v[24:25], v[62:63] op_sel:[1,1,0] op_sel_hi:[1,0,1] neg_lo:[0,1,0]
    v_pk_mul_f32 v[102:103], v[84:85], v[32:33] op_sel_hi:[0,1]
    v_pk_fma_f32 v[102:103], v[84:85], v[32:33], v[102:103] op_sel:[1,1,0] op_sel_hi:[1,0,1] neg_lo:[0,1,0]
    v_cvt_pk_bf16_f32 v128, v62, -v63
    v_cvt_pk_bf16_f32 v129, v102, -v103
    ds_write_b64 v8, v[128:129] offset:14144
    v_pk_mul_f32 v[64:65], v[46:47], v[24:25] op_sel_hi:[0,1]
    v_pk_fma_f32 v[64:65], v[46:47], v[24:25], v[64:65] op_sel:[1,1,0] op_sel_hi:[1,0,1] neg_lo:[0,1,0]
    v_pk_mul_f32 v[104:105], v[86:87], v[32:33] op_sel_hi:[0,1]
    v_pk_fma_f32 v[104:105], v[86:87], v[32:33], v[104:105] op_sel:[1,1,0] op_sel_hi:[1,0,1] neg_lo:[0,1,0]
    v_cvt_pk_bf16_f32 v130, v64, -v65
    v_cvt_pk_bf16_f32 v131, v104, -v105
    ds_write_b64 v8, v[130:131] offset:14688
    v_pk_mul_f32 v[66:67], v[48:49], v[24:25] op_sel_hi:[0,1]
    v_pk_fma_f32 v[66:67], v[48:49], v[24:25], v[66:67] op_sel:[1,1,0] op_sel_hi:[1,0,1] neg_lo:[0,1,0]
    v_pk_mul_f32 v[106:107], v[88:89], v[32:33] op_sel_hi:[0,1]
    v_pk_fma_f32 v[106:107], v[88:89], v[32:33], v[106:107] op_sel:[1,1,0] op_sel_hi:[1,0,1] neg_lo:[0,1,0]
    v_cvt_pk_bf16_f32 v124, v66, -v67
    v_cvt_pk_bf16_f32 v125, v106, -v107
    ds_write_b64 v8, v[124:125] offset:15232
    v_pk_mul_f32 v[68:69], v[50:51], v[24:25] op_sel_hi:[0,1]
    v_pk_fma_f32 v[68:69], v[50:51], v[24:25], v[68:69] op_sel:[1,1,0] op_sel_hi:[1,0,1] neg_lo:[0,1,0]
    v_pk_mul_f32 v[108:109], v[90:91], v[32:33] op_sel_hi:[0,1]
    v_pk_fma_f32 v[108:109], v[90:91], v[32:33], v[108:109] op_sel:[1,1,0] op_sel_hi:[1,0,1] neg_lo:[0,1,0]
    v_cvt_pk_bf16_f32 v126, v68, -v69
    v_cvt_pk_bf16_f32 v127, v108, -v109
    ds_write_b64 v8, v[126:127] offset:15776
    v_pk_mul_f32 v[70:71], v[52:53], v[24:25] op_sel_hi:[0,1]
    v_pk_fma_f32 v[70:71], v[52:53], v[24:25], v[70:71] op_sel:[1,1,0] op_sel_hi:[1,0,1] neg_lo:[0,1,0]
    v_pk_mul_f32 v[110:111], v[92:93], v[32:33] op_sel_hi:[0,1]
    v_pk_fma_f32 v[110:111], v[92:93], v[32:33], v[110:111] op_sel:[1,1,0] op_sel_hi:[1,0,1] neg_lo:[0,1,0]
    v_cvt_pk_bf16_f32 v128, v70, -v71
    v_cvt_pk_bf16_f32 v129, v110, -v111
    ds_write_b64 v8, v[128:129] offset:16320
    v_pk_mul_f32 v[72:73], v[54:55], v[24:25] op_sel_hi:[0,1]
    v_pk_fma_f32 v[72:73], v[54:55], v[24:25], v[72:73] op_sel:[1,1,0] op_sel_hi:[1,0,1] neg_lo:[0,1,0]
    v_pk_mul_f32 v[112:113], v[94:95], v[32:33] op_sel_hi:[0,1]
    v_pk_fma_f32 v[112:113], v[94:95], v[32:33], v[112:113] op_sel:[1,1,0] op_sel_hi:[1,0,1] neg_lo:[0,1,0]
    v_cvt_pk_bf16_f32 v130, v72, -v73
    v_cvt_pk_bf16_f32 v131, v112, -v113
    ds_write_b64 v8, v[130:131] offset:16864
    v_pk_mul_f32 v[74:75], v[56:57], v[24:25] op_sel_hi:[0,1]
    v_pk_fma_f32 v[74:75], v[56:57], v[24:25], v[74:75] op_sel:[1,1,0] op_sel_hi:[1,0,1] neg_lo:[0,1,0]
    v_pk_mul_f32 v[114:115], v[96:97], v[32:33] op_sel_hi:[0,1]
    v_pk_fma_f32 v[114:115], v[96:97], v[32:33], v[114:115] op_sel:[1,1,0] op_sel_hi:[1,0,1] neg_lo:[0,1,0]
    v_pk_mul_f32 v[40:41], v[58:59], v[24:25] op_sel_hi:[0,1]
    v_pk_fma_f32 v[40:41], v[58:59], v[24:25], v[40:41] op_sel:[1,1,0] op_sel_hi:[1,0,1] neg_lo:[0,1,0]
    v_pk_mul_f32 v[80:81], v[98:99], v[32:33] op_sel_hi:[0,1]
    v_pk_fma_f32 v[80:81], v[98:99], v[32:33], v[80:81] op_sel:[1,1,0] op_sel_hi:[1,0,1] neg_lo:[0,1,0]
    v_cvt_pk_bf16_f32 v124, v40, -v41
    v_cvt_pk_bf16_f32 v125, v80, -v81
    ds_write_b64 v8, v[124:125] offset:17408
    v_pk_mul_f32 v[44:45], v[62:63], v[24:25] op_sel_hi:[0,1]
    v_pk_fma_f32 v[44:45], v[62:63], v[24:25], v[44:45] op_sel:[1,1,0] op_sel_hi:[1,0,1] neg_lo:[0,1,0]
    v_pk_mul_f32 v[84:85], v[102:103], v[32:33] op_sel_hi:[0,1]
    v_pk_fma_f32 v[84:85], v[102:103], v[32:33], v[84:85] op_sel:[1,1,0] op_sel_hi:[1,0,1] neg_lo:[0,1,0]
    v_cvt_pk_bf16_f32 v126, v44, -v45
    v_cvt_pk_bf16_f32 v127, v84, -v85
    ds_write_b64 v8, v[126:127] offset:17952
    v_pk_mul_f32 v[48:49], v[66:67], v[24:25] op_sel_hi:[0,1]
    v_pk_fma_f32 v[48:49], v[66:67], v[24:25], v[48:49] op_sel:[1,1,0] op_sel_hi:[1,0,1] neg_lo:[0,1,0]
    v_pk_mul_f32 v[88:89], v[106:107], v[32:33] op_sel_hi:[0,1]
    v_pk_fma_f32 v[88:89], v[106:107], v[32:33], v[88:89] op_sel:[1,1,0] op_sel_hi:[1,0,1] neg_lo:[0,1,0]
    v_cvt_pk_bf16_f32 v128, v48, -v49
    v_cvt_pk_bf16_f32 v129, v88, -v89
    ds_write_b64 v8, v[128:129] offset:18496
    ds_write_b64 v8, v[128:129] offset:19584
    v_pk_mul_f32 v[52:53], v[70:71], v[24:25] op_sel_hi:[0,1]
    v_pk_fma_f32 v[52:53], v[70:71], v[24:25], v[52:53] op_sel:[1,1,0] op_sel_hi:[1,0,1] neg_lo:[0,1,0]
    v_pk_mul_f32 v[92:93], v[110:111], v[32:33] op_sel_hi:[0,1]
    v_pk_fma_f32 v[92:93], v[110:111], v[32:33], v[92:93] op_sel:[1,1,0] op_sel_hi:[1,0,1] neg_lo:[0,1,0]
    v_cvt_pk_bf16_f32 v130, v52, -v53
    v_cvt_pk_bf16_f32 v131, v92, -v93
    ds_write_b64 v8, v[130:131] offset:20128
    v_pk_mul_f32 v[56:57], v[74:75], v[24:25] op_sel_hi:[0,1]
    v_pk_fma_f32 v[56:57], v[74:75], v[24:25], v[56:57] op_sel:[1,1,0] op_sel_hi:[1,0,1] neg_lo:[0,1,0]
    v_pk_mul_f32 v[96:97], v[114:115], v[32:33] op_sel_hi:[0,1]
    v_pk_fma_f32 v[96:97], v[114:115], v[32:33], v[96:97] op_sel:[1,1,0] op_sel_hi:[1,0,1] neg_lo:[0,1,0]
    v_cvt_pk_bf16_f32 v124, v56, -v57
    v_cvt_pk_bf16_f32 v125, v96, -v97
    ds_write_b64 v8, v[124:125] offset:20672
    v_pk_mul_f32 v[58:59], v[40:41], v[24:25] op_sel_hi:[0,1]
    v_pk_fma_f32 v[58:59], v[40:41], v[24:25], v[58:59] op_sel:[1,1,0] op_sel_hi:[1,0,1] neg_lo:[0,1,0]
    v_pk_mul_f32 v[98:99], v[80:81], v[32:33] op_sel_hi:[0,1]
    v_pk_fma_f32 v[98:99], v[80:81], v[32:33], v[98:99] op_sel:[1,1,0] op_sel_hi:[1,0,1] neg_lo:[0,1,0]
    v_cvt_pk_bf16_f32 v126, v58, -v59
    v_cvt_pk_bf16_f32 v127, v98, -v99
    ds_write_b64 v8, v[126:127] offset:21760
    v_pk_mul_f32 v[62:63], v[44:45], v[24:25] op_sel_hi:[0,1]
    v_pk_fma_f32 v[62:63], v[44:45], v[24:25], v[62:63] op_sel:[1,1,0] op_sel_hi:[1,0,1] neg_lo:[0,1,0]
    v_pk_mul_f32 v[102:103], v[84:85], v[32:33] op_sel_hi:[0,1]
    v_pk_fma_f32 v[102:103], v[84:85], v[32:33], v[102:103] op_sel:[1,1,0] op_sel_hi:[1,0,1] neg_lo:[0,1,0]
    v_cvt_pk_bf16_f32 v128, v62, -v63
    v_cvt_pk_bf16_f32 v129, v102, -v103
    ds_write_b64 v8, v[128:129] offset:22304
    v_pk_mul_f32 v[66:67], v[48:49], v[24:25] op_sel_hi:[0,1]
    v_pk_fma_f32 v[66:67], v[48:49], v[24:25], v[66:67] op_sel:[1,1,0] op_sel_hi:[1,0,1] neg_lo:[0,1,0]
    v_pk_mul_f32 v[106:107], v[88:89], v[32:33] op_sel_hi:[0,1]
    v_pk_fma_f32 v[106:107], v[88:89], v[32:33], v[106:107] op_sel:[1,1,0] op_sel_hi:[1,0,1] neg_lo:[0,1,0]
    v_cvt_pk_bf16_f32 v130, v66, -v67
    v_cvt_pk_bf16_f32 v131, v106, -v107
    ds_write_b64 v8, v[130:131] offset:22848
    ds_write_b64 v8, v[130:131] offset:23936
    v_pk_mul_f32 v[70:71], v[52:53], v[24:25] op_sel_hi:[0,1]
    v_pk_fma_f32 v[70:71], v[52:53], v[24:25], v[70:71] op_sel:[1,1,0] op_sel_hi:[1,0,1] neg_lo:[0,1,0]
    v_pk_mul_f32 v[110:111], v[92:93], v[32:33] op_sel_hi:[0,1]
    v_pk_fma_f32 v[110:111], v[92:93], v[32:33], v[110:111] op_sel:[1,1,0] op_sel_hi:[1,0,1] neg_lo:[0,1,0]
    v_cvt_pk_bf16_f32 v124, v70, -v71
    v_cvt_pk_bf16_f32 v125, v110, -v111
    ds_write_b64 v8, v[124:125] offset:24480
    s_waitcnt vmcnt(0)
    v_mov_b32 v2, 25344
    v_mov_b32 v3, 1
    s_mov_b64 exec, 1
    ds_add_u32 v2, v3
    s_mov_b64 exec, -1
    v_pk_mul_f32 v[74:75], v[56:57], v[24:25] op_sel_hi:[0,1]
    v_pk_fma_f32 v[74:75], v[56:57], v[24:25], v[74:75] op_sel:[1,1,0] op_sel_hi:[1,0,1] neg_lo:[0,1,0]
    v_pk_mul_f32 v[114:115], v[96:97], v[32:33] op_sel_hi:[0,1]
    v_pk_fma_f32 v[114:115], v[96:97], v[32:33], v[114:115] op_sel:[1,1,0] op_sel_hi:[1,0,1] neg_lo:[0,1,0]
    v_cvt_pk_bf16_f32 v126, v74, -v75
    v_cvt_pk_bf16_f32 v127, v114, -v115
    ds_write_b64 v8, v[126:127] offset:25024
    v_pk_mul_f32 v[40:41], v[58:59], v[24:25] op_sel_hi:[0,1]
    v_pk_fma_f32 v[40:41], v[58:59], v[24:25], v[40:41] op_sel:[1,1,0] op_sel_hi:[1,0,1] neg_lo:[0,1,0]
    v_pk_mul_f32 v[80:81], v[98:99], v[32:33] op_sel_hi:[0,1]
    v_pk_fma_f32 v[80:81], v[98:99], v[32:33], v[80:81] op_sel:[1,1,0] op_sel_hi:[1,0,1] neg_lo:[0,1,0]
    v_cvt_pk_bf16_f32 v128, v40, -v41
    v_cvt_pk_bf16_f32 v129, v80, -v81
    ds_write_b64 v8, v[128:129] offset:26112
    v_pk_mul_f32 v[48:49], v[66:67], v[24:25] op_sel_hi:[0,1]
    v_pk_fma_f32 v[48:49], v[66:67], v[24:25], v[48:49] op_sel:[1,1,0] op_sel_hi:[1,0,1] neg_lo:[0,1,0]
    v_pk_mul_f32 v[88:89], v[106:107], v[32:33] op_sel_hi:[0,1]
    v_pk_fma_f32 v[88:89], v[106:107], v[32:33], v[88:89] op_sel:[1,1,0] op_sel_hi:[1,0,1] neg_lo:[0,1,0]
    v_cvt_pk_bf16_f32 v130, v48, -v49
    v_cvt_pk_bf16_f32 v131, v88, -v89
    ds_write_b64 v8, v[130:131] offset:26656
    v_pk_mul_f32 v[58:59], v[40:41], v[24:25] op_sel_hi:[0,1]
    v_pk_fma_f32 v[58:59], v[40:41], v[24:25], v[58:59] op_sel:[1,1,0] op_sel_hi:[1,0,1] neg_lo:[0,1,0]
    v_pk_mul_f32 v[98:99], v[80:81], v[32:33] op_sel_hi:[0,1]
    v_pk_fma_f32 v[98:99], v[80:81], v[32:33], v[98:99] op_sel:[1,1,0] op_sel_hi:[1,0,1] neg_lo:[0,1,0]
    v_cvt_pk_bf16_f32 v124, v58, -v59
    v_cvt_pk_bf16_f32 v125, v98, -v99
    ds_write_b64 v8, v[124:125] offset:28288
    v_pk_mul_f32 v[66:67], v[48:49], v[24:25] op_sel_hi:[0,1]
    v_pk_fma_f32 v[66:67], v[48:49], v[24:25], v[66:67] op_sel:[1,1,0] op_sel_hi:[1,0,1] neg_lo:[0,1,0]
    v_pk_mul_f32 v[106:107], v[88:89], v[32:33] op_sel_hi:[0,1]
    v_pk_fma_f32 v[106:107], v[88:89], v[32:33], v[106:107] op_sel:[1,1,0] op_sel_hi:[1,0,1] neg_lo:[0,1,0]
    v_cvt_pk_bf16_f32 v126, v66, -v67
    v_cvt_pk_bf16_f32 v127, v106, -v107
    ds_write_b64 v8, v[126:127] offset:28832
    v_pk_mul_f32 v[40:41], v[58:59], v[24:25] op_sel_hi:[0,1]
    v_pk_fma_f32 v[40:41], v[58:59], v[24:25], v[40:41] op_sel:[1,1,0] op_sel_hi:[1,0,1] neg_lo:[0,1,0]
    v_pk_mul_f32 v[80:81], v[98:99], v[32:33] op_sel_hi:[0,1]
    v_pk_fma_f32 v[80:81], v[98:99], v[32:33], v[80:81] op_sel:[1,1,0] op_sel_hi:[1,0,1] neg_lo:[0,1,0]
    v_cvt_pk_bf16_f32 v128, v40, -v41
    v_cvt_pk_bf16_f32 v129, v80, -v81
    ds_write_b64 v8, v[128:129] offset:30464
    v_pk_mul_f32 v[48:49], v[66:67], v[24:25] op_sel_hi:[0,1]
    v_pk_fma_f32 v[48:49], v[66:67], v[24:25], v[48:49] op_sel:[1,1,0] op_sel_hi:[1,0,1] neg_lo:[0,1,0]
    v_pk_mul_f32 v[88:89], v[106:107], v[32:33] op_sel_hi:[0,1]
    v_pk_fma_f32 v[88:89], v[106:107], v[32:33], v[88:89] op_sel:[1,1,0] op_sel_hi:[1,0,1] neg_lo:[0,1,0]
    v_cvt_pk_bf16_f32 v130, v48, -v49
    v_cvt_pk_bf16_f32 v131, v88, -v89
    ds_write_b64 v8, v[130:131] offset:31008
    v_pk_mul_f32 v[58:59], v[40:41], v[24:25] op_sel_hi:[0,1]
    v_pk_fma_f32 v[58:59], v[40:41], v[24:25], v[58:59] op_sel:[1,1,0] op_sel_hi:[1,0,1] neg_lo:[0,1,0]
    v_pk_mul_f32 v[98:99], v[80:81], v[32:33] op_sel_hi:[0,1]
    v_pk_fma_f32 v[98:99], v[80:81], v[32:33], v[98:99] op_sel:[1,1,0] op_sel_hi:[1,0,1] neg_lo:[0,1,0]
    v_cvt_pk_bf16_f32 v124, v58, -v59
    v_cvt_pk_bf16_f32 v125, v98, -v99
    ds_write_b64 v8, v[124:125] offset:32640
    v_pk_mul_f32 v[66:67], v[48:49], v[24:25] op_sel_hi:[0,1]
    v_pk_fma_f32 v[66:67], v[48:49], v[24:25], v[66:67] op_sel:[1,1,0] op_sel_hi:[1,0,1] neg_lo:[0,1,0]
    v_pk_mul_f32 v[106:107], v[88:89], v[32:33] op_sel_hi:[0,1]
    v_pk_fma_f32 v[106:107], v[88:89], v[32:33], v[106:107] op_sel:[1,1,0] op_sel_hi:[1,0,1] neg_lo:[0,1,0]
    v_cvt_pk_bf16_f32 v126, v66, -v67
    v_cvt_pk_bf16_f32 v127, v106, -v107
    ds_write_b64 v8, v[126:127] offset:33184
    v_pk_mul_f32 v[40:41], v[58:59], v[24:25] op_sel_hi:[0,1]
    v_pk_fma_f32 v[40:41], v[58:59], v[24:25], v[40:41] op_sel:[1,1,0] op_sel_hi:[1,0,1] neg_lo:[0,1,0]
    v_pk_mul_f32 v[80:81], v[98:99], v[32:33] op_sel_hi:[0,1]
    v_pk_fma_f32 v[80:81], v[98:99], v[32:33], v[80:81] op_sel:[1,1,0] op_sel_hi:[1,0,1] neg_lo:[0,1,0]
    v_cvt_pk_bf16_f32 v128, v40, -v41
    v_cvt_pk_bf16_f32 v129, v80, -v81
    ds_write_b64 v8, v[128:129] offset:27200
    v_pk_mul_f32 v[58:59], v[40:41], v[24:25] op_sel_hi:[0,1]
    v_pk_fma_f32 v[58:59], v[40:41], v[24:25], v[58:59] op_sel:[1,1,0] op_sel_hi:[1,0,1] neg_lo:[0,1,0]
    v_pk_mul_f32 v[98:99], v[80:81], v[32:33] op_sel_hi:[0,1]
    v_pk_fma_f32 v[98:99], v[80:81], v[32:33], v[98:99] op_sel:[1,1,0] op_sel_hi:[1,0,1] neg_lo:[0,1,0]
    v_cvt_pk_bf16_f32 v130, v58, -v59
    v_cvt_pk_bf16_f32 v131, v98, -v99
    ds_write_b64 v8, v[130:131] offset:27744
    v_pk_mul_f32 v[40:41], v[58:59], v[24:25] op_sel_hi:[0,1]
    v_pk_fma_f32 v[40:41], v[58:59], v[24:25], v[40:41] op_sel:[1,1,0] op_sel_hi:[1,0,1] neg_lo:[0,1,0]
    v_pk_mul_f32 v[80:81], v[98:99], v[32:33] op_sel_hi:[0,1]
    v_pk_fma_f32 v[80:81], v[98:99], v[32:33], v[80:81] op_sel:[1,1,0] op_sel_hi:[1,0,1] neg_lo:[0,1,0]
    v_cvt_pk_bf16_f32 v124, v40, -v41
    v_cvt_pk_bf16_f32 v125, v80, -v81
    ds_write_b64 v8, v[124:125] offset:29376
    v_pk_mul_f32 v[58:59], v[40:41], v[24:25] op_sel_hi:[0,1]
    v_pk_fma_f32 v[58:59], v[40:41], v[24:25], v[58:59] op_sel:[1,1,0] op_sel_hi:[1,0,1] neg_lo:[0,1,0]
    v_pk_mul_f32 v[98:99], v[80:81], v[32:33] op_sel_hi:[0,1]
    v_pk_fma_f32 v[98:99], v[80:81], v[32:33], v[98:99] op_sel:[1,1,0] op_sel_hi:[1,0,1] neg_lo:[0,1,0]
    v_cvt_pk_bf16_f32 v126, v58, -v59
    v_cvt_pk_bf16_f32 v127, v98, -v99
    ds_write_b64 v8, v[126:127] offset:29920
    v_pk_mul_f32 v[40:41], v[58:59], v[24:25] op_sel_hi:[0,1]
    v_pk_fma_f32 v[40:41], v[58:59], v[24:25], v[40:41] op_sel:[1,1,0] op_sel_hi:[1,0,1] neg_lo:[0,1,0]
    v_pk_mul_f32 v[80:81], v[98:99], v[32:33] op_sel_hi:[0,1]
    v_pk_fma_f32 v[80:81], v[98:99], v[32:33], v[80:81] op_sel:[1,1,0] op_sel_hi:[1,0,1] neg_lo:[0,1,0]
    v_cvt_pk_bf16_f32 v128, v40, -v41
    v_cvt_pk_bf16_f32 v129, v80, -v81
    ds_write_b64 v8, v[128:129] offset:31552
    v_pk_mul_f32 v[58:59], v[40:41], v[24:25] op_sel_hi:[0,1]
    v_pk_fma_f32 v[58:59], v[40:41], v[24:25], v[58:59] op_sel:[1,1,0] op_sel_hi:[1,0,1] neg_lo:[0,1,0]
    v_pk_mul_f32 v[98:99], v[80:81], v[32:33] op_sel_hi:[0,1]
    v_pk_fma_f32 v[98:99], v[80:81], v[32:33], v[98:99] op_sel:[1,1,0] op_sel_hi:[1,0,1] neg_lo:[0,1,0]
    v_cvt_pk_bf16_f32 v130, v58, -v59
    v_cvt_pk_bf16_f32 v131, v98, -v99
    ds_write_b64 v8, v[130:131] offset:32096
    v_pk_mul_f32 v[40:41], v[58:59], v[24:25] op_sel_hi:[0,1]
    v_pk_fma_f32 v[40:41], v[58:59], v[24:25], v[40:41] op_sel:[1,1,0] op_sel_hi:[1,0,1] neg_lo:[0,1,0]
    v_pk_mul_f32 v[80:81], v[98:99], v[32:33] op_sel_hi:[0,1]
    v_pk_fma_f32 v[80:81], v[98:99], v[32:33], v[80:81] op_sel:[1,1,0] op_sel_hi:[1,0,1] neg_lo:[0,1,0]
    v_cvt_pk_bf16_f32 v124, v40, -v41
    v_cvt_pk_bf16_f32 v125, v80, -v81
    ds_write_b64 v8, v[124:125] offset:33728
    v_pk_mul_f32 v[58:59], v[40:41], v[24:25] op_sel_hi:[0,1]
    v_pk_fma_f32 v[58:59], v[40:41], v[24:25], v[58:59] op_sel:[1,1,0] op_sel_hi:[1,0,1] neg_lo:[0,1,0]
    v_pk_mul_f32 v[98:99], v[80:81], v[32:33] op_sel_hi:[0,1]
    v_pk_fma_f32 v[98:99], v[80:81], v[32:33], v[98:99] op_sel:[1,1,0] op_sel_hi:[1,0,1] neg_lo:[0,1,0]
    v_cvt_pk_bf16_f32 v126, v58, -v59
    v_cvt_pk_bf16_f32 v127, v98, -v99
    ds_write_b64 v8, v[126:127] offset:34272
    v_pk_mul_f32 v[40:41], v[58:59], v[24:25] op_sel_hi:[0,1]
    v_pk_fma_f32 v[40:41], v[58:59], v[24:25], v[40:41] op_sel:[1,1,0] op_sel_hi:[1,0,1] neg_lo:[0,1,0]
    v_pk_mul_f32 v[80:81], v[98:99], v[32:33] op_sel_hi:[0,1]
    v_pk_fma_f32 v[80:81], v[98:99], v[32:33], v[80:81] op_sel:[1,1,0] op_sel_hi:[1,0,1] neg_lo:[0,1,0]
    v_cvt_pk_bf16_f32 v128, v40, -v41
    v_cvt_pk_bf16_f32 v129, v80, -v81
    ds_write_b64 v8, v[128:129] offset:19040
    v_and_b32 v6, 15, v1
    v_lshrrev_b32 v7, 4, v1
    v_mul_u32_u24 v8, 544, v6
    v_lshl_add_u32 v8, v7, 4, v8
    s_mul_i32 s56, s3, 34816
    s_add_u32 s56, s56, 25600
    v_add_u32 v8, s56, v8
    s_waitcnt lgkmcnt(0)
    ds_read_b128 v[20:23], v8 offset:0
    ds_read_b128 v[24:27], v8 offset:8704
    ds_read_b128 v[28:31], v8 offset:17408
    ds_read_b128 v[32:35], v8 offset:26112
    ds_read_b128 v[36:39], v8 offset:64
    ds_read_b128 v[40:43], v8 offset:8768
    ds_read_b128 v[44:47], v8 offset:17472
    ds_read_b128 v[48:51], v8 offset:26176
    ds_read_b128 v[52:55], v8 offset:128
    ds_read_b128 v[56:59], v8 offset:8832
    ds_read_b128 v[60:63], v8 offset:17536
    ds_read_b128 v[64:67], v8 offset:26240
    ds_read_b128 v[68:71], v8 offset:192
    ds_read_b128 v[72:75], v8 offset:8896
    ds_read_b128 v[76:79], v8 offset:17600
    ds_read_b128 v[80:83], v8 offset:26304
    s_waitcnt lgkmcnt(12)
    v_mfma_f32_16x16x32_bf16 v[100:103], v[24:27], v[20:23], 0
    v_mfma_f32_16x16x32_bf16 v[104:107], v[28:31], v[20:23], 0
    v_mfma_f32_16x16x32_bf16 v[108:111], v[32:35], v[20:23], 0
    ds_read_b128 v[20:23], v8 offset:256
    ds_read_b128 v[24:27], v8 offset:8960
    ds_read_b128 v[28:31], v8 offset:17664
    ds_read_b128 v[32:35], v8 offset:26368
    s_waitcnt lgkmcnt(12)
    v_mfma_f32_16x16x32_bf16 v[100:103], v[40:43], v[36:39], v[100:103]
    v_mfma_f32_16x16x32_bf16 v[104:107], v[44:47], v[36:39], v[104:107]
    v_mfma_f32_16x16x32_bf16 v[108:111], v[48:51], v[36:39], v[108:111]
    ds_read_b128 v[36:39], v8 offset:320
    ds_read_b128 v[40:43], v8 offset:9024
    ds_read_b128 v[44:47], v8 offset:17728
    ds_read_b128 v[48:51], v8 offset:26432
    s_waitcnt lgkmcnt(12)
    v_mfma_f32_16x16x32_bf16 v[100:103], v[56:59], v[52:55], v[100:103]
    v_mfma_f32_16x16x32_bf16 v[104:107], v[60:63], v[52:55], v[104:107]
    v_mfma_f32_16x16x32_bf16 v[108:111], v[64:67], v[52:55], v[108:111]
    ds_read_b128 v[52:55], v8 offset:384
    ds_read_b128 v[56:59], v8 offset:9088
    ds_read_b128 v[60:63], v8 offset:17792
    ds_read_b128 v[64:67], v8 offset:26496
    s_waitcnt lgkmcnt(12)
    v_mfma_f32_16x16x32_bf16 v[100:103], v[72:75], v[68:71], v[100:103]
    v_mfma_f32_16x16x32_bf16 v[104:107], v[76:79], v[68:71], v[104:107]
    v_mfma_f32_16x16x32_bf16 v[108:111], v[80:83], v[68:71], v[108:111]
    ds_read_b128 v[68:71], v8 offset:448
    ds_read_b128 v[72:75], v8 offset:9152
    ds_read_b128 v[76:79], v8 offset:17856
    ds_read_b128 v[80:83], v8 offset:26560
    s_waitcnt lgkmcnt(12)
    v_mfma_f32_16x16x32_bf16 v[100:103], v[24:27], v[20:23], v[100:103]
    v_mfma_f32_16x16x32_bf16 v[104:107], v[28:31], v[20:23], v[104:107]
    v_mfma_f32_16x16x32_bf16 v[108:111], v[32:35], v[20:23], v[108:111]
    s_waitcnt lgkmcnt(8)
    v_mfma_f32_16x16x32_bf16 v[100:103], v[40:43], v[36:39], v[100:103]
    v_mfma_f32_16x16x32_bf16 v[104:107], v[44:47], v[36:39], v[104:107]
    v_mfma_f32_16x16x32_bf16 v[108:111], v[48:51], v[36:39], v[108:111]
    s_waitcnt lgkmcnt(4)
    v_mfma_f32_16x16x32_bf16 v[100:103], v[56:59], v[52:55], v[100:103]
    v_mfma_f32_16x16x32_bf16 v[104:107], v[60:63], v[52:55], v[104:107]
    v_mfma_f32_16x16x32_bf16 v[108:111], v[64:67], v[52:55], v[108:111]
    s_waitcnt lgkmcnt(0)
    v_mfma_f32_16x16x32_bf16 v[100:103], v[72:75], v[68:71], v[100:103]
    v_mfma_f32_16x16x32_bf16 v[104:107], v[76:79], v[68:71], v[104:107]
    v_mfma_f32_16x16x32_bf16 v[108:111], v[80:83], v[68:71], v[108:111]
    s_mul_i32 s56, s3, 8448
    v_lshlrev_b32 v10, 4, v6
    v_sub_u32 v10, s56, v10
    v_lshrrev_b32 v11, 1, v7
    v_lshlrev_b32 v11, 8, v11
    v_sub_u32 v11, v10, v11
    v_and_b32 v12, 1, v7
    v_lshlrev_b32 v12, 3, v12
    v_sub_u32 v11, v11, v12
    v_add_u32 v11, 3580, v11
    v_lshlrev_b32 v12, 8, v7
    v_sub_u32 v12, v10, v12
    v_add_u32 v12, 3064, v12
    v_lshlrev_b32 v13, 9, v7
    v_sub_u32 v13, v10, v13
    v_add_u32 v13, 1788, v13
    v_cmp_eq_u32 vcc, 0, v1
    s_nop 1
    v_cndmask_b32 v245, 0, v245, vcc
    v_mov_b32 v14, 0
    v_min_u32 v15, 15, v1
    v_lshl_add_u32 v15, v15, 2, s56
    ds_write_b32 v15, v14 offset:4100
    ds_write_b32 v15, v14 offset:8328
    v_mov_b32_dpp v20, v110 quad_perm:[0,0,2,2] row_mask:0xf bank_mask:0xf
    v_cvt_pk_bf16_f32 v24, v110, v110
    v_cvt_pk_bf16_f32 v27, v110, v20
    v_mov_b32 v25, v24
    v_mov_b32 v26, v24
    ds_write2_b32 v13, v24, v24 offset0:64 offset1:65
    ds_write2_b32 v13, v24, v27 offset0:66 offset1:67
    ds_write_b128 v13, v[24:27] offset:4484
    v_mov_b32_dpp v20, v111 quad_perm:[0,0,2,2] row_mask:0xf bank_mask:0xf
    v_cvt_pk_bf16_f32 v28, v111, v111
    v_cvt_pk_bf16_f32 v31, v111, v20
    v_mov_b32 v29, v28
    v_mov_b32 v30, v28
    ds_write2_b32 v13, v28, v28 offset0:0 offset1:1
    ds_write2_b32 v13, v28, v31 offset0:2 offset1:3
    ds_write_b128 v13, v[28:31] offset:4228
    v_cvt_pk_bf16_f32 v32, v107, v107
    v_mov_b32 v33, v32
    v_mov_b32 v16, s56
    s_mov_b64 exec, 1
    ds_write2_b32 v16, v32, v32 offset0:1 offset1:2
    ds_write_b64 v16, v[32:33] offset:4232
    s_mov_b64 exec, -1
    v_cvt_pk_bf16_f32 v36, v109, v109
    v_cvt_pk_bf16_f32 v37, v109, v108
    v_cvt_pk_bf16_f32 v38, v108, v108
    v_mov_b32 v39, v38
    v_add_u32 v17, 4228, v12
    ds_write2_b64 v12, v[36:37], v[38:39] offset0:0 offset1:1
    ds_write2_b32 v17, v36, v37 offset0:0 offset1:1
    ds_write2_b32 v17, v38, v38 offset0:2 offset1:3
    v_cvt_pk_bf16_f32 v40, v106, v105
    v_cvt_pk_bf16_f32 v41, v104, v104
    v_add_f32 v100, v100, v245
    v_cvt_pk_bf16_f32 v42, v103, v102
    v_cvt_pk_bf16_f32 v43, v101, v100
    ds_write2_b32 v11, v40, v41 offset0:0 offset1:1
    ds_write_b64 v11, v[40:41] offset:4228
    ds_write2_b32 v11, v42, v43 offset0:128 offset1:129
    ds_write_b64 v11, v[42:43] offset:4740
    s_sub_u32 s56, s50, s3
    s_min_u32 s56, s56, 636
    s_sub_u32 s62, s50, s56
    v_lshrrev_b32 v8, 2, v1
    v_mul_u32_u24 v8, 10240, v8
    v_xor_b32 v10, v1, v7
    v_and_b32 v9, 3, v10
    v_add_u32 v9, s56, v9
    v_lshl_add_u32 v8, v9, 4, v8
    v_lshlrev_b32 v10, 4, v10
    v_min_u32 v9, 11, v1
    v_lshrrev_b32 v12, 2, v9
    v_and_b32 v9, 3, v9
    v_mul_u32_u24 v9, 15360, v9
    v_mul_u32_u24 v12, 2560, v12
    s_lshl_b32 s57, s50, 2
    v_add3_u32 v9, v9, v12, s57
    v_and_b32 v11, 1, v6
    s_mul_i32 s58, s3, 655360
    s_add_u32 s58, s58, 1048576
    s_mov_b32 s59, 32768
    s_lshl_b32 s60, s3, 12
    s_add_u32 s61, s60, 53248
    s_mul_i32 s57, s3, 8448
    v_lshrrev_b32 v14, 1, v6
    v_lshlrev_b32 v14, 3, v14
    v_lshlrev_b32 v15, 4, v7
    v_sub_u32 v14, v15, v14
    v_mul_u32_u24 v15, 4224, v11
    v_add3_u32 v14, v14, v15, s57
    v_add_u32 v223, 64, v14
    v_add_u32 v219, 2112, v14
    s_waitcnt lgkmcnt(0)
    v_min_u32 v250, 15, v1
    v_lshlrev_b32 v250, 7, v250
    v_add_u32 v250, 0, v250
    v_mov_b32 v251, 16
    v_mov_b32 v252, 16
    s_cmp_lg_u32 s3, 0
    s_cbranch_scc1 no_look
    s_mov_b32 s57, 0
    v_mov_b32 v3, 0
ipoll_1:
    v_cmp_eq_u32 vcc, 0, v253
    s_cbranch_vccz iok_2
    global_load_dword v253, v3, s[44:45] sc1
    s_add_u32 s57, s57, 1
    s_cmp_ge_u32 s57, 100000
    s_waitcnt vmcnt(0)
    s_cbranch_scc0 ipoll_1
iok_2:
    buffer_load_dword v252, v250, s[4:7], 0 offen sc1
no_look:
    ds_read_b64 a[0:1], v223 offset:3584
    ds_read_b64 a[2:3], v223 offset:3592
    ds_read_b64 a[4:5], v223 offset:3072
    ds_read_b64 a[6:7], v223 offset:3080
    ds_read_b64 a[8:9], v223 offset:2560
    ds_read_b64 a[10:11], v223 offset:2568
    ds_read_b64 a[12:13], v223 offset:2048
    ds_read_b64 a[14:15], v223 offset:2056
    ds_read_b64 a[16:17], v223 offset:3648
    ds_read_b64 a[18:19], v223 offset:3656
    ds_read_b64 a[20:21], v223 offset:3136
    ds_read_b64 a[22:23], v223 offset:3144
    ds_read_b64 a[24:25], v223 offset:2624
    ds_read_b64 a[26:27], v223 offset:2632
    ds_read_b64 a[28:29], v223 offset:2112
    ds_read_b64 a[30:31], v223 offset:2120
    ds_read_b64 a[32:33], v223 offset:3712
    ds_read_b64 a[34:35], v223 offset:3720
    ds_read_b64 a[36:37], v223 offset:3200
    ds_read_b64 a[38:39], v223 offset:3208
    ds_read_b64 a[40:41], v223 offset:2688
    ds_read_b64 a[42:43], v223 offset:2696
    ds_read_b64 a[44:45], v223 offset:2176
    ds_read_b64 a[46:47], v223 offset:2184
    ds_read_b64 a[48:49], v223 offset:3776
    ds_read_b64 a[50:51], v223 offset:3784
    ds_read_b64 a[52:53], v223 offset:3264
    ds_read_b64 a[54:55], v223 offset:3272
    ds_read_b64 a[56:57], v223 offset:2752
    ds_read_b64 a[58:59], v223 offset:2760
    ds_read_b64 a[60:61], v223 offset:2240
    ds_read_b64 a[62:63], v223 offset:2248
    ds_read_b64 a[64:65], v223 offset:3840
    ds_read_b64 a[66:67], v223 offset:3848
    ds_read_b64 a[68:69], v223 offset:3328
    ds_read_b64 a[70:71], v223 offset:3336
    ds_read_b64 a[72:73], v223 offset:2816
    ds_read_b64 a[74:75], v223 offset:2824
    ds_read_b64 a[76:77], v223 offset:2304
    ds_read_b64 a[78:79], v223 offset:2312
    ds_read_b64 a[80:81], v223 offset:3904
    ds_read_b64 a[82:83], v223 offset:3912
    ds_read_b64 a[84:85], v223 offset:3392
    ds_read_b64 a[86:87], v223 offset:3400
    ds_read_b64 a[88:89], v223 offset:2880
    ds_read_b64 a[90:91], v223 offset:2888
    ds_read_b64 a[92:93], v223 offset:2368
    ds_read_b64 a[94:95], v223 offset:2376
    ds_read_b64 a[96:97], v223 offset:3968
    ds_read_b64 a[98:99], v223 offset:3976
    ds_read_b64 a[100:101], v223 offset:3456
    ds_read_b64 a[102:103], v223 offset:3464
    ds_read_b64 a[104:105], v223 offset:2944
    ds_read_b64 a[106:107], v223 offset:2952
    ds_read_b64 a[108:109], v223 offset:2432
    ds_read_b64 a[110:111], v223 offset:2440
    ds_read_b64 a[112:113], v223 offset:4032
    ds_read_b64 a[114:115], v223 offset:4040
    ds_read_b64 a[116:117], v223 offset:3520
    ds_read_b64 a[118:119], v223 offset:3528
    ds_read_b64 a[120:121], v223 offset:3008
    ds_read_b64 a[122:123], v223 offset:3016
    ds_read_b64 a[124:125], v223 offset:2496
    ds_read_b64 a[126:127], v223 offset:2504
    ds_read_b64 v[96:97], v223 offset:1536
    ds_read_b64 v[98:99], v223 offset:1544
    ds_read_b64 v[100:101], v223 offset:1024
    ds_read_b64 v[102:103], v223 offset:1032
    ds_read_b64 v[104:105], v223 offset:512
    ds_read_b64 v[106:107], v223 offset:520
    ds_read_b64 v[108:109], v223 offset:0
    ds_read_b64 v[110:111], v223 offset:8
    s_waitcnt vmcnt(0)
    v_cmp_gt_u32 vcc, v251, v252
    s_cbranch_vccz c1_seen
    s_mov_b32 s57, 0
poll_3:
    buffer_load_dword v252, v250, s[4:7], 0 offen sc1
    s_add_u32 s57, s57, 1
    s_cmp_ge_u32 s57, 100000
    s_waitcnt vmcnt(0)
    s_cbranch_scc1 pdone_4
    v_cmp_gt_u32 vcc, v251, v252
    s_cbranch_vccz pdone_4
    s_sleep 2
    s_branch poll_3
pdone_4:
c1_seen:
    s_mov_b32 m0, s61
    s_barrier
    buffer_load_dword v12, v9, s[4:7], s59 offen sc1
    s_cmp_ge_u32 s3, 2
    s_cbranch_scc0 do_st
    s_waitcnt vmcnt(0)
    s_branch no_st
do_st:
    buffer_load_dwordx4 v8, s[4:7], s58 offen sc1 lds
    s_add_u32 s58, s58, 163840
    s_add_u32 m0, m0, 1024
    s_nop 0
    buffer_load_dwordx4 v8, s[4:7], s58 offen sc1 lds
    s_add_u32 s58, s58, 163840
    s_add_u32 m0, m0, 1024
    s_nop 0
    buffer_load_dwordx4 v8, s[4:7], s58 offen sc1 lds
    s_add_u32 s58, s58, 163840
    s_add_u32 m0, m0, 1024
    s_nop 0
    buffer_load_dwordx4 v8, s[4:7], s58 offen sc1 lds
    s_add_u32 m0, s60, 76288
    s_add_u32 s57, s60, 237568
    buffer_load_dwordx4 v10, s[4:7], s57 offen offset:0 sc1 lds
    buffer_load_dwordx4 v10, s[4:7], s57 offen offset:1024 sc1 lds
    buffer_load_dwordx4 v10, s[4:7], s57 offen offset:2048 sc1 lds
    buffer_load_dwordx4 v10, s[4:7], s57 offen offset:3072 sc1 lds
    s_add_u32 s58, s58, 819200
    s_add_u32 m0, s61, 8192
    s_nop 0
    buffer_load_dwordx4 v8, s[4:7], s58 offen sc1 lds
    s_add_u32 s58, s58, 163840
    s_add_u32 m0, m0, 1024
    s_nop 0
    buffer_load_dwordx4 v8, s[4:7], s58 offen sc1 lds
    s_add_u32 s58, s58, 163840
    s_add_u32 m0, m0, 1024
    s_nop 0
    buffer_load_dwordx4 v8, s[4:7], s58 offen sc1 lds
    s_add_u32 s58, s58, 163840
    s_add_u32 m0, m0, 1024
    s_nop 0
    buffer_load_dwordx4 v8, s[4:7], s58 offen sc1 lds
    s_add_u32 m0, s60, 84480
    s_add_u32 s57, s60, 245760
    buffer_load_dwordx4 v10, s[4:7], s57 offen offset:0 sc1 lds
    buffer_load_dwordx4 v10, s[4:7], s57 offen offset:1024 sc1 lds
    buffer_load_dwordx4 v10, s[4:7], s57 offen offset:2048 sc1 lds
    buffer_load_dwordx4 v10, s[4:7], s57 offen offset:3072 sc1 lds
no_st:
    s_mul_i32 s56, s3, 9216
    s_add_u32 s56, s56, 25600
    v_mov_b32 v32, 0
    v_mov_b32 v33, 0
    v_mov_b32 v34, 0
    v_mov_b32 v35, 0
    v_min_u32 v13, 27, v1
    v_lshl_add_u32 v13, v13, 4, s56
    ds_write_b128 v13, v[32:35]
    ds_write_b128 v13, v[32:35] offset:4576
    v_add_u32 v13, s56, v4
    v_lshrrev_b32 v14, 1, v6
    v_lshlrev_b32 v14, 6, v14
    v_lshl_add_u32 v14, v7, 4, v14
    v_xor_b32 v15, 1, v11
    v_mul_u32_u24 v15, 4576, v15
    v_add3_u32 v222, v14, v15, s56
    v_bfe_u32 v14, v1, 2, 2
    v_lshlrev_b32 v15, 6, v1
    v_xor_b32 v8, s62, v14
    v_lshl_add_u32 v8, v8, 4, v15
    v_add_u32 v8, 53248, v8
    v_add_u32 v15, 76288, v15
    v_xor_b32 v48, 0, v14
    v_lshl_add_u32 v48, v48, 4, v15
    v_xor_b32 v49, 1, v14
    v_lshl_add_u32 v49, v49, 4, v15
    v_xor_b32 v50, 2, v14
    v_lshl_add_u32 v50, v50, 4, v15
    v_xor_b32 v51, 3, v14
    v_lshl_add_u32 v51, v51, 4, v15
    v_lshrrev_b32 v14, 1, v6
    v_lshl_add_u32 v15, v14, 2, v7
    v_lshlrev_b32 v15, 6, v15
    v_and_b32 v14, 3, v14
    v_xor_b32 v14, s62, v14
    v_lshl_add_u32 v14, v14, 4, v15
    v_lshl_add_u32 v14, v11, 3, v14
    v_add_u32 v221, 53248, v14
    v_and_b32 v14, 1, v7
    v_lshlrev_b32 v14, 3, v14
    v_lshrrev_b32 v15, 1, v6
    v_add_u32 v14, v14, v15
    v_mul_u32_u24 v14, 40960, v14
    v_lshrrev_b32 v15, 1, v7
    v_lshl_add_u32 v14, v15, 5, v14
    v_lshl_add_u32 v220, v11, 4, v14
    s_lshl_b32 s61, s50, 6
    s_add_u32 s61, s61, 3670016
    s_waitcnt vmcnt(8)
    s_cmp_ge_u32 s3, 2
    s_cbranch_scc1 no_arr
    v_mov_b32 v2, 25356
    v_mov_b32 v3, 1
    s_mov_b64 exec, 1
    ds_add_u32 v2, v3
    s_mov_b64 exec, -1
no_arr:
    v_add_f32_dpp v12, v12, v12 quad_perm:[1,0,3,2] row_mask:0xf bank_mask:0xf
    s_nop 1
    v_add_f32_dpp v12, v12, v12 quad_perm:[2,3,0,1] row_mask:0xf bank_mask:0xf
    v_cvt_pk_bf16_f32 v12, v12, v12
    v_lshlrev_b32 v12, 16, v12
    v_add_f32 v14, 1.0, v12
    v_cvt_pk_bf16_f32 v14, v14, v14
    v_lshlrev_b32 v14, 16, v14
    v_readlane_b32 s60, v12, 0
    v_readlane_b32 s58, v14, 4
    v_readlane_b32 s62, v12, 8
    v_mov_b32 v14, s60
    v_mov_b32 v15, s58
    v_mul_f32 v14, s62, v14
    v_mul_f32 v15, s62, v15
    v_mov_b32 v212, 0
    v_readfirstlane_b32 s58, v15
    v_readfirstlane_b32 s59, v15
    v_mov_b32 v2, 25356
    s_mov_b32 s57, 0
lw_5:
    ds_read_b32 v3, v2
    s_add_u32 s57, s57, 1
    s_cmp_ge_u32 s57, 2000000
    s_waitcnt lgkmcnt(0)
    s_cbranch_scc1 lwd_6
    v_cmp_gt_u32 vcc, 2, v3
    s_cbranch_vccnz lw_5
lwd_6:
    v_cmp_eq_u32 s[30:31], 0, v1
    ds_read_b128 v[160:163], v8 offset:0
    ds_read_b128 v[164:167], v48 offset:0
    ds_read_b128 v[168:171], v49 offset:0
    ds_read_b128 v[172:175], v50 offset:0
    ds_read_b128 v[176:179], v51 offset:0
    ds_read_b128 v[180:183], v8 offset:4096
    ds_read_b128 v[184:187], v48 offset:4096
    ds_read_b128 v[188:191], v49 offset:4096
    ds_read_b128 v[192:195], v50 offset:4096
    ds_read_b128 v[196:199], v51 offset:4096
    s_waitcnt lgkmcnt(5)
    v_lshlrev_b32 v200, 16, v160
    v_and_b32 v201, 0xffff0000, v160
    v_lshlrev_b32 v202, 16, v161
    v_and_b32 v203, 0xffff0000, v161
    v_lshlrev_b32 v204, 16, v162
    v_and_b32 v205, 0xffff0000, v162
    v_lshlrev_b32 v206, 16, v163
    v_and_b32 v207, 0xffff0000, v163
    v_pk_fma_f32 v[200:201], v[200:201], v[164:165], v[166:167] neg_lo:[0,0,1] neg_hi:[0,0,1]
    v_pk_fma_f32 v[202:203], v[202:203], v[168:169], v[170:171] neg_lo:[0,0,1] neg_hi:[0,0,1]
    v_pk_fma_f32 v[204:205], v[204:205], v[172:173], v[174:175] neg_lo:[0,0,1] neg_hi:[0,0,1]
    v_pk_fma_f32 v[206:207], v[206:207], v[176:177], v[178:179] neg_lo:[0,0,1] neg_hi:[0,0,1]
    v_pk_fma_f32 v[200:201], v[200:201], s[58:59], v[14:15] op_sel_hi:[1,1,0]
    v_pk_fma_f32 v[202:203], v[202:203], s[58:59], v[14:15] op_sel_hi:[1,1,0]
    v_pk_fma_f32 v[204:205], v[204:205], s[58:59], v[14:15] op_sel_hi:[1,1,0]
    v_pk_fma_f32 v[206:207], v[206:207], s[58:59], v[14:15] op_sel_hi:[1,1,0]
    v_cvt_pk_bf16_f32 v52, v200, v204
    v_cvt_pk_bf16_f32 v53, v201, v205
    v_cvt_pk_bf16_f32 v54, v202, v206
    v_cvt_pk_bf16_f32 v55, v203, v207
    v_mov_b32_dpp v213, v207 wave_ror:1 row_mask:0xf bank_mask:0xf
    v_cvt_pk_bf16_f32 v57, v204, v201
    v_cvt_pk_bf16_f32 v58, v205, v202
    v_cvt_pk_bf16_f32 v59, v206, v203
    v_cndmask_b32 v217, v213, v212, s[30:31]
    ds_write_b128 v13, v[52:55] offset:448
    v_cvt_pk_bf16_f32 v56, v217, v200
    ds_write_b128 v13, v[56:59] offset:5024
    s_waitcnt lgkmcnt(2)
    v_lshlrev_b32 v200, 16, v180
    v_and_b32 v201, 0xffff0000, v180
    v_lshlrev_b32 v202, 16, v181
    v_and_b32 v203, 0xffff0000, v181
    v_lshlrev_b32 v204, 16, v182
    v_and_b32 v205, 0xffff0000, v182
    v_lshlrev_b32 v206, 16, v183
    v_and_b32 v207, 0xffff0000, v183
    v_pk_fma_f32 v[200:201], v[200:201], v[184:185], v[186:187] neg_lo:[0,0,1] neg_hi:[0,0,1]
    v_pk_fma_f32 v[202:203], v[202:203], v[188:189], v[190:191] neg_lo:[0,0,1] neg_hi:[0,0,1]
    v_pk_fma_f32 v[204:205], v[204:205], v[192:193], v[194:195] neg_lo:[0,0,1] neg_hi:[0,0,1]
    v_pk_fma_f32 v[206:207], v[206:207], v[196:197], v[198:199] neg_lo:[0,0,1] neg_hi:[0,0,1]
    v_pk_fma_f32 v[200:201], v[200:201], s[58:59], v[14:15] op_sel_hi:[1,1,0]
    v_pk_fma_f32 v[202:203], v[202:203], s[58:59], v[14:15] op_sel_hi:[1,1,0]
    v_pk_fma_f32 v[204:205], v[204:205], s[58:59], v[14:15] op_sel_hi:[1,1,0]
    v_pk_fma_f32 v[206:207], v[206:207], s[58:59], v[14:15] op_sel_hi:[1,1,0]
    v_cvt_pk_bf16_f32 v64, v200, v204
    v_cvt_pk_bf16_f32 v65, v201, v205
    v_cvt_pk_bf16_f32 v66, v202, v206
    v_cvt_pk_bf16_f32 v67, v203, v207
    v_mov_b32_dpp v214, v207 wave_ror:1 row_mask:0xf bank_mask:0xf
    v_cvt_pk_bf16_f32 v69, v204, v201
    v_cvt_pk_bf16_f32 v70, v205, v202
    v_cvt_pk_bf16_f32 v71, v206, v203
    v_cndmask_b32 v217, v214, v213, s[30:31]
    ds_write_b128 v13, v[64:67] offset:1472
    v_cvt_pk_bf16_f32 v68, v217, v200
    ds_write_b128 v13, v[68:71] offset:6048
    s_waitcnt lgkmcnt(0)
    ds_read_b128 v[112:115], v222 offset:0
    ds_read_b128 v[116:119], v222 offset:512
    ds_read_b128 v[120:123], v222 offset:1024
    ds_read_b128 v[124:127], v222 offset:1536
    s_waitcnt lgkmcnt(3)
    v_mfma_f32_16x16x32_bf16 v[16:19], a[0:3], v[112:115], 0
    ds_read_b128 v[144:147], v222 offset:64
    v_mfma_f32_16x16x32_bf16 v[20:23], a[4:7], v[112:115], 0
    v_mfma_f32_16x16x32_bf16 v[24:27], a[8:11], v[112:115], 0
    ds_read_b128 v[148:151], v222 offset:576
    v_mfma_f32_16x16x32_bf16 v[28:31], a[12:15], v[112:115], 0
    s_waitcnt lgkmcnt(4)
    v_mfma_f32_16x16x32_bf16 v[20:23], a[0:3], v[116:119], v[20:23]
    ds_read_b128 v[152:155], v222 offset:1088
    v_mfma_f32_16x16x32_bf16 v[24:27], a[4:7], v[116:119], v[24:27]
    v_mfma_f32_16x16x32_bf16 v[28:31], a[8:11], v[116:119], v[28:31]
    ds_read_b128 v[156:159], v222 offset:1600
    v_mfma_f32_16x16x32_bf16 v[32:35], a[12:15], v[116:119], 0
    s_waitcnt lgkmcnt(5)
    v_mfma_f32_16x16x32_bf16 v[24:27], a[0:3], v[120:123], v[24:27]
    ds_read_b64 v[128:129], v223 offset:1600
    v_mfma_f32_16x16x32_bf16 v[28:31], a[4:7], v[120:123], v[28:31]
    v_mfma_f32_16x16x32_bf16 v[32:35], a[8:11], v[120:123], v[32:35]
    ds_read_b64 v[130:131], v223 offset:1608
    v_mfma_f32_16x16x32_bf16 v[36:39], a[12:15], v[120:123], 0
    s_waitcnt lgkmcnt(6)
    v_mfma_f32_16x16x32_bf16 v[28:31], a[0:3], v[124:127], v[28:31]
    ds_read_b64 v[132:133], v223 offset:1088
    v_mfma_f32_16x16x32_bf16 v[32:35], a[4:7], v[124:127], v[32:35]
    v_mfma_f32_16x16x32_bf16 v[36:39], a[8:11], v[124:127], v[36:39]
    ds_read_b64 v[134:135], v223 offset:1096
    v_mfma_f32_16x16x32_bf16 v[40:43], a[12:15], v[124:127], 0
    v_mfma_f32_16x16x32_bf16 v[32:35], v[96:99], v[112:115], v[32:35]
    ds_read_b64 v[136:137], v223 offset:576
    v_mfma_f32_16x16x32_bf16 v[36:39], v[100:103], v[112:115], v[36:39]
    v_mfma_f32_16x16x32_bf16 v[40:43], v[104:107], v[112:115], v[40:43]
    ds_read_b64 v[138:139], v223 offset:584
    v_mfma_f32_16x16x32_bf16 v[44:47], v[108:111], v[112:115], 0
    v_mfma_f32_16x16x32_bf16 v[36:39], v[96:99], v[116:119], v[36:39]
    ds_read_b64 v[140:141], v223 offset:64
    v_mfma_f32_16x16x32_bf16 v[40:43], v[100:103], v[116:119], v[40:43]
    v_mfma_f32_16x16x32_bf16 v[44:47], v[104:107], v[116:119], v[44:47]
    ds_read_b64 v[142:143], v223 offset:72
    v_mfma_f32_16x16x32_bf16 v[40:43], v[96:99], v[120:123], v[40:43]
    v_mfma_f32_16x16x32_bf16 v[44:47], v[100:103], v[120:123], v[44:47]
    v_mfma_f32_16x16x32_bf16 v[44:47], v[96:99], v[124:127], v[44:47]
    s_cmp_ge_u32 s3, 2
    s_cbranch_scc1 na_7
    s_waitcnt vmcnt(0)
    v_mov_b32 v2, 25356
    v_mov_b32 v3, 1
    s_mov_b64 exec, 1
    ds_add_u32 v2, v3
    s_mov_b64 exec, -1
na_7:
    s_waitcnt lgkmcnt(8)
    v_mfma_f32_16x16x32_bf16 v[16:19], a[16:19], v[144:147], v[16:19]
    ds_read_b128 v[112:115], v222 offset:128
    v_mfma_f32_16x16x32_bf16 v[20:23], a[20:23], v[144:147], v[20:23]
    v_mfma_f32_16x16x32_bf16 v[24:27], a[24:27], v[144:147], v[24:27]
    ds_read_b128 v[116:119], v222 offset:640
    v_mfma_f32_16x16x32_bf16 v[28:31], a[28:31], v[144:147], v[28:31]
    v_mfma_f32_16x16x32_bf16 v[20:23], a[16:19], v[148:151], v[20:23]
    ds_read_b128 v[120:123], v222 offset:1152
    v_mfma_f32_16x16x32_bf16 v[24:27], a[20:23], v[148:151], v[24:27]
    v_mfma_f32_16x16x32_bf16 v[28:31], a[24:27], v[148:151], v[28:31]
    ds_read_b128 v[124:127], v222 offset:1664
    v_mfma_f32_16x16x32_bf16 v[32:35], a[28:31], v[148:151], v[32:35]
    v_mfma_f32_16x16x32_bf16 v[24:27], a[16:19], v[152:155], v[24:27]
    ds_read_b64 v[96:97], v223 offset:1664
    v_mfma_f32_16x16x32_bf16 v[28:31], a[20:23], v[152:155], v[28:31]
    v_mfma_f32_16x16x32_bf16 v[32:35], a[24:27], v[152:155], v[32:35]
    ds_read_b64 v[98:99], v223 offset:1672
    v_mfma_f32_16x16x32_bf16 v[36:39], a[28:31], v[152:155], v[36:39]
    v_mfma_f32_16x16x32_bf16 v[28:31], a[16:19], v[156:159], v[28:31]
    ds_read_b64 v[100:101], v223 offset:1152
    v_mfma_f32_16x16x32_bf16 v[32:35], a[20:23], v[156:159], v[32:35]
    v_mfma_f32_16x16x32_bf16 v[36:39], a[24:27], v[156:159], v[36:39]
    ds_read_b64 v[102:103], v223 offset:1160
    v_mfma_f32_16x16x32_bf16 v[40:43], a[28:31], v[156:159], v[40:43]
    s_waitcnt lgkmcnt(8)
    v_mfma_f32_16x16x32_bf16 v[32:35], v[128:131], v[144:147], v[32:35]
    ds_read_b64 v[104:105], v223 offset:640
    v_mfma_f32_16x16x32_bf16 v[36:39], v[132:135], v[144:147], v[36:39]
    v_mfma_f32_16x16x32_bf16 v[40:43], v[136:139], v[144:147], v[40:43]
    ds_read_b64 v[106:107], v223 offset:648
    v_mfma_f32_16x16x32_bf16 v[44:47], v[140:143], v[144:147], v[44:47]
    v_mov_b32 v2, 25356
    ds_read_b32 v3, v2
    v_mfma_f32_16x16x32_bf16 v[36:39], v[128:131], v[148:151], v[36:39]
    ds_read_b64 v[108:109], v223 offset:128
    v_mfma_f32_16x16x32_bf16 v[40:43], v[132:135], v[148:151], v[40:43]
    v_mfma_f32_16x16x32_bf16 v[44:47], v[136:139], v[148:151], v[44:47]
    ds_read_b64 v[110:111], v223 offset:136
    v_mfma_f32_16x16x32_bf16 v[40:43], v[128:131], v[152:155], v[40:43]
    v_mfma_f32_16x16x32_bf16 v[44:47], v[132:135], v[152:155], v[44:47]
    v_mfma_f32_16x16x32_bf16 v[44:47], v[128:131], v[156:159], v[44:47]
    s_waitcnt lgkmcnt(2)
    v_cmp_gt_u32 vcc, 4, v3
    s_cbranch_vccz g2ok_8
    v_mov_b32 v2, 25356
    s_mov_b32 s57, 0
lw_9:
    ds_read_b32 v3, v2
    s_add_u32 s57, s57, 1
    s_cmp_ge_u32 s57, 2000000
    s_waitcnt lgkmcnt(0)
    s_cbranch_scc1 lwd_10
    v_cmp_gt_u32 vcc, 4, v3
    s_cbranch_vccnz lw_9
lwd_10:
g2ok_8:
    v_mfma_f32_16x16x32_bf16 v[16:19], a[32:35], v[112:115], v[16:19]
    ds_read_b128 v[144:147], v222 offset:192
    ds_read_b128 v[160:163], v8 offset:8192
    v_mfma_f32_16x16x32_bf16 v[20:23], a[36:39], v[112:115], v[20:23]
    ds_read_b128 v[164:167], v48 offset:8192
    ds_read_b128 v[168:171], v49 offset:8192
    v_mfma_f32_16x16x32_bf16 v[24:27], a[40:43], v[112:115], v[24:27]
    ds_read_b128 v[148:151], v222 offset:704
    ds_read_b128 v[172:175], v50 offset:8192
    v_mfma_f32_16x16x32_bf16 v[28:31], a[44:47], v[112:115], v[28:31]
    ds_read_b128 v[176:179], v51 offset:8192
    v_mfma_f32_16x16x32_bf16 v[20:23], a[32:35], v[116:119], v[20:23]
    ds_read_b128 v[152:155], v222 offset:1216
    v_mfma_f32_16x16x32_bf16 v[24:27], a[36:39], v[116:119], v[24:27]
    v_mfma_f32_16x16x32_bf16 v[28:31], a[40:43], v[116:119], v[28:31]
    ds_read_b128 v[156:159], v222 offset:1728
    v_mfma_f32_16x16x32_bf16 v[32:35], a[44:47], v[116:119], v[32:35]
    v_mfma_f32_16x16x32_bf16 v[24:27], a[32:35], v[120:123], v[24:27]
    ds_read_b64 v[128:129], v223 offset:1728
    v_mfma_f32_16x16x32_bf16 v[28:31], a[36:39], v[120:123], v[28:31]
    v_mfma_f32_16x16x32_bf16 v[32:35], a[40:43], v[120:123], v[32:35]
    ds_read_b64 v[130:131], v223 offset:1736
    v_mfma_f32_16x16x32_bf16 v[36:39], a[44:47], v[120:123], v[36:39]
    v_mfma_f32_16x16x32_bf16 v[28:31], a[32:35], v[124:127], v[28:31]
    ds_read_b64 v[132:133], v223 offset:1216
    v_mfma_f32_16x16x32_bf16 v[32:35], a[36:39], v[124:127], v[32:35]
    s_waitcnt lgkmcnt(5)
    v_lshlrev_b32 v200, 16, v160
    v_mfma_f32_16x16x32_bf16 v[36:39], a[40:43], v[124:127], v[36:39]
    ds_read_b64 v[134:135], v223 offset:1224
    v_and_b32 v201, 0xffff0000, v160
    v_mfma_f32_16x16x32_bf16 v[40:43], a[44:47], v[124:127], v[40:43]
    v_lshlrev_b32 v202, 16, v161
    v_and_b32 v203, 0xffff0000, v161
    v_mfma_f32_16x16x32_bf16 v[32:35], v[96:99], v[112:115], v[32:35]
    ds_read_b64 v[136:137], v223 offset:704
    v_lshlrev_b32 v204, 16, v162
    v_mfma_f32_16x16x32_bf16 v[36:39], v[100:103], v[112:115], v[36:39]
    v_and_b32 v205, 0xffff0000, v162
    v_lshlrev_b32 v206, 16, v163
    v_mfma_f32_16x16x32_bf16 v[40:43], v[104:107], v[112:115], v[40:43]
    ds_read_b64 v[138:139], v223 offset:712
    v_and_b32 v207, 0xffff0000, v163
    v_mfma_f32_16x16x32_bf16 v[44:47], v[108:111], v[112:115], v[44:47]
    v_fma_f32 v200, v200, v164, -v166
    v_fma_f32 v201, v201, v165, -v167
    v_mfma_f32_16x16x32_bf16 v[36:39], v[96:99], v[116:119], v[36:39]
    ds_read_b64 v[140:141], v223 offset:192
    v_fma_f32 v202, v202, v168, -v170
    v_mfma_f32_16x16x32_bf16 v[40:43], v[100:103], v[116:119], v[40:43]
    v_fma_f32 v203, v203, v169, -v171
    v_fma_f32 v204, v204, v172, -v174
    v_mfma_f32_16x16x32_bf16 v[44:47], v[104:107], v[116:119], v[44:47]
    ds_read_b64 v[142:143], v223 offset:200
    v_fma_f32 v205, v205, v173, -v175
    v_mfma_f32_16x16x32_bf16 v[40:43], v[96:99], v[120:123], v[40:43]
    v_fma_f32 v206, v206, v176, -v178
    v_fma_f32 v207, v207, v177, -v179
    v_mfma_f32_16x16x32_bf16 v[44:47], v[100:103], v[120:123], v[44:47]
    v_fma_f32 v200, v200, v15, v14
    v_fma_f32 v201, v201, v15, v14
    v_mfma_f32_16x16x32_bf16 v[44:47], v[96:99], v[124:127], v[44:47]
    v_fma_f32 v202, v202, v15, v14
    v_fma_f32 v203, v203, v15, v14
    s_waitcnt lgkmcnt(8)
    v_mfma_f32_16x16x32_bf16 v[16:19], a[48:51], v[144:147], v[16:19]
    ds_read_b128 v[112:115], v222 offset:256
    v_fma_f32 v204, v204, v15, v14
    v_mfma_f32_16x16x32_bf16 v[20:23], a[52:55], v[144:147], v[20:23]
    v_fma_f32 v205, v205, v15, v14
    v_fma_f32 v206, v206, v15, v14
    v_mfma_f32_16x16x32_bf16 v[24:27], a[56:59], v[144:147], v[24:27]
    ds_read_b128 v[116:119], v222 offset:768
    v_fma_f32 v207, v207, v15, v14
    v_mfma_f32_16x16x32_bf16 v[28:31], a[60:63], v[144:147], v[28:31]
    ds_read_b128 v[160:163], v8 offset:12288
    ds_read_b128 v[164:167], v48 offset:12288
    v_mfma_f32_16x16x32_bf16 v[20:23], a[48:51], v[148:151], v[20:23]
    ds_read_b128 v[120:123], v222 offset:1280
    ds_read_b128 v[168:171], v49 offset:12288
    v_mfma_f32_16x16x32_bf16 v[24:27], a[52:55], v[148:151], v[24:27]
    ds_read_b128 v[172:175], v50 offset:12288
    ds_read_b128 v[176:179], v51 offset:12288
    v_mfma_f32_16x16x32_bf16 v[28:31], a[56:59], v[148:151], v[28:31]
    ds_read_b128 v[124:127], v222 offset:1792
    v_cvt_pk_bf16_f32 v52, v200, v204
    v_mfma_f32_16x16x32_bf16 v[32:35], a[60:63], v[148:151], v[32:35]
    v_cvt_pk_bf16_f32 v53, v201, v205
    v_cvt_pk_bf16_f32 v54, v202, v206
    v_mfma_f32_16x16x32_bf16 v[24:27], a[48:51], v[152:155], v[24:27]
    ds_read_b64 v[96:97], v223 offset:1792
    v_cvt_pk_bf16_f32 v55, v203, v207
    v_mfma_f32_16x16x32_bf16 v[28:31], a[52:55], v[152:155], v[28:31]
    v_mov_b32_dpp v215, v207 wave_ror:1 row_mask:0xf bank_mask:0xf
    v_cvt_pk_bf16_f32 v57, v204, v201
    v_mfma_f32_16x16x32_bf16 v[32:35], a[56:59], v[152:155], v[32:35]
    ds_read_b64 v[98:99], v223 offset:1800
    v_cvt_pk_bf16_f32 v58, v205, v202
    v_mfma_f32_16x16x32_bf16 v[36:39], a[60:63], v[152:155], v[36:39]
    v_cvt_pk_bf16_f32 v59, v206, v203
    v_cndmask_b32 v217, v215, v214, s[30:31]
    v_mfma_f32_16x16x32_bf16 v[28:31], a[48:51], v[156:159], v[28:31]
    ds_read_b64 v[100:101], v223 offset:1280
    ds_write_b128 v13, v[52:55] offset:2496
    v_mfma_f32_16x16x32_bf16 v[32:35], a[52:55], v[156:159], v[32:35]
    v_cvt_pk_bf16_f32 v56, v217, v200
    ds_write_b128 v13, v[56:59] offset:7072
    v_mfma_f32_16x16x32_bf16 v[36:39], a[56:59], v[156:159], v[36:39]
    ds_read_b64 v[102:103], v223 offset:1288
    s_waitcnt lgkmcnt(7)
    v_mfma_f32_16x16x32_bf16 v[40:43], a[60:63], v[156:159], v[40:43]
    v_lshlrev_b32 v200, 16, v160
    v_and_b32 v201, 0xffff0000, v160
    v_mfma_f32_16x16x32_bf16 v[32:35], v[128:131], v[144:147], v[32:35]
    ds_read_b64 v[104:105], v223 offset:768
    v_lshlrev_b32 v202, 16, v161
    v_mfma_f32_16x16x32_bf16 v[36:39], v[132:135], v[144:147], v[36:39]
    v_and_b32 v203, 0xffff0000, v161
    v_lshlrev_b32 v204, 16, v162
    v_mfma_f32_16x16x32_bf16 v[40:43], v[136:139], v[144:147], v[40:43]
    ds_read_b64 v[106:107], v223 offset:776
    v_and_b32 v205, 0xffff0000, v162
    v_mfma_f32_16x16x32_bf16 v[44:47], v[140:143], v[144:147], v[44:47]
    v_lshlrev_b32 v206, 16, v163
    v_and_b32 v207, 0xffff0000, v163
    v_mfma_f32_16x16x32_bf16 v[36:39], v[128:131], v[148:151], v[36:39]
    ds_read_b64 v[108:109], v223 offset:256
    v_fma_f32 v200, v200, v164, -v166
    v_mfma_f32_16x16x32_bf16 v[40:43], v[132:135], v[148:151], v[40:43]
    v_fma_f32 v201, v201, v165, -v167
    v_fma_f32 v202, v202, v168, -v170
    v_mfma_f32_16x16x32_bf16 v[44:47], v[136:139], v[148:151], v[44:47]
    ds_read_b64 v[110:111], v223 offset:264
    v_fma_f32 v203, v203, v169, -v171
    v_mfma_f32_16x16x32_bf16 v[40:43], v[128:131], v[152:155], v[40:43]
    v_fma_f32 v204, v204, v172, -v174
    v_fma_f32 v205, v205, v173, -v175
    v_mfma_f32_16x16x32_bf16 v[44:47], v[132:135], v[152:155], v[44:47]
    v_fma_f32 v206, v206, v176, -v178
    v_fma_f32 v207, v207, v177, -v179
    v_mfma_f32_16x16x32_bf16 v[44:47], v[128:131], v[156:159], v[44:47]
    v_fma_f32 v200, v200, v15, v14
    v_fma_f32 v201, v201, v15, v14
    s_waitcnt lgkmcnt(10)
    v_mfma_f32_16x16x32_bf16 v[16:19], a[64:67], v[112:115], v[16:19]
    ds_read_b128 v[144:147], v222 offset:320
    v_fma_f32 v202, v202, v15, v14
    v_mfma_f32_16x16x32_bf16 v[20:23], a[68:71], v[112:115], v[20:23]
    v_fma_f32 v203, v203, v15, v14
    v_fma_f32 v204, v204, v15, v14
    v_mfma_f32_16x16x32_bf16 v[24:27], a[72:75], v[112:115], v[24:27]
    ds_read_b128 v[148:151], v222 offset:832
    v_fma_f32 v205, v205, v15, v14
    v_mfma_f32_16x16x32_bf16 v[28:31], a[76:79], v[112:115], v[28:31]
    v_fma_f32 v206, v206, v15, v14
    v_fma_f32 v207, v207, v15, v14
    v_mfma_f32_16x16x32_bf16 v[20:23], a[64:67], v[116:119], v[20:23]
    ds_read_b128 v[152:155], v222 offset:1344
    v_cvt_pk_bf16_f32 v52, v200, v204
    v_mfma_f32_16x16x32_bf16 v[24:27], a[68:71], v[116:119], v[24:27]
    v_cvt_pk_bf16_f32 v53, v201, v205
    v_cvt_pk_bf16_f32 v54, v202, v206
    v_mfma_f32_16x16x32_bf16 v[28:31], a[72:75], v[116:119], v[28:31]
    ds_read_b128 v[156:159], v222 offset:1856
    v_cvt_pk_bf16_f32 v55, v203, v207
    v_mfma_f32_16x16x32_bf16 v[32:35], a[76:79], v[116:119], v[32:35]
    v_mov_b32_dpp v216, v207 wave_ror:1 row_mask:0xf bank_mask:0xf
    v_cvt_pk_bf16_f32 v57, v204, v201
    v_mfma_f32_16x16x32_bf16 v[24:27], a[64:67], v[120:123], v[24:27]
    ds_read_b64 v[128:129], v223 offset:1856
    v_cvt_pk_bf16_f32 v58, v205, v202
    v_mfma_f32_16x16x32_bf16 v[28:31], a[68:71], v[120:123], v[28:31]
    v_cvt_pk_bf16_f32 v59, v206, v203
    v_cndmask_b32 v217, v216, v215, s[30:31]
    v_mfma_f32_16x16x32_bf16 v[32:35], a[72:75], v[120:123], v[32:35]
    ds_read_b64 v[130:131], v223 offset:1864
    ds_write_b128 v13, v[52:55] offset:3520
    v_mfma_f32_16x16x32_bf16 v[36:39], a[76:79], v[120:123], v[36:39]
    v_cvt_pk_bf16_f32 v56, v217, v200
    ds_write_b128 v13, v[56:59] offset:8096
    v_mfma_f32_16x16x32_bf16 v[28:31], a[64:67], v[124:127], v[28:31]
    ds_read_b64 v[132:133], v223 offset:1344
    v_mov_b32 v2, 25348
    v_mov_b32 v3, 1
    s_mov_b64 exec, 1
    ds_add_u32 v2, v3
    s_mov_b64 exec, -1
    v_mfma_f32_16x16x32_bf16 v[32:35], a[68:71], v[124:127], v[32:35]
    v_mfma_f32_16x16x32_bf16 v[36:39], a[72:75], v[124:127], v[36:39]
    ds_read_b64 v[134:135], v223 offset:1352
    v_mfma_f32_16x16x32_bf16 v[40:43], a[76:79], v[124:127], v[40:43]
    s_waitcnt lgkmcnt(11)
    v_mfma_f32_16x16x32_bf16 v[32:35], v[96:99], v[112:115], v[32:35]
    ds_read_b64 v[136:137], v223 offset:832
    v_mfma_f32_16x16x32_bf16 v[36:39], v[100:103], v[112:115], v[36:39]
    v_mfma_f32_16x16x32_bf16 v[40:43], v[104:107], v[112:115], v[40:43]
    ds_read_b64 v[138:139], v223 offset:840
    v_mfma_f32_16x16x32_bf16 v[44:47], v[108:111], v[112:115], v[44:47]
    v_mfma_f32_16x16x32_bf16 v[36:39], v[96:99], v[116:119], v[36:39]
    ds_read_b64 v[140:141], v223 offset:320
    v_mfma_f32_16x16x32_bf16 v[40:43], v[100:103], v[116:119], v[40:43]
    v_mfma_f32_16x16x32_bf16 v[44:47], v[104:107], v[116:119], v[44:47]
    ds_read_b64 v[142:143], v223 offset:328
    v_mfma_f32_16x16x32_bf16 v[40:43], v[96:99], v[120:123], v[40:43]
    v_mfma_f32_16x16x32_bf16 v[44:47], v[100:103], v[120:123], v[44:47]
    v_mfma_f32_16x16x32_bf16 v[44:47], v[96:99], v[124:127], v[44:47]
    s_waitcnt lgkmcnt(11)
    v_mfma_f32_16x16x32_bf16 v[16:19], a[80:83], v[144:147], v[16:19]
    ds_read_b128 v[112:115], v222 offset:384
    v_mfma_f32_16x16x32_bf16 v[20:23], a[84:87], v[144:147], v[20:23]
    v_mfma_f32_16x16x32_bf16 v[24:27], a[88:91], v[144:147], v[24:27]
    ds_read_b128 v[116:119], v222 offset:896
    v_mfma_f32_16x16x32_bf16 v[28:31], a[92:95], v[144:147], v[28:31]
    v_mfma_f32_16x16x32_bf16 v[20:23], a[80:83], v[148:151], v[20:23]
    ds_read_b128 v[120:123], v222 offset:1408
    v_mfma_f32_16x16x32_bf16 v[24:27], a[84:87], v[148:151], v[24:27]
    v_mfma_f32_16x16x32_bf16 v[28:31], a[88:91], v[148:151], v[28:31]
    ds_read_b128 v[124:127], v222 offset:1920
    v_mfma_f32_16x16x32_bf16 v[32:35], a[92:95], v[148:151], v[32:35]
    v_mfma_f32_16x16x32_bf16 v[24:27], a[80:83], v[152:155], v[24:27]
    ds_read_b64 v[96:97], v223 offset:1920
    v_mfma_f32_16x16x32_bf16 v[28:31], a[84:87], v[152:155], v[28:31]
    v_mfma_f32_16x16x32_bf16 v[32:35], a[88:91], v[152:155], v[32:35]
    ds_read_b64 v[98:99], v223 offset:1928
    v_mfma_f32_16x16x32_bf16 v[36:39], a[92:95], v[152:155], v[36:39]
    v_mfma_f32_16x16x32_bf16 v[28:31], a[80:83], v[156:159], v[28:31]
    ds_read_b64 v[100:101], v223 offset:1408
    v_mfma_f32_16x16x32_bf16 v[32:35], a[84:87], v[156:159], v[32:35]
    v_mfma_f32_16x16x32_bf16 v[36:39], a[88:91], v[156:159], v[36:39]
    ds_read_b64 v[102:103], v223 offset:1416
    v_mfma_f32_16x16x32_bf16 v[40:43], a[92:95], v[156:159], v[40:43]
    s_waitcnt lgkmcnt(8)
    v_mfma_f32_16x16x32_bf16 v[32:35], v[128:131], v[144:147], v[32:35]
    ds_read_b64 v[104:105], v223 offset:896
    v_mfma_f32_16x16x32_bf16 v[36:39], v[132:135], v[144:147], v[36:39]
    v_mfma_f32_16x16x32_bf16 v[40:43], v[136:139], v[144:147], v[40:43]
    ds_read_b64 v[106:107], v223 offset:904
    v_mfma_f32_16x16x32_bf16 v[44:47], v[140:143], v[144:147], v[44:47]
    v_mfma_f32_16x16x32_bf16 v[36:39], v[128:131], v[148:151], v[36:39]
    ds_read_b64 v[108:109], v223 offset:384
    v_mfma_f32_16x16x32_bf16 v[40:43], v[132:135], v[148:151], v[40:43]
    v_mfma_f32_16x16x32_bf16 v[44:47], v[136:139], v[148:151], v[44:47]
    ds_read_b64 v[110:111], v223 offset:392
    v_mfma_f32_16x16x32_bf16 v[40:43], v[128:131], v[152:155], v[40:43]
    v_mfma_f32_16x16x32_bf16 v[44:47], v[132:135], v[152:155], v[44:47]
    v_mfma_f32_16x16x32_bf16 v[44:47], v[128:131], v[156:159], v[44:47]
    s_waitcnt lgkmcnt(8)
    v_mfma_f32_16x16x32_bf16 v[16:19], a[96:99], v[112:115], v[16:19]
    ds_read_b128 v[144:147], v222 offset:448
    v_mfma_f32_16x16x32_bf16 v[20:23], a[100:103], v[112:115], v[20:23]
    v_mfma_f32_16x16x32_bf16 v[24:27], a[104:107], v[112:115], v[24:27]
    ds_read_b128 v[148:151], v222 offset:960
    v_mfma_f32_16x16x32_bf16 v[28:31], a[108:111], v[112:115], v[28:31]
    v_mfma_f32_16x16x32_bf16 v[20:23], a[96:99], v[116:119], v[20:23]
    ds_read_b128 v[152:155], v222 offset:1472
    v_mfma_f32_16x16x32_bf16 v[24:27], a[100:103], v[116:119], v[24:27]
    v_mfma_f32_16x16x32_bf16 v[28:31], a[104:107], v[116:119], v[28:31]
    ds_read_b128 v[156:159], v222 offset:1984
    v_mfma_f32_16x16x32_bf16 v[32:35], a[108:111], v[116:119], v[32:35]
    v_mfma_f32_16x16x32_bf16 v[24:27], a[96:99], v[120:123], v[24:27]
    ds_read_b64 v[128:129], v223 offset:1984
    v_mfma_f32_16x16x32_bf16 v[28:31], a[100:103], v[120:123], v[28:31]
    v_mfma_f32_16x16x32_bf16 v[32:35], a[104:107], v[120:123], v[32:35]
    ds_read_b64 v[130:131], v223 offset:1992
    v_mfma_f32_16x16x32_bf16 v[36:39], a[108:111], v[120:123], v[36:39]
    v_mfma_f32_16x16x32_bf16 v[28:31], a[96:99], v[124:127], v[28:31]
    ds_read_b64 v[132:133], v223 offset:1472
    v_mfma_f32_16x16x32_bf16 v[32:35], a[100:103], v[124:127], v[32:35]
    v_mfma_f32_16x16x32_bf16 v[36:39], a[104:107], v[124:127], v[36:39]
    ds_read_b64 v[134:135], v223 offset:1480
    v_mfma_f32_16x16x32_bf16 v[40:43], a[108:111], v[124:127], v[40:43]
    s_waitcnt lgkmcnt(8)
    v_mfma_f32_16x16x32_bf16 v[32:35], v[96:99], v[112:115], v[32:35]
    ds_read_b64 v[136:137], v223 offset:960
    v_mfma_f32_16x16x32_bf16 v[36:39], v[100:103], v[112:115], v[36:39]
    v_mfma_f32_16x16x32_bf16 v[40:43], v[104:107], v[112:115], v[40:43]
    ds_read_b64 v[138:139], v223 offset:968
    v_mfma_f32_16x16x32_bf16 v[44:47], v[108:111], v[112:115], v[44:47]
    v_mfma_f32_16x16x32_bf16 v[36:39], v[96:99], v[116:119], v[36:39]
    ds_read_b64 v[140:141], v223 offset:448
    v_mfma_f32_16x16x32_bf16 v[40:43], v[100:103], v[116:119], v[40:43]
    v_mfma_f32_16x16x32_bf16 v[44:47], v[104:107], v[116:119], v[44:47]
    ds_read_b64 v[142:143], v223 offset:456
    v_mfma_f32_16x16x32_bf16 v[40:43], v[96:99], v[120:123], v[40:43]
    v_mfma_f32_16x16x32_bf16 v[44:47], v[100:103], v[120:123], v[44:47]
    v_mfma_f32_16x16x32_bf16 v[44:47], v[96:99], v[124:127], v[44:47]
    s_waitcnt lgkmcnt(8)
    v_mfma_f32_16x16x32_bf16 v[16:19], a[112:115], v[144:147], v[16:19]
    ds_read_b128 v[112:115], v222 offset:2048
    v_mfma_f32_16x16x32_bf16 v[20:23], a[116:119], v[144:147], v[20:23]
    v_mfma_f32_16x16x32_bf16 v[24:27], a[120:123], v[144:147], v[24:27]
    ds_read_b128 v[116:119], v222 offset:2560
    v_mfma_f32_16x16x32_bf16 v[28:31], a[124:127], v[144:147], v[28:31]
    v_mfma_f32_16x16x32_bf16 v[20:23], a[112:115], v[148:151], v[20:23]
    ds_read_b128 v[120:123], v222 offset:3072
    v_mfma_f32_16x16x32_bf16 v[24:27], a[116:119], v[148:151], v[24:27]
    v_mfma_f32_16x16x32_bf16 v[28:31], a[120:123], v[148:151], v[28:31]
    ds_read_b128 v[124:127], v222 offset:3584
    v_mfma_f32_16x16x32_bf16 v[32:35], a[124:127], v[148:151], v[32:35]
    v_mfma_f32_16x16x32_bf16 v[24:27], a[112:115], v[152:155], v[24:27]
    v_mfma_f32_16x16x32_bf16 v[28:31], a[116:119], v[152:155], v[28:31]
    v_mfma_f32_16x16x32_bf16 v[32:35], a[120:123], v[152:155], v[32:35]
    v_mfma_f32_16x16x32_bf16 v[36:39], a[124:127], v[152:155], v[36:39]
    ds_read_b64 v[160:161], v221 offset:0
    ds_read_b64 v[162:163], v221 offset:2048
    v_mfma_f32_16x16x32_bf16 v[28:31], a[112:115], v[156:159], v[28:31]
    ds_read_b64 v[164:165], v221 offset:4096
    ds_read_b64 v[166:167], v221 offset:6144
    v_mfma_f32_16x16x32_bf16 v[32:35], a[116:119], v[156:159], v[32:35]
    v_mfma_f32_16x16x32_bf16 v[36:39], a[120:123], v[156:159], v[36:39]
    v_mfma_f32_16x16x32_bf16 v[40:43], a[124:127], v[156:159], v[40:43]
    s_waitcnt lgkmcnt(8)
    v_mfma_f32_16x16x32_bf16 v[32:35], v[128:131], v[144:147], v[32:35]
    v_mfma_f32_16x16x32_bf16 v[36:39], v[132:135], v[144:147], v[36:39]
    v_mfma_f32_16x16x32_bf16 v[40:43], v[136:139], v[144:147], v[40:43]
    v_mfma_f32_16x16x32_bf16 v[44:47], v[140:143], v[144:147], v[44:47]
    v_mfma_f32_16x16x32_bf16 v[36:39], v[128:131], v[148:151], v[36:39]
    v_mfma_f32_16x16x32_bf16 v[40:43], v[132:135], v[148:151], v[40:43]
    v_mfma_f32_16x16x32_bf16 v[44:47], v[136:139], v[148:151], v[44:47]
    v_mfma_f32_16x16x32_bf16 v[40:43], v[128:131], v[152:155], v[40:43]
    v_mfma_f32_16x16x32_bf16 v[44:47], v[132:135], v[152:155], v[44:47]
    v_mfma_f32_16x16x32_bf16 v[44:47], v[128:131], v[156:159], v[44:47]
    s_waitcnt lgkmcnt(4)
    v_mfma_f32_16x16x32_bf16 v[32:35], a[0:3], v[112:115], v[32:35]
    v_mfma_f32_16x16x32_bf16 v[36:39], a[4:7], v[112:115], v[36:39]
    ds_read_b128 v[144:147], v222 offset:2112
    v_mfma_f32_16x16x32_bf16 v[40:43], a[8:11], v[112:115], v[40:43]
    ds_read_b128 v[148:151], v222 offset:2624
    s_waitcnt lgkmcnt(4)
    v_mfma_f32_16x16x32_bf16 v[44:47], a[12:15], v[112:115], v[44:47]
    ds_read_b128 v[152:155], v222 offset:3136
    v_lshlrev_b32 v200, 16, v160
    v_mfma_f32_16x16x32_bf16 v[36:39], a[0:3], v[116:119], v[36:39]
    ds_read_b128 v[156:159], v222 offset:3648
    v_and_b32 v201, 0xffff0000, v160
    v_mfma_f32_16x16x32_bf16 v[40:43], a[4:7], v[116:119], v[40:43]
    v_add_f32 v200, v200, v16
    v_add_f32 v201, v201, v17
    v_mfma_f32_16x16x32_bf16 v[44:47], a[8:11], v[116:119], v[44:47]
    v_cvt_pk_bf16_f32 v176, v200, v201
    v_lshlrev_b32 v202, 16, v161
    v_mfma_f32_16x16x32_bf16 v[40:43], a[0:3], v[120:123], v[40:43]
    v_and_b32 v203, 0xffff0000, v161
    v_add_f32 v202, v202, v18
    v_mfma_f32_16x16x32_bf16 v[44:47], a[4:7], v[120:123], v[44:47]
    v_add_f32 v203, v203, v19
    v_cvt_pk_bf16_f32 v177, v202, v203
    v_mfma_f32_16x16x32_bf16 v[44:47], a[0:3], v[124:127], v[44:47]
    v_lshlrev_b32 v200, 16, v162
    v_and_b32 v201, 0xffff0000, v162
    s_waitcnt lgkmcnt(0)
    v_mfma_f32_16x16x32_bf16 v[32:35], a[16:19], v[144:147], v[32:35]
    v_add_f32 v200, v200, v20
    v_add_f32 v201, v201, v21
    v_mfma_f32_16x16x32_bf16 v[36:39], a[20:23], v[144:147], v[36:39]
    ds_read_b128 v[112:115], v222 offset:2176
    v_cvt_pk_bf16_f32 v178, v200, v201
    v_mfma_f32_16x16x32_bf16 v[40:43], a[24:27], v[144:147], v[40:43]
    ds_read_b128 v[116:119], v222 offset:2688
    v_lshlrev_b32 v202, 16, v163
    v_mfma_f32_16x16x32_bf16 v[44:47], a[28:31], v[144:147], v[44:47]
    ds_read_b128 v[120:123], v222 offset:3200
    v_and_b32 v203, 0xffff0000, v163
    v_mfma_f32_16x16x32_bf16 v[36:39], a[16:19], v[148:151], v[36:39]
    ds_read_b128 v[124:127], v222 offset:3712
    v_add_f32 v202, v202, v22
    v_mfma_f32_16x16x32_bf16 v[40:43], a[20:23], v[148:151], v[40:43]
    v_add_f32 v203, v203, v23
    v_cvt_pk_bf16_f32 v179, v202, v203
    v_mfma_f32_16x16x32_bf16 v[44:47], a[24:27], v[148:151], v[44:47]
    v_permlane16_swap_b32 v176, v178
    v_permlane16_swap_b32 v177, v179
    v_mfma_f32_16x16x32_bf16 v[40:43], a[16:19], v[152:155], v[40:43]
    buffer_store_dwordx4 v[176:179], v220, s[4:7], s61 offen sc1
    s_add_u32 s61, s61, 655360
    v_mfma_f32_16x16x32_bf16 v[44:47], a[20:23], v[152:155], v[44:47]
    v_lshlrev_b32 v200, 16, v164
    v_and_b32 v201, 0xffff0000, v164
    v_mfma_f32_16x16x32_bf16 v[44:47], a[16:19], v[156:159], v[44:47]
    v_add_f32 v200, v200, v24
    v_add_f32 v201, v201, v25
    s_waitcnt lgkmcnt(0)
    v_mfma_f32_16x16x32_bf16 v[32:35], a[32:35], v[112:115], v[32:35]
    v_cvt_pk_bf16_f32 v180, v200, v201
    v_lshlrev_b32 v202, 16, v165
    v_mfma_f32_16x16x32_bf16 v[36:39], a[36:39], v[112:115], v[36:39]
    ds_read_b128 v[144:147], v222 offset:2240
    v_and_b32 v203, 0xffff0000, v165
    v_mfma_f32_16x16x32_bf16 v[40:43], a[40:43], v[112:115], v[40:43]
    ds_read_b128 v[148:151], v222 offset:2752
    v_add_f32 v202, v202, v26
    v_mfma_f32_16x16x32_bf16 v[44:47], a[44:47], v[112:115], v[44:47]
    ds_read_b128 v[152:155], v222 offset:3264
    v_add_f32 v203, v203, v27
    v_mfma_f32_16x16x32_bf16 v[36:39], a[32:35], v[116:119], v[36:39]
    ds_read_b128 v[156:159], v222 offset:3776
    v_cvt_pk_bf16_f32 v181, v202, v203
    v_mfma_f32_16x16x32_bf16 v[40:43], a[36:39], v[116:119], v[40:43]
    v_lshlrev_b32 v200, 16, v166
    v_and_b32 v201, 0xffff0000, v166
    v_mfma_f32_16x16x32_bf16 v[44:47], a[40:43], v[116:119], v[44:47]
    v_add_f32 v200, v200, v28
    v_add_f32 v201, v201, v29
    v_mfma_f32_16x16x32_bf16 v[40:43], a[32:35], v[120:123], v[40:43]
    v_cvt_pk_bf16_f32 v182, v200, v201
    v_lshlrev_b32 v202, 16, v167
    v_mfma_f32_16x16x32_bf16 v[44:47], a[36:39], v[120:123], v[44:47]
    v_and_b32 v203, 0xffff0000, v167
    v_add_f32 v202, v202, v30
    v_mfma_f32_16x16x32_bf16 v[44:47], a[32:35], v[124:127], v[44:47]
    v_add_f32 v203, v203, v31
    v_cvt_pk_bf16_f32 v183, v202, v203
    s_waitcnt lgkmcnt(0)
    v_mfma_f32_16x16x32_bf16 v[32:35], a[48:51], v[144:147], v[32:35]
    v_permlane16_swap_b32 v180, v182
    v_permlane16_swap_b32 v181, v183
    v_mfma_f32_16x16x32_bf16 v[36:39], a[52:55], v[144:147], v[36:39]
    ds_read_b128 v[112:115], v222 offset:2304
    buffer_store_dwordx4 v[180:183], v220, s[4:7], s61 offen sc1
    s_add_u32 s61, s61, 655360
    v_mfma_f32_16x16x32_bf16 v[40:43], a[56:59], v[144:147], v[40:43]
    ds_read_b128 v[116:119], v222 offset:2816
    ds_read_b64 v[168:169], v221 offset:8192
    v_mfma_f32_16x16x32_bf16 v[44:47], a[60:63], v[144:147], v[44:47]
    ds_read_b128 v[120:123], v222 offset:3328
    ds_read_b64 v[170:171], v221 offset:10240
    v_mfma_f32_16x16x32_bf16 v[36:39], a[48:51], v[148:151], v[36:39]
    ds_read_b128 v[124:127], v222 offset:3840
    ds_read_b64 v[172:173], v221 offset:12288
    v_mfma_f32_16x16x32_bf16 v[40:43], a[52:55], v[148:151], v[40:43]
    ds_read_b64 v[174:175], v221 offset:14336
    v_mfma_f32_16x16x32_bf16 v[44:47], a[56:59], v[148:151], v[44:47]
    v_mfma_f32_16x16x32_bf16 v[40:43], a[48:51], v[152:155], v[40:43]
    v_mfma_f32_16x16x32_bf16 v[44:47], a[52:55], v[152:155], v[44:47]
    v_mfma_f32_16x16x32_bf16 v[44:47], a[48:51], v[156:159], v[44:47]
    s_waitcnt lgkmcnt(2)
    v_mfma_f32_16x16x32_bf16 v[32:35], a[64:67], v[112:115], v[32:35]
    v_mfma_f32_16x16x32_bf16 v[36:39], a[68:71], v[112:115], v[36:39]
    ds_read_b128 v[144:147], v222 offset:2368
    v_mfma_f32_16x16x32_bf16 v[40:43], a[72:75], v[112:115], v[40:43]
    ds_read_b128 v[148:151], v222 offset:2880
    v_mfma_f32_16x16x32_bf16 v[44:47], a[76:79], v[112:115], v[44:47]
    ds_read_b128 v[152:155], v222 offset:3392
    v_mfma_f32_16x16x32_bf16 v[36:39], a[64:67], v[116:119], v[36:39]
    ds_read_b128 v[156:159], v222 offset:3904
    v_mfma_f32_16x16x32_bf16 v[40:43], a[68:71], v[116:119], v[40:43]
    v_mfma_f32_16x16x32_bf16 v[44:47], a[72:75], v[116:119], v[44:47]
    v_mfma_f32_16x16x32_bf16 v[40:43], a[64:67], v[120:123], v[40:43]
    v_mfma_f32_16x16x32_bf16 v[44:47], a[68:71], v[120:123], v[44:47]
    v_mfma_f32_16x16x32_bf16 v[44:47], a[64:67], v[124:127], v[44:47]
    s_waitcnt lgkmcnt(0)
    v_mfma_f32_16x16x32_bf16 v[32:35], a[80:83], v[144:147], v[32:35]
    v_mfma_f32_16x16x32_bf16 v[36:39], a[84:87], v[144:147], v[36:39]
    ds_read_b128 v[112:115], v222 offset:2432
    v_mfma_f32_16x16x32_bf16 v[40:43], a[88:91], v[144:147], v[40:43]
    ds_read_b128 v[116:119], v222 offset:2944
    v_mfma_f32_16x16x32_bf16 v[44:47], a[92:95], v[144:147], v[44:47]
    ds_read_b128 v[120:123], v222 offset:3456
    v_mfma_f32_16x16x32_bf16 v[36:39], a[80:83], v[148:151], v[36:39]
    ds_read_b128 v[124:127], v222 offset:3968
    v_mfma_f32_16x16x32_bf16 v[40:43], a[84:87], v[148:151], v[40:43]
    v_mfma_f32_16x16x32_bf16 v[44:47], a[88:91], v[148:151], v[44:47]
    v_mfma_f32_16x16x32_bf16 v[40:43], a[80:83], v[152:155], v[40:43]
    v_mfma_f32_16x16x32_bf16 v[44:47], a[84:87], v[152:155], v[44:47]
    v_mfma_f32_16x16x32_bf16 v[44:47], a[80:83], v[156:159], v[44:47]
    s_waitcnt lgkmcnt(0)
    v_mfma_f32_16x16x32_bf16 v[32:35], a[96:99], v[112:115], v[32:35]
    v_mfma_f32_16x16x32_bf16 v[36:39], a[100:103], v[112:115], v[36:39]
    ds_read_b128 v[144:147], v222 offset:2496
    v_mfma_f32_16x16x32_bf16 v[40:43], a[104:107], v[112:115], v[40:43]
    ds_read_b128 v[148:151], v222 offset:3008
    v_mfma_f32_16x16x32_bf16 v[44:47], a[108:111], v[112:115], v[44:47]
    ds_read_b128 v[152:155], v222 offset:3520
    v_mfma_f32_16x16x32_bf16 v[36:39], a[96:99], v[116:119], v[36:39]
    ds_read_b128 v[156:159], v222 offset:4032
    v_mfma_f32_16x16x32_bf16 v[40:43], a[100:103], v[116:119], v[40:43]
    v_mfma_f32_16x16x32_bf16 v[44:47], a[104:107], v[116:119], v[44:47]
    v_mfma_f32_16x16x32_bf16 v[40:43], a[96:99], v[120:123], v[40:43]
    v_mfma_f32_16x16x32_bf16 v[44:47], a[100:103], v[120:123], v[44:47]
    v_mfma_f32_16x16x32_bf16 v[44:47], a[96:99], v[124:127], v[44:47]
    s_waitcnt lgkmcnt(0)
    v_mfma_f32_16x16x32_bf16 v[32:35], a[112:115], v[144:147], v[32:35]
    v_mfma_f32_16x16x32_bf16 v[36:39], a[116:119], v[144:147], v[36:39]
    v_mfma_f32_16x16x32_bf16 v[40:43], a[120:123], v[144:147], v[40:43]
    v_mfma_f32_16x16x32_bf16 v[44:47], a[124:127], v[144:147], v[44:47]
    v_mfma_f32_16x16x32_bf16 v[36:39], a[112:115], v[148:151], v[36:39]
    v_mfma_f32_16x16x32_bf16 v[40:43], a[116:119], v[148:151], v[40:43]
    v_mfma_f32_16x16x32_bf16 v[44:47], a[120:123], v[148:151], v[44:47]
    v_mfma_f32_16x16x32_bf16 v[40:43], a[112:115], v[152:155], v[40:43]
    v_mfma_f32_16x16x32_bf16 v[44:47], a[116:119], v[152:155], v[44:47]
    v_mfma_f32_16x16x32_bf16 v[44:47], a[112:115], v[156:159], v[44:47]
    v_lshlrev_b32 v200, 16, v168
    v_and_b32 v201, 0xffff0000, v168
    v_add_f32 v200, v200, v32
    v_add_f32 v201, v201, v33
    v_cvt_pk_bf16_f32 v184, v200, v201
    v_lshlrev_b32 v202, 16, v169
    v_and_b32 v203, 0xffff0000, v169
    v_add_f32 v202, v202, v34
    v_add_f32 v203, v203, v35
    v_cvt_pk_bf16_f32 v185, v202, v203
    v_lshlrev_b32 v200, 16, v170
    v_and_b32 v201, 0xffff0000, v170
    v_add_f32 v200, v200, v36
    v_add_f32 v201, v201, v37
    v_cvt_pk_bf16_f32 v186, v200, v201
    v_lshlrev_b32 v202, 16, v171
    v_and_b32 v203, 0xffff0000, v171
    v_add_f32 v202, v202, v38
    v_add_f32 v203, v203, v39
    v_cvt_pk_bf16_f32 v187, v202, v203
    v_permlane16_swap_b32 v184, v186
    s_nop 0
    v_permlane16_swap_b32 v185, v187
    buffer_store_dwordx4 v[184:187], v220, s[4:7], s61 offen sc1
    s_add_u32 s61, s61, 655360
    v_lshlrev_b32 v200, 16, v172
    v_and_b32 v201, 0xffff0000, v172
    v_add_f32 v200, v200, v40
    v_add_f32 v201, v201, v41
    v_cvt_pk_bf16_f32 v188, v200, v201
    v_lshlrev_b32 v202, 16, v173
    v_and_b32 v203, 0xffff0000, v173
    v_add_f32 v202, v202, v42
    v_add_f32 v203, v203, v43
    v_cvt_pk_bf16_f32 v189, v202, v203
    v_lshlrev_b32 v200, 16, v174
    v_and_b32 v201, 0xffff0000, v174
    v_add_f32 v200, v200, v44
    v_add_f32 v201, v201, v45
    v_cvt_pk_bf16_f32 v190, v200, v201
    v_lshlrev_b32 v202, 16, v175
    v_and_b32 v203, 0xffff0000, v175
    v_add_f32 v202, v202, v46
    v_add_f32 v203, v203, v47
    v_cvt_pk_bf16_f32 v191, v202, v203
    v_permlane16_swap_b32 v188, v190
    s_nop 0
    v_permlane16_swap_b32 v189, v191
    buffer_store_dwordx4 v[188:191], v220, s[4:7], s61 offen sc1
    s_add_u32 s61, s61, 655360
    s_waitcnt vmcnt(0)
    v_mov_b32 v2, 25352
    v_mov_b32 v3, 1
    s_mov_b64 exec, 1
    ds_add_rtn_u32 v3, v2, v3
    s_mov_b64 exec, -1
    s_waitcnt lgkmcnt(0)
    v_readfirstlane_b32 s57, v3
    s_nop 0
    s_add_u32 s57, s57, 1
    s_cmp_lg_u32 s57, s49
    s_cbranch_scc1 c_nosig
    s_and_b32 s56, s2, 15
    s_lshl_b32 s56, s56, 7
    s_add_u32 s56, s56, 16384
    v_mov_b32 v2, 1
    v_mov_b32 v3, 0
    s_mov_b64 exec, 1
    buffer_atomic_add v2, v3, s[4:7], s56 offen sc1
    s_mov_b64 exec, -1
c_nosig:
    v_mov_b32 v2, 25360
    s_mov_b32 s57, 0
lw_11:
    ds_read_b32 v3, v2
    s_add_u32 s57, s57, 1
    s_cmp_ge_u32 s57, 2000000
    s_waitcnt lgkmcnt(0)
    s_cbranch_scc1 lwd_12
    v_cmp_gt_u32 vcc, 1, v3
    s_cbranch_vccnz lw_11
lwd_12:
    s_cmp_eq_u32 s3, 1
    s_cbranch_scc1 c_aug
    s_mul_i32 s57, s3, 6
    s_mul_i32 s23, s55, 56
    s_add_u32 s23, s23, s57
    s_mul_i32 s23, s23, 5120
    s_add_u32 s23, s23, 10878976
    s_add_u32 s59, s23, 0
    buffer_load_dwordx4 a[160:163], v4, s[4:7], s59 offen offset:0 sc1
    buffer_load_dwordx4 a[164:167], v4, s[4:7], s59 offen offset:1024 sc1
    buffer_load_dwordx4 a[168:171], v4, s[4:7], s59 offen offset:2048 sc1
    buffer_load_dwordx4 a[172:175], v4, s[4:7], s59 offen offset:3072 sc1
    s_add_u32 s59, s23, 4096
    buffer_load_dwordx4 a[176:179], v4, s[4:7], s59 offen offset:0 sc1
    buffer_load_dwordx4 a[180:183], v4, s[4:7], s59 offen offset:1024 sc1
    buffer_load_dwordx4 a[184:187], v4, s[4:7], s59 offen offset:2048 sc1
    buffer_load_dwordx4 a[188:191], v4, s[4:7], s59 offen offset:3072 sc1
    s_add_u32 s59, s23, 8192
    buffer_load_dwordx4 a[192:195], v4, s[4:7], s59 offen offset:0 sc1
    buffer_load_dwordx4 a[196:199], v4, s[4:7], s59 offen offset:1024 sc1
    buffer_load_dwordx4 a[200:203], v4, s[4:7], s59 offen offset:2048 sc1
    buffer_load_dwordx4 a[204:207], v4, s[4:7], s59 offen offset:3072 sc1
    s_add_u32 s59, s23, 12288
    buffer_load_dwordx4 a[208:211], v4, s[4:7], s59 offen offset:0 sc1
    buffer_load_dwordx4 a[212:215], v4, s[4:7], s59 offen offset:1024 sc1
    buffer_load_dwordx4 a[216:219], v4, s[4:7], s59 offen offset:2048 sc1
    buffer_load_dwordx4 a[220:223], v4, s[4:7], s59 offen offset:3072 sc1
    s_add_u32 s59, s23, 16384
    buffer_load_dwordx4 a[224:227], v4, s[4:7], s59 offen offset:0 sc1
    buffer_load_dwordx4 a[228:231], v4, s[4:7], s59 offen offset:1024 sc1
    buffer_load_dwordx4 a[232:235], v4, s[4:7], s59 offen offset:2048 sc1
    buffer_load_dwordx4 a[236:239], v4, s[4:7], s59 offen offset:3072 sc1
    s_add_u32 s59, s23, 20480
    buffer_load_dwordx4 a[240:243], v4, s[4:7], s59 offen offset:0 sc1
    buffer_load_dwordx4 a[244:247], v4, s[4:7], s59 offen offset:1024 sc1
    buffer_load_dwordx4 a[248:251], v4, s[4:7], s59 offen offset:2048 sc1
    buffer_load_dwordx4 a[252:255], v4, s[4:7], s59 offen offset:3072 sc1
    s_add_u32 s59, s23, 24576
    buffer_load_dwordx4 v[224:227], v4, s[4:7], s59 offen offset:0 sc1
    buffer_load_dwordx4 v[228:231], v4, s[4:7], s59 offen offset:1024 sc1
    buffer_load_dwordx4 v[232:235], v4, s[4:7], s59 offen offset:2048 sc1
    buffer_load_dwordx4 v[236:239], v4, s[4:7], s59 offen offset:3072 sc1
    s_add_u32 s59, s23, 28672
    buffer_load_dwordx4 v[240:243], v4, s[4:7], s59 offen offset:0 sc1
    buffer_load_dwordx4 v[244:247], v4, s[4:7], s59 offen offset:1024 sc1
    s_branch sync2
c_aug:
    v_and_b32 v9, 31, v1
    v_lshrrev_b32 v10, 4, v9
    v_bfe_u32 v11, v9, 3, 1
    v_bfe_u32 v12, v9, 2, 1
    v_and_b32 v13, 3, v9
    v_lshl_add_u32 v13, v11, 2, v13
    v_lshl_add_u32 v13, v12, 3, v13
    v_lshrrev_b32 v14, 5, v1
    v_lshl_add_u32 v13, v14, 4, v13
    s_mul_i32 s56, s53, 108
    v_mul_u32_u24 v10, 1728, v10
    v_add3_u32 v10, v10, v13, s56
    v_lshlrev_b32 v10, 3, v10
    s_mov_b32 s58, 98304
    buffer_load_dwordx2 v[16:17], v10, s[4:7], s58 offen offset:0 sc1
    buffer_load_dwordx2 v[26:27], v10, s[4:7], s58 offen offset:256 sc1
    buffer_load_dwordx2 v[36:37], v10, s[4:7], s58 offen offset:512 sc1
    buffer_load_dwordx2 v[46:47], v10, s[4:7], s58 offen offset:768 sc1
    s_add_u32 s58, s58, 27648
    buffer_load_dwordx2 v[18:19], v10, s[4:7], s58 offen offset:0 sc1
    buffer_load_dwordx2 v[28:29], v10, s[4:7], s58 offen offset:256 sc1
    buffer_load_dwordx2 v[38:39], v10, s[4:7], s58 offen offset:512 sc1
    buffer_load_dwordx2 v[48:49], v10, s[4:7], s58 offen offset:768 sc1
    s_add_u32 s58, s58, 27648
    buffer_load_dwordx2 v[20:21], v10, s[4:7], s58 offen offset:0 sc1
    buffer_load_dwordx2 v[30:31], v10, s[4:7], s58 offen offset:256 sc1
    buffer_load_dwordx2 v[40:41], v10, s[4:7], s58 offen offset:512 sc1
    buffer_load_dwordx2 v[50:51], v10, s[4:7], s58 offen offset:768 sc1
    s_add_u32 s58, s58, 27648
    buffer_load_dwordx2 v[22:23], v10, s[4:7], s58 offen offset:0 sc1
    buffer_load_dwordx2 v[32:33], v10, s[4:7], s58 offen offset:256 sc1
    buffer_load_dwordx2 v[42:43], v10, s[4:7], s58 offen offset:512 sc1
    buffer_load_dwordx2 v[52:53], v10, s[4:7], s58 offen offset:768 sc1
    s_add_u32 s58, s58, 27648
    buffer_load_dwordx2 v[24:25], v10, s[4:7], s58 offen offset:0 sc1
    buffer_load_dwordx2 v[34:35], v10, s[4:7], s58 offen offset:256 sc1
    buffer_load_dwordx2 v[44:45], v10, s[4:7], s58 offen offset:512 sc1
    buffer_load_dwordx2 v[54:55], v10, s[4:7], s58 offen offset:768 sc1
    s_add_u32 s58, s58, 27648
    s_mul_i32 s56, s55, 320
    s_add_u32 s58, s56, 45568
    v_min_u32 v11, 39, v1
    v_lshlrev_b32 v11, 3, v11
    buffer_load_dwordx2 v[60:61], v11, s[4:7], s58 offen sc1
    s_add_u32 s58, s58, 15360
    buffer_load_dwordx2 v[62:63], v11, s[4:7], s58 offen sc1
    s_add_u32 s58, s58, 15360
    buffer_load_dwordx2 v[64:65], v11, s[4:7], s58 offen sc1
    s_add_u32 s58, s58, 15360
    buffer_load_dwordx2 v[66:67], v11, s[4:7], s58 offen sc1
    s_add_u32 s58, s58, 15360
    s_mul_i32 s57, s3, 6
    s_mul_i32 s23, s55, 56
    s_add_u32 s23, s23, s57
    s_mul_i32 s23, s23, 5120
    s_add_u32 s23, s23, 10878976
    s_add_u32 s59, s23, 0
    buffer_load_dwordx4 a[160:163], v4, s[4:7], s59 offen offset:0 sc1
    buffer_load_dwordx4 a[164:167], v4, s[4:7], s59 offen offset:1024 sc1
    buffer_load_dwordx4 a[168:171], v4, s[4:7], s59 offen offset:2048 sc1
    buffer_load_dwordx4 a[172:175], v4, s[4:7], s59 offen offset:3072 sc1
    s_add_u32 s59, s23, 4096
    buffer_load_dwordx4 a[176:179], v4, s[4:7], s59 offen offset:0 sc1
    buffer_load_dwordx4 a[180:183], v4, s[4:7], s59 offen offset:1024 sc1
    buffer_load_dwordx4 a[184:187], v4, s[4:7], s59 offen offset:2048 sc1
    buffer_load_dwordx4 a[188:191], v4, s[4:7], s59 offen offset:3072 sc1
    s_add_u32 s59, s23, 8192
    buffer_load_dwordx4 a[192:195], v4, s[4:7], s59 offen offset:0 sc1
    buffer_load_dwordx4 a[196:199], v4, s[4:7], s59 offen offset:1024 sc1
    buffer_load_dwordx4 a[200:203], v4, s[4:7], s59 offen offset:2048 sc1
    buffer_load_dwordx4 a[204:207], v4, s[4:7], s59 offen offset:3072 sc1
    s_add_u32 s59, s23, 12288
    buffer_load_dwordx4 a[208:211], v4, s[4:7], s59 offen offset:0 sc1
    buffer_load_dwordx4 a[212:215], v4, s[4:7], s59 offen offset:1024 sc1
    buffer_load_dwordx4 a[216:219], v4, s[4:7], s59 offen offset:2048 sc1
    buffer_load_dwordx4 a[220:223], v4, s[4:7], s59 offen offset:3072 sc1
    s_add_u32 s59, s23, 16384
    buffer_load_dwordx4 a[224:227], v4, s[4:7], s59 offen offset:0 sc1
    buffer_load_dwordx4 a[228:231], v4, s[4:7], s59 offen offset:1024 sc1
    buffer_load_dwordx4 a[232:235], v4, s[4:7], s59 offen offset:2048 sc1
    buffer_load_dwordx4 a[236:239], v4, s[4:7], s59 offen offset:3072 sc1
    s_add_u32 s59, s23, 20480
    buffer_load_dwordx4 a[240:243], v4, s[4:7], s59 offen offset:0 sc1
    buffer_load_dwordx4 a[244:247], v4, s[4:7], s59 offen offset:1024 sc1
    buffer_load_dwordx4 a[248:251], v4, s[4:7], s59 offen offset:2048 sc1
    buffer_load_dwordx4 a[252:255], v4, s[4:7], s59 offen offset:3072 sc1
    s_add_u32 s59, s23, 24576
    buffer_load_dwordx4 v[224:227], v4, s[4:7], s59 offen offset:0 sc1
    buffer_load_dwordx4 v[228:231], v4, s[4:7], s59 offen offset:1024 sc1
    buffer_load_dwordx4 v[232:235], v4, s[4:7], s59 offen offset:2048 sc1
    buffer_load_dwordx4 v[236:239], v4, s[4:7], s59 offen offset:3072 sc1
    s_add_u32 s59, s23, 28672
    buffer_load_dwordx4 v[240:243], v4, s[4:7], s59 offen offset:0 sc1
    buffer_load_dwordx4 v[244:247], v4, s[4:7], s59 offen offset:1024 sc1
    s_waitcnt vmcnt(30)
    v_mov_b32 v74, 0
    v_mov_b32 v75, 0
    v_lshlrev_b32 v12, 4, v1
    v_add_u32 v12, 71680, v12
    v_pk_add_f32 v[16:17], v[16:17], v[18:19]
    v_pk_add_f32 v[20:21], v[20:21], v[22:23]
    v_pk_add_f32 v[16:17], v[16:17], v[24:25]
    v_pk_add_f32 v[16:17], v[16:17], v[20:21]
    v_cvt_pk_bf16_f32 v70, v16, v17
    v_lshlrev_b32 v76, 16, v70
    v_and_b32 v77, 0xffff0000, v70
    v_sub_f32 v76, v16, v76
    v_sub_f32 v77, v17, v77
    v_cvt_pk_bf16_f32 v71, v76, v77
    v_lshrrev_b32 v72, 16, v70
    v_and_b32 v76, 0xffff0000, v71
    v_or_b32 v72, v72, v76
    v_and_b32 v73, 0xffff, v70
    v_lshl_or_b32 v73, v71, 16, v73
    ds_write_b128 v12, v[72:75] offset:0
    s_waitcnt lgkmcnt(0)
    v_pk_add_f32 v[26:27], v[26:27], v[28:29]
    v_pk_add_f32 v[30:31], v[30:31], v[32:33]
    v_pk_add_f32 v[26:27], v[26:27], v[34:35]
    v_pk_add_f32 v[26:27], v[26:27], v[30:31]
    v_cvt_pk_bf16_f32 v70, v26, v27
    v_lshlrev_b32 v76, 16, v70
    v_and_b32 v77, 0xffff0000, v70
    v_sub_f32 v76, v26, v76
    v_sub_f32 v77, v27, v77
    v_cvt_pk_bf16_f32 v71, v76, v77
    v_lshrrev_b32 v72, 16, v70
    v_and_b32 v76, 0xffff0000, v71
    v_or_b32 v72, v72, v76
    v_and_b32 v73, 0xffff, v70
    v_lshl_or_b32 v73, v71, 16, v73
    ds_write_b128 v12, v[72:75] offset:1024
    s_waitcnt lgkmcnt(0)
    v_pk_add_f32 v[36:37], v[36:37], v[38:39]
    v_pk_add_f32 v[40:41], v[40:41], v[42:43]
    v_pk_add_f32 v[36:37], v[36:37], v[44:45]
    v_pk_add_f32 v[36:37], v[36:37], v[40:41]
    v_cvt_pk_bf16_f32 v70, v36, v37
    v_lshlrev_b32 v76, 16, v70
    v_and_b32 v77, 0xffff0000, v70
    v_sub_f32 v76, v36, v76
    v_sub_f32 v77, v37, v77
    v_cvt_pk_bf16_f32 v71, v76, v77
    v_lshrrev_b32 v72, 16, v70
    v_and_b32 v76, 0xffff0000, v71
    v_or_b32 v72, v72, v76
    v_and_b32 v73, 0xffff, v70
    v_lshl_or_b32 v73, v71, 16, v73
    ds_write_b128 v12, v[72:75] offset:2048
    s_waitcnt lgkmcnt(0)
    v_pk_add_f32 v[46:47], v[46:47], v[48:49]
    v_pk_add_f32 v[50:51], v[50:51], v[52:53]
    v_pk_add_f32 v[46:47], v[46:47], v[54:55]
    v_pk_add_f32 v[46:47], v[46:47], v[50:51]
    v_cvt_pk_bf16_f32 v70, v46, v47
    v_lshlrev_b32 v76, 16, v70
    v_and_b32 v77, 0xffff0000, v70
    v_sub_f32 v76, v46, v76
    v_sub_f32 v77, v47, v77
    v_cvt_pk_bf16_f32 v71, v76, v77
    v_lshrrev_b32 v72, 16, v70
    v_and_b32 v76, 0xffff0000, v71
    v_or_b32 v72, v72, v76
    v_and_b32 v73, 0xffff, v70
    v_lshl_or_b32 v73, v71, 16, v73
    v_cmp_gt_u32 vcc, 12, v13
    s_nop 1
    v_cndmask_b32 v72, 0, v72, vcc
    v_cndmask_b32 v73, 0, v73, vcc
    s_mov_b32 exec_hi, 0
    ds_write_b128 v12, v[72:75] offset:3072
    s_waitcnt lgkmcnt(0)
    s_mov_b64 exec, -1
    v_pk_add_f32 v[60:61], v[60:61], v[62:63]
    v_pk_add_f32 v[64:65], v[64:65], v[66:67]
    v_pk_add_f32 v[60:61], v[60:61], v[64:65]
    v_cvt_pk_bf16_f32 v60, v60, v61
    v_and_b32 v61, 0xffff0000, v60
    v_lshlrev_b32 v60, 16, v60
    v_add_u32 v11, 75776, v11
    ds_write_b64 v11, v[60:61]
    s_waitcnt lgkmcnt(0)
    s_branch sync2
helper:
    v_and_b32 v6, 15, v1
    v_lshrrev_b32 v7, 4, v1
    v_lshlrev_b32 v8, 3, v7
    v_sub_u32 v8, v6, v8
    v_mov_b32 v9, 0x3f80
    v_mov_b32 v10, 0x3f800000
    v_and_b32 v14, 7, v1
    v_lshrrev_b32 v15, 3, v1
    s_cmp_ge_u32 s51, 270
    s_cbranch_scc1 h_down
    s_cmp_ge_u32 s51, 135
    s_cselect_b32 s61, 1, 0
    s_cselect_b32 s8, s34, s32
    s_cselect_b32 s9, s35, s33
    s_mov_b32 s10, 2211840
    s_mov_b32 s11, 0x20000
    s_mul_i32 s57, s61, 135
    s_sub_u32 s57, s51, s57
    s_mul_hi_u32 s58, s57, 0x33333334
    s_mul_i32 s59, s58, 5
    s_sub_u32 s59, s57, s59
    s_mul_i32 s60, s59, 442368
    s_lshl_b32 s62, s58, 7
    s_add_u32 s60, s60, s62
    v_lshrrev_b32 v11, 2, v14
    v_lshlrev_b32 v11, 2, v11
    v_add_u32 v11, v11, v14
    v_mul_u32_u24 v11, 3456, v11
    v_lshl_add_u32 v11, v15, 4, v11
    buffer_load_dwordx4 v[16:19], v11, s[8:11], s60 offen nt
    s_add_u32 s60, s60, 13824
    buffer_load_dwordx4 v[20:23], v11, s[8:11], s60 offen nt
    s_add_u32 s60, s60, 41472
    buffer_load_dwordx4 v[24:27], v11, s[8:11], s60 offen nt
    s_add_u32 s60, s60, 13824
    buffer_load_dwordx4 v[28:31], v11, s[8:11], s60 offen nt
    s_add_u32 s60, s60, 41472
    buffer_load_dwordx4 v[32:35], v11, s[8:11], s60 offen nt
    s_add_u32 s60, s60, 13824
    buffer_load_dwordx4 v[36:39], v11, s[8:11], s60 offen nt
    s_add_u32 s60, s60, 41472
    buffer_load_dwordx4 v[40:43], v11, s[8:11], s60 offen nt
    s_add_u32 s60, s60, 13824
    buffer_load_dwordx4 v[44:47], v11, s[8:11], s60 offen nt
    s_add_u32 s60, s60, 41472
    buffer_load_dwordx4 v[48:51], v11, s[8:11], s60 offen nt
    s_add_u32 s60, s60, 13824
    buffer_load_dwordx4 v[52:55], v11, s[8:11], s60 offen nt
    s_add_u32 s60, s60, 41472
    buffer_load_dwordx4 v[56:59], v11, s[8:11], s60 offen nt
    s_add_u32 s60, s60, 13824
    buffer_load_dwordx4 v[60:63], v11, s[8:11], s60 offen nt
    s_add_u32 s60, s60, 41472
    buffer_load_dwordx4 v[64:67], v11, s[8:11], s60 offen nt
    s_add_u32 s60, s60, 13824
    buffer_load_dwordx4 v[68:71], v11, s[8:11], s60 offen nt
    s_add_u32 s60, s60, 41472
    buffer_load_dwordx4 v[72:75], v11, s[8:11], s60 offen nt
    s_add_u32 s60, s60, 13824
    buffer_load_dwordx4 v[76:79], v11, s[8:11], s60 offen nt
    s_waitcnt vmcnt(16)
    v_mov_b32 v2, 25344
    v_mov_b32 v3, 1
    s_mov_b64 exec, 1
    ds_add_u32 v2, v3
    s_mov_b64 exec, -1
    s_cmp_lg_u32 s3, 3
    s_cbranch_scc1 a_done_13
    s_mov_b32 s57, 0
    v_mov_b32 v3, 0
ipoll_14:
    v_cmp_eq_u32 vcc, 0, v253
    s_cbranch_vccz iok_15
    global_load_dword v253, v3, s[44:45] sc1
    s_add_u32 s57, s57, 1
    s_cmp_ge_u32 s57, 100000
    s_waitcnt vmcnt(0)
    s_cbranch_scc0 ipoll_14
iok_15:
    v_mov_b32 v2, 25344
    s_mov_b32 s57, 0
lw_16:
    ds_read_b32 v3, v2
    s_add_u32 s57, s57, 1
    s_cmp_ge_u32 s57, 2000000
    s_waitcnt lgkmcnt(0)
    s_cbranch_scc1 lwd_17
    v_cmp_gt_u32 vcc, 4, v3
    s_cbranch_vccnz lw_16
lwd_17:
    s_and_b32 s56, s2, 15
    s_lshl_b32 s56, s56, 7
    s_add_u32 s56, s56, 0
    v_mov_b32 v2, 1
    v_mov_b32 v3, 0
    s_mov_b64 exec, 1
    buffer_atomic_add v2, v3, s[4:7], s56 offen sc1
    s_mov_b64 exec, -1
a_done_13:
    v_cmp_eq_u32 vcc, 0, v8
    s_nop 1
    v_cndmask_b32 v224, 0, v9, vcc
    v_cmp_eq_u32 vcc, 1, v8
    s_nop 1
    v_cndmask_b32 v224, v224, v10, vcc
    v_cmp_eq_u32 vcc, 2, v8
    s_nop 1
    v_cndmask_b32 v225, 0, v9, vcc
    v_cmp_eq_u32 vcc, 3, v8
    s_nop 1
    v_cndmask_b32 v225, v225, v10, vcc
    v_cmp_eq_u32 vcc, 4, v8
    s_nop 1
    v_cndmask_b32 v226, 0, v9, vcc
    v_cmp_eq_u32 vcc, 5, v8
    s_nop 1
    v_cndmask_b32 v226, v226, v10, vcc
    v_cmp_eq_u32 vcc, 6, v8
    s_nop 1
    v_cndmask_b32 v227, 0, v9, vcc
    v_cmp_eq_u32 vcc, 7, v8
    s_nop 1
    v_cndmask_b32 v227, v227, v10, vcc
    v_cmp_eq_u32 vcc, -16, v8
    s_nop 1
    v_cndmask_b32 v228, 0, v9, vcc
    v_cmp_eq_u32 vcc, -15, v8
    s_nop 1
    v_cndmask_b32 v228, v228, v10, vcc
    v_cmp_eq_u32 vcc, -14, v8
    s_nop 1
    v_cndmask_b32 v229, 0, v9, vcc
    v_cmp_eq_u32 vcc, -13, v8
    s_nop 1
    v_cndmask_b32 v229, v229, v10, vcc
    v_cmp_eq_u32 vcc, -12, v8
    s_nop 1
    v_cndmask_b32 v230, 0, v9, vcc
    v_cmp_eq_u32 vcc, -11, v8
    s_nop 1
    v_cndmask_b32 v230, v230, v10, vcc
    v_cmp_eq_u32 vcc, -10, v8
    s_nop 1
    v_cndmask_b32 v231, 0, v9, vcc
    v_cmp_eq_u32 vcc, -9, v8
    s_nop 1
    v_cndmask_b32 v231, v231, v10, vcc
    v_lshrrev_b32 v9, 3, v6
    v_lshrrev_b32 v10, 1, v7
    v_cmp_eq_u32 vcc, v9, v10
    v_mov_b32 v236, 0x3f803f80
    s_nop 0
    v_cndmask_b32 v232, 0, v236, vcc
    v_cndmask_b32 v233, 0, v236, vcc
    v_cndmask_b32 v234, 0, v236, vcc
    v_cndmask_b32 v235, 0, v236, vcc
    v_mov_b32 v237, v236
    v_mov_b32 v238, v236
    v_mov_b32 v239, v236
    v_lshrrev_b32 v12, 3, v6
    v_lshlrev_b32 v12, 4, v12
    v_lshrrev_b32 v13, 1, v7
    v_lshl_add_u32 v12, v13, 3, v12
    v_and_b32 v13, 7, v6
    s_lshl_b32 s62, s58, 6
    v_add3_u32 v8, v12, v13, s62
    v_add_u32 v9, 0, v8
    v_mul_u32_u24 v10, 607, v9
    v_lshrrev_b32 v10, 16, v10
    v_mul_u32_u24 v2, 108, v10
    v_sub_u32 v2, v9, v2
    v_lshrrev_b32 v12, 4, v2
    v_bfe_u32 v13, v2, 2, 1
    v_lshlrev_b32 v13, 3, v13
    v_bfe_u32 v3, v2, 3, 1
    v_lshl_add_u32 v13, v3, 2, v13
    v_and_b32 v3, 3, v2
    s_lshl_b32 s62, s61, 4
    v_add3_u32 v13, v13, v3, s62
    v_and_b32 v3, 1, v7
    v_lshl_add_u32 v13, v3, 5, v13
    v_lshlrev_b32 v13, 4, v13
    s_mov_b32 s62, 286720
    v_mad_u32_u24 v13, v10, s62, v13
    v_add_u32 v3, 1, v12
    v_cmp_eq_u32 vcc, 6, v12
    s_nop 1
    v_cndmask_b32 v3, v3, 0, vcc
    s_mul_i32 s62, s59, 16
    v_add_u32 v9, s62, v3
    v_mul_u32_u24 v10, 40, v12
    s_lshl_b32 s62, s59, 3
    v_add3_u32 v10, v10, s62, 40
    v_cmp_gt_u32 vcc, 2, v3
    s_nop 1
    v_cndmask_b32 v9, v10, v9, vcc
    v_lshl_add_u32 v240, v9, 10, v13
    v_mov_b32 v10, 1024
    v_mov_b32 v2, 2048
    v_cndmask_b32 v242, v10, v2, vcc
    v_add_u32 v9, 32, v8
    v_mul_u32_u24 v10, 607, v9
    v_lshrrev_b32 v10, 16, v10
    v_mul_u32_u24 v2, 108, v10
    v_sub_u32 v2, v9, v2
    v_lshrrev_b32 v12, 4, v2
    v_bfe_u32 v13, v2, 2, 1
    v_lshlrev_b32 v13, 3, v13
    v_bfe_u32 v3, v2, 3, 1
    v_lshl_add_u32 v13, v3, 2, v13
    v_and_b32 v3, 3, v2
    s_lshl_b32 s62, s61, 4
    v_add3_u32 v13, v13, v3, s62
    v_and_b32 v3, 1, v7
    v_lshl_add_u32 v13, v3, 5, v13
    v_lshlrev_b32 v13, 4, v13
    s_mov_b32 s62, 286720
    v_mad_u32_u24 v13, v10, s62, v13
    v_add_u32 v3, 1, v12
    v_cmp_eq_u32 vcc, 6, v12
    s_nop 1
    v_cndmask_b32 v3, v3, 0, vcc
    s_mul_i32 s62, s59, 16
    v_add_u32 v9, s62, v3
    v_mul_u32_u24 v10, 40, v12
    s_lshl_b32 s62, s59, 3
    v_add3_u32 v10, v10, s62, 40
    v_cmp_gt_u32 vcc, 2, v3
    s_nop 1
    v_cndmask_b32 v9, v10, v9, vcc
    v_lshl_add_u32 v241, v9, 10, v13
    v_mov_b32 v10, 1024
    v_mov_b32 v2, 2048
    v_cndmask_b32 v243, v10, v2, vcc
    v_and_b32 v3, 1, v7
    v_lshl_add_u32 v12, v3, 5, v8
    v_lshlrev_b32 v12, 3, v12
    s_mul_i32 s50, s59, 27648
    s_mul_i32 s62, s61, 13824
    s_add_u32 s50, s50, s62
    s_add_u32 s50, s50, 98304
    s_lshl_b32 s62, s59, 9
    v_lshl_add_u32 v8, v1, 3, s62
    s_sub_u32 s61, s3, 2
    s_lshl_b32 s61, s61, 10
    s_add_u32 s61, s61, 69632
    v_lshl_add_u32 v9, v1, 3, s61
    v_lshl_add_u32 v10, v3, 5, s61
    s_mov_b32 s62, 40448
    s_barrier
    buffer_load_dwordx2 v[208:209], v8, s[4:7], s62 offen offset:0 sc1
    s_add_u32 s62, s62, 15360
    buffer_load_dwordx2 v[210:211], v8, s[4:7], s62 offen offset:0 sc1
    s_add_u32 s62, s62, 15360
    buffer_load_dwordx2 v[212:213], v8, s[4:7], s62 offen offset:0 sc1
    s_add_u32 s62, s62, 15360
    buffer_load_dwordx2 v[214:215], v8, s[4:7], s62 offen offset:0 sc1
    s_add_u32 s62, s62, 15360
    s_sub_u32 s62, s62, 61440
    buffer_load_dwordx2 v[216:217], v8, s[4:7], s62 offen offset:2560 sc1
    s_add_u32 s62, s62, 15360
    buffer_load_dwordx2 v[218:219], v8, s[4:7], s62 offen offset:2560 sc1
    s_add_u32 s62, s62, 15360
    buffer_load_dwordx2 v[220:221], v8, s[4:7], s62 offen offset:2560 sc1
    s_add_u32 s62, s62, 15360
    buffer_load_dwordx2 v[222:223], v8, s[4:7], s62 offen offset:2560 sc1
    s_add_u32 s62, s62, 15360
    s_sub_u32 s62, s62, 61440
    s_mov_b32 s62, 6291456
    s_waitcnt vmcnt(8)
    v_mfma_f32_16x16x32_bf16 v[80:83], v[16:19], v[224:227], 0
    v_mfma_f32_16x16x32_bf16 v[88:91], v[16:19], v[228:231], 0
    v_mfma_f32_16x16x32_bf16 v[84:87], v[20:23], v[224:227], 0
    v_mfma_f32_16x16x32_bf16 v[92:95], v[20:23], v[228:231], 0
    v_mfma_f32_16x16x32_bf16 v[96:99], v[24:27], v[224:227], 0
    v_mfma_f32_16x16x32_bf16 v[104:107], v[24:27], v[228:231], 0
    v_mfma_f32_16x16x32_bf16 v[100:103], v[28:31], v[224:227], 0
    v_mfma_f32_16x16x32_bf16 v[108:111], v[28:31], v[228:231], 0
    v_mfma_f32_16x16x32_bf16 v[112:115], v[32:35], v[224:227], 0
    v_mfma_f32_16x16x32_bf16 v[120:123], v[32:35], v[228:231], 0
    v_mfma_f32_16x16x32_bf16 v[116:119], v[36:39], v[224:227], 0
    v_mfma_f32_16x16x32_bf16 v[124:127], v[36:39], v[228:231], 0
    v_mfma_f32_16x16x32_bf16 v[128:131], v[40:43], v[224:227], 0
    v_mfma_f32_16x16x32_bf16 v[136:139], v[40:43], v[228:231], 0
    v_mfma_f32_16x16x32_bf16 v[132:135], v[44:47], v[224:227], 0
    v_mfma_f32_16x16x32_bf16 v[140:143], v[44:47], v[228:231], 0
    v_mfma_f32_16x16x32_bf16 v[144:147], v[48:51], v[224:227], 0
    v_mfma_f32_16x16x32_bf16 v[152:155], v[48:51], v[228:231], 0
    v_mfma_f32_16x16x32_bf16 v[148:151], v[52:55], v[224:227], 0
    v_mfma_f32_16x16x32_bf16 v[156:159], v[52:55], v[228:231], 0
    v_mfma_f32_16x16x32_bf16 v[160:163], v[56:59], v[224:227], 0
    v_mfma_f32_16x16x32_bf16 v[168:171], v[56:59], v[228:231], 0
    v_mfma_f32_16x16x32_bf16 v[164:167], v[60:63], v[224:227], 0
    v_mfma_f32_16x16x32_bf16 v[172:175], v[60:63], v[228:231], 0
    v_mfma_f32_16x16x32_bf16 v[176:179], v[64:67], v[224:227], 0
    v_mfma_f32_16x16x32_bf16 v[184:187], v[64:67], v[228:231], 0
    v_mfma_f32_16x16x32_bf16 v[180:183], v[68:71], v[224:227], 0
    v_mfma_f32_16x16x32_bf16 v[188:191], v[68:71], v[228:231], 0
    v_mfma_f32_16x16x32_bf16 v[192:195], v[72:75], v[224:227], 0
    v_mfma_f32_16x16x32_bf16 v[200:203], v[72:75], v[228:231], 0
    v_mfma_f32_16x16x32_bf16 v[196:199], v[76:79], v[224:227], 0
    v_mfma_f32_16x16x32_bf16 v[204:207], v[76:79], v[228:231], 0
    s_waitcnt vmcnt(0)
    v_pk_add_f32 v[208:209], v[208:209], v[210:211]
    v_pk_add_f32 v[212:213], v[212:213], v[214:215]
    v_pk_add_f32 v[208:209], v[208:209], v[212:213]
    v_cvt_pk_bf16_f32 v208, v208, v209
    v_and_b32 v209, 0xffff0000, v208
    v_lshlrev_b32 v208, 16, v208
    v_pk_add_f32 v[216:217], v[216:217], v[218:219]
    v_pk_add_f32 v[220:221], v[220:221], v[222:223]
    v_pk_add_f32 v[216:217], v[216:217], v[220:221]
    v_cvt_pk_bf16_f32 v216, v216, v217
    v_and_b32 v217, 0xffff0000, v216
    v_lshlrev_b32 v216, 16, v216
    v_add_f32 v216, 1.0, v216
    v_add_f32 v217, 1.0, v217
    v_cvt_pk_bf16_f32 v216, v216, v217
    v_and_b32 v217, 0xffff0000, v216
    v_lshlrev_b32 v216, 16, v216
    ds_write_b64 v9, v[208:209]
    ds_write_b64 v9, v[216:217] offset:512
    s_waitcnt lgkmcnt(0)
    ds_read_b128 v[208:211], v10 offset:512
    ds_read_b128 v[212:215], v10 offset:528
    ds_read_b128 v[216:219], v10 offset:576
    ds_read_b128 v[220:223], v10 offset:592
    s_waitcnt lgkmcnt(2)
    v_pk_mul_f32 v[244:245], v[80:81], v[208:209]
    v_pk_mul_f32 v[246:247], v[82:83], v[210:211]
    v_pk_mul_f32 v[248:249], v[84:85], v[212:213]
    v_pk_mul_f32 v[250:251], v[86:87], v[214:215]
    v_cvt_pk_bf16_f32 v16, v244, v245
    v_cvt_pk_bf16_f32 v17, v246, v247
    v_cvt_pk_bf16_f32 v18, v248, v249
    v_cvt_pk_bf16_f32 v19, v250, v251
    buffer_store_dwordx4 v[16:19], v240, s[4:7], s62 offen sc1
    v_add_u32 v240, v240, v242
    v_pk_mul_f32 v[244:245], v[88:89], v[208:209]
    v_pk_mul_f32 v[246:247], v[90:91], v[210:211]
    v_pk_mul_f32 v[248:249], v[92:93], v[212:213]
    v_pk_mul_f32 v[250:251], v[94:95], v[214:215]
    v_cvt_pk_bf16_f32 v20, v244, v245
    v_cvt_pk_bf16_f32 v21, v246, v247
    v_cvt_pk_bf16_f32 v22, v248, v249
    v_cvt_pk_bf16_f32 v23, v250, v251
    buffer_store_dwordx4 v[20:23], v241, s[4:7], s62 offen sc1
    v_add_u32 v241, v241, v243
    ds_read_b128 v[208:211], v10 offset:640
    ds_read_b128 v[212:215], v10 offset:656
    s_waitcnt lgkmcnt(2)
    v_pk_mul_f32 v[244:245], v[96:97], v[216:217]
    v_pk_mul_f32 v[246:247], v[98:99], v[218:219]
    v_pk_mul_f32 v[248:249], v[100:101], v[220:221]
    v_pk_mul_f32 v[250:251], v[102:103], v[222:223]
    v_cvt_pk_bf16_f32 v24, v244, v245
    v_cvt_pk_bf16_f32 v25, v246, v247
    v_cvt_pk_bf16_f32 v26, v248, v249
    v_cvt_pk_bf16_f32 v27, v250, v251
    buffer_store_dwordx4 v[24:27], v240, s[4:7], s62 offen sc1
    v_add_u32 v240, v240, v242
    v_pk_mul_f32 v[244:245], v[104:105], v[216:217]
    v_pk_mul_f32 v[246:247], v[106:107], v[218:219]
    v_pk_mul_f32 v[248:249], v[108:109], v[220:221]
    v_pk_mul_f32 v[250:251], v[110:111], v[222:223]
    v_cvt_pk_bf16_f32 v28, v244, v245
    v_cvt_pk_bf16_f32 v29, v246, v247
    v_cvt_pk_bf16_f32 v30, v248, v249
    v_cvt_pk_bf16_f32 v31, v250, v251
    buffer_store_dwordx4 v[28:31], v241, s[4:7], s62 offen sc1
    v_add_u32 v241, v241, v243
    ds_read_b128 v[216:219], v10 offset:704
    ds_read_b128 v[220:223], v10 offset:720
    s_waitcnt lgkmcnt(2)
    v_pk_mul_f32 v[244:245], v[112:113], v[208:209]
    v_pk_mul_f32 v[246:247], v[114:115], v[210:211]
    v_pk_mul_f32 v[248:249], v[116:117], v[212:213]
    v_pk_mul_f32 v[250:251], v[118:119], v[214:215]
    v_cvt_pk_bf16_f32 v32, v244, v245
    v_cvt_pk_bf16_f32 v33, v246, v247
    v_cvt_pk_bf16_f32 v34, v248, v249
    v_cvt_pk_bf16_f32 v35, v250, v251
    buffer_store_dwordx4 v[32:35], v240, s[4:7], s62 offen sc1
    v_add_u32 v240, v240, v242
    v_pk_mul_f32 v[244:245], v[120:121], v[208:209]
    v_pk_mul_f32 v[246:247], v[122:123], v[210:211]
    v_pk_mul_f32 v[248:249], v[124:125], v[212:213]
    v_pk_mul_f32 v[250:251], v[126:127], v[214:215]
    v_cvt_pk_bf16_f32 v36, v244, v245
    v_cvt_pk_bf16_f32 v37, v246, v247
    v_cvt_pk_bf16_f32 v38, v248, v249
    v_cvt_pk_bf16_f32 v39, v250, v251
    buffer_store_dwordx4 v[36:39], v241, s[4:7], s62 offen sc1
    v_add_u32 v241, v241, v243
    ds_read_b128 v[208:211], v10 offset:768
    ds_read_b128 v[212:215], v10 offset:784
    s_waitcnt lgkmcnt(2)
    v_pk_mul_f32 v[244:245], v[128:129], v[216:217]
    v_pk_mul_f32 v[246:247], v[130:131], v[218:219]
    v_pk_mul_f32 v[248:249], v[132:133], v[220:221]
    v_pk_mul_f32 v[250:251], v[134:135], v[222:223]
    v_cvt_pk_bf16_f32 v40, v244, v245
    v_cvt_pk_bf16_f32 v41, v246, v247
    v_cvt_pk_bf16_f32 v42, v248, v249
    v_cvt_pk_bf16_f32 v43, v250, v251
    buffer_store_dwordx4 v[40:43], v240, s[4:7], s62 offen sc1
    v_add_u32 v240, v240, v242
    v_pk_mul_f32 v[244:245], v[136:137], v[216:217]
    v_pk_mul_f32 v[246:247], v[138:139], v[218:219]
    v_pk_mul_f32 v[248:249], v[140:141], v[220:221]
    v_pk_mul_f32 v[250:251], v[142:143], v[222:223]
    v_cvt_pk_bf16_f32 v44, v244, v245
    v_cvt_pk_bf16_f32 v45, v246, v247
    v_cvt_pk_bf16_f32 v46, v248, v249
    v_cvt_pk_bf16_f32 v47, v250, v251
    buffer_store_dwordx4 v[44:47], v241, s[4:7], s62 offen sc1
    v_add_u32 v241, v241, v243
    ds_read_b128 v[216:219], v10 offset:832
    ds_read_b128 v[220:223], v10 offset:848
    s_waitcnt lgkmcnt(2)
    v_pk_mul_f32 v[244:245], v[144:145], v[208:209]
    v_pk_mul_f32 v[246:247], v[146:147], v[210:211]
    v_pk_mul_f32 v[248:249], v[148:149], v[212:213]
    v_pk_mul_f32 v[250:251], v[150:151], v[214:215]
    v_cvt_pk_bf16_f32 v48, v244, v245
    v_cvt_pk_bf16_f32 v49, v246, v247
    v_cvt_pk_bf16_f32 v50, v248, v249
    v_cvt_pk_bf16_f32 v51, v250, v251
    buffer_store_dwordx4 v[48:51], v240, s[4:7], s62 offen sc1
    v_add_u32 v240, v240, v242
    v_pk_mul_f32 v[244:245], v[152:153], v[208:209]
    v_pk_mul_f32 v[246:247], v[154:155], v[210:211]
    v_pk_mul_f32 v[248:249], v[156:157], v[212:213]
    v_pk_mul_f32 v[250:251], v[158:159], v[214:215]
    v_cvt_pk_bf16_f32 v52, v244, v245
    v_cvt_pk_bf16_f32 v53, v246, v247
    v_cvt_pk_bf16_f32 v54, v248, v249
    v_cvt_pk_bf16_f32 v55, v250, v251
    buffer_store_dwordx4 v[52:55], v241, s[4:7], s62 offen sc1
    v_add_u32 v241, v241, v243
    ds_read_b128 v[208:211], v10 offset:896
    ds_read_b128 v[212:215], v10 offset:912
    s_waitcnt lgkmcnt(2)
    v_pk_mul_f32 v[244:245], v[160:161], v[216:217]
    v_pk_mul_f32 v[246:247], v[162:163], v[218:219]
    v_pk_mul_f32 v[248:249], v[164:165], v[220:221]
    v_pk_mul_f32 v[250:251], v[166:167], v[222:223]
    v_cvt_pk_bf16_f32 v56, v244, v245
    v_cvt_pk_bf16_f32 v57, v246, v247
    v_cvt_pk_bf16_f32 v58, v248, v249
    v_cvt_pk_bf16_f32 v59, v250, v251
    buffer_store_dwordx4 v[56:59], v240, s[4:7], s62 offen sc1
    v_add_u32 v240, v240, v242
    v_pk_mul_f32 v[244:245], v[168:169], v[216:217]
    v_pk_mul_f32 v[246:247], v[170:171], v[218:219]
    v_pk_mul_f32 v[248:249], v[172:173], v[220:221]
    v_pk_mul_f32 v[250:251], v[174:175], v[222:223]
    v_cvt_pk_bf16_f32 v60, v244, v245
    v_cvt_pk_bf16_f32 v61, v246, v247
    v_cvt_pk_bf16_f32 v62, v248, v249
    v_cvt_pk_bf16_f32 v63, v250, v251
    buffer_store_dwordx4 v[60:63], v241, s[4:7], s62 offen sc1
    v_add_u32 v241, v241, v243
    ds_read_b128 v[216:219], v10 offset:960
    ds_read_b128 v[220:223], v10 offset:976
    s_waitcnt lgkmcnt(2)
    v_pk_mul_f32 v[244:245], v[176:177], v[208:209]
    v_pk_mul_f32 v[246:247], v[178:179], v[210:211]
    v_pk_mul_f32 v[248:249], v[180:181], v[212:213]
    v_pk_mul_f32 v[250:251], v[182:183], v[214:215]
    v_cvt_pk_bf16_f32 v64, v244, v245
    v_cvt_pk_bf16_f32 v65, v246, v247
    v_cvt_pk_bf16_f32 v66, v248, v249
    v_cvt_pk_bf16_f32 v67, v250, v251
    buffer_store_dwordx4 v[64:67], v240, s[4:7], s62 offen sc1
    v_add_u32 v240, v240, v242
    v_pk_mul_f32 v[244:245], v[184:185], v[208:209]
    v_pk_mul_f32 v[246:247], v[186:187], v[210:211]
    v_pk_mul_f32 v[248:249], v[188:189], v[212:213]
    v_pk_mul_f32 v[250:251], v[190:191], v[214:215]
    v_cvt_pk_bf16_f32 v68, v244, v245
    v_cvt_pk_bf16_f32 v69, v246, v247
    v_cvt_pk_bf16_f32 v70, v248, v249
    v_cvt_pk_bf16_f32 v71, v250, v251
    buffer_store_dwordx4 v[68:71], v241, s[4:7], s62 offen sc1
    v_add_u32 v241, v241, v243
    ds_read_b128 v[208:211], v10 offset:0
    ds_read_b128 v[212:215], v10 offset:16
    s_waitcnt lgkmcnt(2)
    v_pk_mul_f32 v[244:245], v[192:193], v[216:217]
    v_pk_mul_f32 v[246:247], v[194:195], v[218:219]
    v_pk_mul_f32 v[248:249], v[196:197], v[220:221]
    v_pk_mul_f32 v[250:251], v[198:199], v[222:223]
    v_cvt_pk_bf16_f32 v72, v244, v245
    v_cvt_pk_bf16_f32 v73, v246, v247
    v_cvt_pk_bf16_f32 v74, v248, v249
    v_cvt_pk_bf16_f32 v75, v250, v251
    buffer_store_dwordx4 v[72:75], v240, s[4:7], s62 offen sc1
    v_pk_mul_f32 v[244:245], v[200:201], v[216:217]
    v_pk_mul_f32 v[246:247], v[202:203], v[218:219]
    v_pk_mul_f32 v[248:249], v[204:205], v[220:221]
    v_pk_mul_f32 v[250:251], v[206:207], v[222:223]
    v_cvt_pk_bf16_f32 v76, v244, v245
    v_cvt_pk_bf16_f32 v77, v246, v247
    v_cvt_pk_bf16_f32 v78, v248, v249
    v_cvt_pk_bf16_f32 v79, v250, v251
    buffer_store_dwordx4 v[76:79], v241, s[4:7], s62 offen sc1
    ds_read_b128 v[216:219], v10 offset:64
    ds_read_b128 v[220:223], v10 offset:80
    s_waitcnt lgkmcnt(2)
    v_pk_mul_f32 v[244:245], v[80:81], v[208:209]
    v_pk_mul_f32 v[246:247], v[88:89], v[208:209]
    v_pk_fma_f32 v[244:245], v[82:83], v[210:211], v[244:245]
    v_pk_fma_f32 v[246:247], v[90:91], v[210:211], v[246:247]
    v_pk_fma_f32 v[244:245], v[84:85], v[212:213], v[244:245]
    v_pk_fma_f32 v[246:247], v[92:93], v[212:213], v[246:247]
    v_pk_fma_f32 v[244:245], v[86:87], v[214:215], v[244:245]
    v_pk_fma_f32 v[246:247], v[94:95], v[214:215], v[246:247]
    ds_read_b128 v[208:211], v10 offset:128
    ds_read_b128 v[212:215], v10 offset:144
    s_waitcnt lgkmcnt(2)
    v_pk_fma_f32 v[244:245], v[96:97], v[216:217], v[244:245]
    v_pk_fma_f32 v[246:247], v[104:105], v[216:217], v[246:247]
    v_pk_fma_f32 v[244:245], v[98:99], v[218:219], v[244:245]
    v_pk_fma_f32 v[246:247], v[106:107], v[218:219], v[246:247]
    v_pk_fma_f32 v[244:245], v[100:101], v[220:221], v[244:245]
    v_pk_fma_f32 v[246:247], v[108:109], v[220:221], v[246:247]
    v_pk_fma_f32 v[244:245], v[102:103], v[222:223], v[244:245]
    v_pk_fma_f32 v[246:247], v[110:111], v[222:223], v[246:247]
    ds_read_b128 v[216:219], v10 offset:192
    ds_read_b128 v[220:223], v10 offset:208
    s_waitcnt lgkmcnt(2)
    v_pk_fma_f32 v[244:245], v[112:113], v[208:209], v[244:245]
    v_pk_fma_f32 v[246:247], v[120:121], v[208:209], v[246:247]
    v_pk_fma_f32 v[244:245], v[114:115], v[210:211], v[244:245]
    v_pk_fma_f32 v[246:247], v[122:123], v[210:211], v[246:247]
    v_pk_fma_f32 v[244:245], v[116:117], v[212:213], v[244:245]
    v_pk_fma_f32 v[246:247], v[124:125], v[212:213], v[246:247]
    v_pk_fma_f32 v[244:245], v[118:119], v[214:215], v[244:245]
    v_pk_fma_f32 v[246:247], v[126:127], v[214:215], v[246:247]
    ds_read_b128 v[208:211], v10 offset:256
    ds_read_b128 v[212:215], v10 offset:272
    s_waitcnt lgkmcnt(2)
    v_pk_fma_f32 v[244:245], v[128:129], v[216:217], v[244:245]
    v_pk_fma_f32 v[246:247], v[136:137], v[216:217], v[246:247]
    v_pk_fma_f32 v[244:245], v[130:131], v[218:219], v[244:245]
    v_pk_fma_f32 v[246:247], v[138:139], v[218:219], v[246:247]
    v_pk_fma_f32 v[244:245], v[132:133], v[220:221], v[244:245]
    v_pk_fma_f32 v[246:247], v[140:141], v[220:221], v[246:247]
    v_pk_fma_f32 v[244:245], v[134:135], v[222:223], v[244:245]
    v_pk_fma_f32 v[246:247], v[142:143], v[222:223], v[246:247]
    ds_read_b128 v[216:219], v10 offset:320
    ds_read_b128 v[220:223], v10 offset:336
    s_waitcnt lgkmcnt(2)
    v_pk_fma_f32 v[244:245], v[144:145], v[208:209], v[244:245]
    v_pk_fma_f32 v[246:247], v[152:153], v[208:209], v[246:247]
    v_pk_fma_f32 v[244:245], v[146:147], v[210:211], v[244:245]
    v_pk_fma_f32 v[246:247], v[154:155], v[210:211], v[246:247]
    v_pk_fma_f32 v[244:245], v[148:149], v[212:213], v[244:245]
    v_pk_fma_f32 v[246:247], v[156:157], v[212:213], v[246:247]
    v_pk_fma_f32 v[244:245], v[150:151], v[214:215], v[244:245]
    v_pk_fma_f32 v[246:247], v[158:159], v[214:215], v[246:247]
    ds_read_b128 v[208:211], v10 offset:384
    ds_read_b128 v[212:215], v10 offset:400
    s_waitcnt lgkmcnt(2)
    v_pk_fma_f32 v[244:245], v[160:161], v[216:217], v[244:245]
    v_pk_fma_f32 v[246:247], v[168:169], v[216:217], v[246:247]
    v_pk_fma_f32 v[244:245], v[162:163], v[218:219], v[244:245]
    v_pk_fma_f32 v[246:247], v[170:171], v[218:219], v[246:247]
    v_pk_fma_f32 v[244:245], v[164:165], v[220:221], v[244:245]
    v_pk_fma_f32 v[246:247], v[172:173], v[220:221], v[246:247]
    v_pk_fma_f32 v[244:245], v[166:167], v[222:223], v[244:245]
    v_pk_fma_f32 v[246:247], v[174:175], v[222:223], v[246:247]
    ds_read_b128 v[216:219], v10 offset:448
    ds_read_b128 v[220:223], v10 offset:464
    s_waitcnt lgkmcnt(2)
    v_pk_fma_f32 v[244:245], v[176:177], v[208:209], v[244:245]
    v_pk_fma_f32 v[246:247], v[184:185], v[208:209], v[246:247]
    v_pk_fma_f32 v[244:245], v[178:179], v[210:211], v[244:245]
    v_pk_fma_f32 v[246:247], v[186:187], v[210:211], v[246:247]
    v_pk_fma_f32 v[244:245], v[180:181], v[212:213], v[244:245]
    v_pk_fma_f32 v[246:247], v[188:189], v[212:213], v[246:247]
    v_pk_fma_f32 v[244:245], v[182:183], v[214:215], v[244:245]
    v_pk_fma_f32 v[246:247], v[190:191], v[214:215], v[246:247]
    s_waitcnt lgkmcnt(0)
    v_pk_fma_f32 v[244:245], v[192:193], v[216:217], v[244:245]
    v_pk_fma_f32 v[246:247], v[200:201], v[216:217], v[246:247]
    v_pk_fma_f32 v[244:245], v[194:195], v[218:219], v[244:245]
    v_pk_fma_f32 v[246:247], v[202:203], v[218:219], v[246:247]
    v_pk_fma_f32 v[244:245], v[196:197], v[220:221], v[244:245]
    v_pk_fma_f32 v[246:247], v[204:205], v[220:221], v[246:247]
    v_pk_fma_f32 v[244:245], v[198:199], v[222:223], v[244:245]
    v_pk_fma_f32 v[246:247], v[206:207], v[222:223], v[246:247]
    v_mfma_f32_16x16x32_bf16 v[248:251], v[232:235], v[16:19], 0
    v_mfma_f32_16x16x32_bf16 v[252:255], v[232:235], v[20:23], 0
    v_mfma_f32_16x16x32_bf16 v[248:251], v[232:235], v[24:27], v[248:251]
    v_mfma_f32_16x16x32_bf16 v[252:255], v[232:235], v[28:31], v[252:255]
    v_mfma_f32_16x16x32_bf16 v[248:251], v[232:235], v[32:35], v[248:251]
    v_mfma_f32_16x16x32_bf16 v[252:255], v[232:235], v[36:39], v[252:255]
    v_mfma_f32_16x16x32_bf16 v[248:251], v[232:235], v[40:43], v[248:251]
    v_mfma_f32_16x16x32_bf16 v[252:255], v[232:235], v[44:47], v[252:255]
    v_mfma_f32_16x16x32_bf16 v[248:251], v[232:235], v[48:51], v[248:251]
    v_mfma_f32_16x16x32_bf16 v[252:255], v[232:235], v[52:55], v[252:255]
    v_mfma_f32_16x16x32_bf16 v[248:251], v[232:235], v[56:59], v[248:251]
    v_mfma_f32_16x16x32_bf16 v[252:255], v[232:235], v[60:63], v[252:255]
    v_mfma_f32_16x16x32_bf16 v[248:251], v[232:235], v[64:67], v[248:251]
    v_mfma_f32_16x16x32_bf16 v[252:255], v[232:235], v[68:71], v[252:255]
    v_mfma_f32_16x16x32_bf16 v[248:251], v[232:235], v[72:75], v[248:251]
    v_mfma_f32_16x16x32_bf16 v[252:255], v[232:235], v[76:79], v[252:255]
    v_add_f32 v244, v244, v245
    v_add_f32 v246, v246, v247
    v_and_b32 v3, 1, v7
    v_cmp_eq_u32 vcc, 1, v3
    v_permlane16_swap_b32 v244, v246
    v_add_f32 v209, v244, v246
    s_nop 1
    v_cndmask_b32 v208, v248, v252, vcc
    buffer_store_dwordx2 v[208:209], v12, s[4:7], s50 offen sc1
    s_branch h_ones
h_down:
    s_mov_b32 s8, s36
    s_mov_b32 s9, s37
    s_mov_b32 s10, 2211840
    s_mov_b32 s11, 0x20000
    s_sub_u32 s56, s51, 270
    s_lshr_b32 s58, s56, 1
    s_and_b32 s59, s56, 1
    s_mul_i32 s61, s59, 640
    s_cmp_ge_u32 s51, 382
    s_cselect_b32 s61, 0x7f000000, s61
    s_lshl_b32 s60, s58, 2
    s_add_u32 s60, s60, 0
    v_lshrrev_b32 v100, 2, v14
    v_add_u32 v100, s60, v100
    v_mul_u32_u24 v101, 10923, v100
    v_lshrrev_b32 v101, 16, v101
    v_mul_u32_u24 v102, 6, v101
    v_sub_u32 v102, v100, v102
    v_mul_u32_u24 v101, 108, v101
    v_lshlrev_b32 v103, 3, v102
    v_add_u32 v104, 64, v103
    v_cmp_lt_u32 vcc, 3, v102
    s_nop 1
    v_cndmask_b32 v103, v103, v104, vcc
    v_add_u32 v103, v103, v101
    v_add_u32 v104, 4, v103
    v_mov_b32 v105, 2000
    v_cmp_eq_u32 vcc, 5, v102
    s_nop 1
    v_cndmask_b32 v104, v104, v105, vcc
    v_subrev_u32 v105, 96, v100
    v_bfe_u32 v106, v105, 2, 4
    v_mul_u32_u24 v106, 108, v106
    v_bfe_u32 v107, v105, 6, 1
    v_lshl_add_u32 v106, v107, 5, v106
    v_and_b32 v105, 3, v105
    v_lshl_add_u32 v105, v105, 3, v106
    v_add_u32 v105, 32, v105
    v_add_u32 v106, 4, v105
    v_cmp_lt_u32 vcc, 95, v100
    s_nop 1
    v_cndmask_b32 v103, v103, v105, vcc
    v_cndmask_b32 v104, v104, v106, vcc
    v_and_b32 v105, 3, v14
    v_add_u32 v103, v103, v105
    v_add_u32 v104, v104, v105
    v_mul_u32_u24 v103, 1280, v103
    v_mul_u32_u24 v104, 1280, v104
    v_lshl_add_u32 v112, v15, 4, v103
    v_lshl_add_u32 v113, v15, 4, v104
    s_lshl_b32 s60, s58, 2
    s_add_u32 s60, s60, 2
    v_lshrrev_b32 v100, 2, v14
    v_add_u32 v100, s60, v100
    v_mul_u32_u24 v101, 10923, v100
    v_lshrrev_b32 v101, 16, v101
    v_mul_u32_u24 v102, 6, v101
    v_sub_u32 v102, v100, v102
    v_mul_u32_u24 v101, 108, v101
    v_lshlrev_b32 v103, 3, v102
    v_add_u32 v104, 64, v103
    v_cmp_lt_u32 vcc, 3, v102
    s_nop 1
    v_cndmask_b32 v103, v103, v104, vcc
    v_add_u32 v103, v103, v101
    v_add_u32 v104, 4, v103
    v_mov_b32 v105, 2000
    v_cmp_eq_u32 vcc, 5, v102
    s_nop 1
    v_cndmask_b32 v104, v104, v105, vcc
    v_subrev_u32 v105, 96, v100
    v_bfe_u32 v106, v105, 2, 4
    v_mul_u32_u24 v106, 108, v106
    v_bfe_u32 v107, v105, 6, 1
    v_lshl_add_u32 v106, v107, 5, v106
    v_and_b32 v105, 3, v105
    v_lshl_add_u32 v105, v105, 3, v106
    v_add_u32 v105, 32, v105
    v_add_u32 v106, 4, v105
    v_cmp_lt_u32 vcc, 95, v100
    s_nop 1
    v_cndmask_b32 v103, v103, v105, vcc
    v_cndmask_b32 v104, v104, v106, vcc
    v_and_b32 v105, 3, v14
    v_add_u32 v103, v103, v105
    v_add_u32 v104, v104, v105
    v_mul_u32_u24 v103, 1280, v103
    v_mul_u32_u24 v104, 1280, v104
    v_lshl_add_u32 v114, v15, 4, v103
    v_lshl_add_u32 v115, v15, 4, v104
    s_waitcnt vmcnt(0)
    v_mov_b32 v2, 25344
    v_mov_b32 v3, 1
    s_mov_b64 exec, 1
    ds_add_u32 v2, v3
    s_mov_b64 exec, -1
    v_cmp_eq_u32 vcc, 0, v8
    s_nop 1
    v_cndmask_b32 v224, 0, v9, vcc
    v_cmp_eq_u32 vcc, 1, v8
    s_nop 1
    v_cndmask_b32 v224, v224, v10, vcc
    v_cmp_eq_u32 vcc, 2, v8
    s_nop 1
    v_cndmask_b32 v225, 0, v9, vcc
    v_cmp_eq_u32 vcc, 3, v8
    s_nop 1
    v_cndmask_b32 v225, v225, v10, vcc
    v_cmp_eq_u32 vcc, 4, v8
    s_nop 1
    v_cndmask_b32 v226, 0, v9, vcc
    v_cmp_eq_u32 vcc, 5, v8
    s_nop 1
    v_cndmask_b32 v226, v226, v10, vcc
    v_cmp_eq_u32 vcc, 6, v8
    s_nop 1
    v_cndmask_b32 v227, 0, v9, vcc
    v_cmp_eq_u32 vcc, 7, v8
    s_nop 1
    v_cndmask_b32 v227, v227, v10, vcc
    v_cmp_eq_u32 vcc, -16, v8
    s_nop 1
    v_cndmask_b32 v228, 0, v9, vcc
    v_cmp_eq_u32 vcc, -15, v8
    s_nop 1
    v_cndmask_b32 v228, v228, v10, vcc
    v_cmp_eq_u32 vcc, -14, v8
    s_nop 1
    v_cndmask_b32 v229, 0, v9, vcc
    v_cmp_eq_u32 vcc, -13, v8
    s_nop 1
    v_cndmask_b32 v229, v229, v10, vcc
    v_cmp_eq_u32 vcc, -12, v8
    s_nop 1
    v_cndmask_b32 v230, 0, v9, vcc
    v_cmp_eq_u32 vcc, -11, v8
    s_nop 1
    v_cndmask_b32 v230, v230, v10, vcc
    v_cmp_eq_u32 vcc, -10, v8
    s_nop 1
    v_cndmask_b32 v231, 0, v9, vcc
    v_cmp_eq_u32 vcc, -9, v8
    s_nop 1
    v_cndmask_b32 v231, v231, v10, vcc
    v_lshrrev_b32 v9, 3, v6
    v_lshrrev_b32 v10, 1, v7
    v_cmp_eq_u32 vcc, v9, v10
    v_mov_b32 v236, 0x3f803f80
    s_nop 0
    v_cndmask_b32 v232, 0, v236, vcc
    v_cndmask_b32 v233, 0, v236, vcc
    v_cndmask_b32 v234, 0, v236, vcc
    v_cndmask_b32 v235, 0, v236, vcc
    v_mov_b32 v237, v236
    v_mov_b32 v238, v236
    v_mov_b32 v239, v236
    v_lshrrev_b32 v8, 1, v7
    v_and_b32 v9, 7, v6
    v_bfe_u32 v10, v6, 2, 1
    v_lshlrev_b32 v10, 10, v10
    v_lshl_add_u32 v10, v8, 6, v10
    v_and_b32 v11, 3, v6
    v_lshl_add_u32 v10, v11, 4, v10
    v_and_b32 v11, 1, v7
    v_lshl_add_u32 v10, v11, 8, v10
    v_lshl_add_u32 v9, v8, 3, v9
    v_lshlrev_b32 v9, 4, v9
    v_lshl_add_u32 v9, v11, 8, v9
    v_cmp_lt_u32 vcc, 7, v6
    s_mul_i32 s60, s59, 1146880
    s_mul_i32 s62, s58, 5120
    s_add_u32 s62, s62, s60
    s_add_u32 s62, s62, 10878976
    s_cmp_ge_u32 s51, 382
    s_cselect_b32 s62, 0x7f000000, s62
    v_add_u32 v12, 0, v10
    v_add_u32 v13, 128, v10
    v_cndmask_b32 v100, v12, v13, vcc
    v_add_u32 v12, 2048, v10
    v_add_u32 v13, 2176, v10
    v_cndmask_b32 v101, v12, v13, vcc
    v_add_u32 v12, 4096, v9
    v_add_u32 v13, 286720, v10
    v_cndmask_b32 v102, v12, v13, vcc
    v_add_u32 v12, 286848, v10
    v_add_u32 v13, 288768, v10
    v_cndmask_b32 v103, v12, v13, vcc
    v_add_u32 v12, 288896, v10
    v_add_u32 v13, 290816, v9
    v_cndmask_b32 v104, v12, v13, vcc
    v_add_u32 v12, 573440, v10
    v_add_u32 v13, 573568, v10
    v_cndmask_b32 v105, v12, v13, vcc
    v_add_u32 v12, 575488, v10
    v_add_u32 v13, 575616, v10
    v_cndmask_b32 v106, v12, v13, vcc
    v_add_u32 v12, 577536, v9
    v_add_u32 v13, 860160, v10
    v_cndmask_b32 v107, v12, v13, vcc
    v_add_u32 v12, 860288, v10
    v_add_u32 v13, 862208, v10
    v_cndmask_b32 v108, v12, v13, vcc
    v_add_u32 v12, 862336, v10
    v_add_u32 v13, 864256, v9
    v_cndmask_b32 v109, v12, v13, vcc
    buffer_load_dwordx4 v[16:19], v112, s[8:11], s61 offen offset:0 nt
    buffer_load_dwordx4 v[20:23], v113, s[8:11], s61 offen offset:0 nt
    buffer_load_dwordx4 v[24:27], v114, s[8:11], s61 offen offset:0 nt
    buffer_load_dwordx4 v[28:31], v115, s[8:11], s61 offen offset:0 nt
    buffer_load_dwordx4 v[32:35], v112, s[8:11], s61 offen offset:128 nt
    buffer_load_dwordx4 v[36:39], v113, s[8:11], s61 offen offset:128 nt
    buffer_load_dwordx4 v[40:43], v114, s[8:11], s61 offen offset:128 nt
    buffer_load_dwordx4 v[44:47], v115, s[8:11], s61 offen offset:128 nt
    buffer_load_dwordx4 v[48:51], v112, s[8:11], s61 offen offset:256 nt
    buffer_load_dwordx4 v[52:55], v113, s[8:11], s61 offen offset:256 nt
    buffer_load_dwordx4 v[56:59], v114, s[8:11], s61 offen offset:256 nt
    buffer_load_dwordx4 v[60:63], v115, s[8:11], s61 offen offset:256 nt
    buffer_load_dwordx4 v[64:67], v112, s[8:11], s61 offen offset:384 nt
    buffer_load_dwordx4 v[68:71], v113, s[8:11], s61 offen offset:384 nt
    buffer_load_dwordx4 v[72:75], v114, s[8:11], s61 offen offset:384 nt
    buffer_load_dwordx4 v[76:79], v115, s[8:11], s61 offen offset:384 nt
    buffer_load_dwordx4 v[80:83], v112, s[8:11], s61 offen offset:512 nt
    buffer_load_dwordx4 v[84:87], v113, s[8:11], s61 offen offset:512 nt
    buffer_load_dwordx4 v[88:91], v114, s[8:11], s61 offen offset:512 nt
    buffer_load_dwordx4 v[92:95], v115, s[8:11], s61 offen offset:512 nt
    s_barrier
    v_mov_b32 v2, 25356
    s_mov_b32 s57, 0
lw_18:
    ds_read_b32 v3, v2
    s_add_u32 s57, s57, 1
    s_cmp_ge_u32 s57, 2000000
    s_waitcnt lgkmcnt(0)
    s_cbranch_scc1 lwd_19
    v_cmp_gt_u32 vcc, 2, v3
    s_cbranch_vccnz lw_18
lwd_19:
    s_waitcnt vmcnt(16)
    v_mfma_f32_16x16x32_bf16 v[128:131], v[16:19], v[224:227], 0
    v_mfma_f32_16x16x32_bf16 v[136:139], v[16:19], v[228:231], 0
    v_mfma_f32_16x16x32_bf16 v[132:135], v[20:23], v[224:227], 0
    v_mfma_f32_16x16x32_bf16 v[140:143], v[20:23], v[228:231], 0
    v_mfma_f32_16x16x32_bf16 v[144:147], v[24:27], v[224:227], 0
    v_mfma_f32_16x16x32_bf16 v[152:155], v[24:27], v[228:231], 0
    v_mfma_f32_16x16x32_bf16 v[148:151], v[28:31], v[224:227], 0
    v_mfma_f32_16x16x32_bf16 v[156:159], v[28:31], v[228:231], 0
    s_nop 0
    v_cvt_pk_bf16_f32 v160, v128, v129
    v_cvt_pk_bf16_f32 v161, v130, v131
    v_cvt_pk_bf16_f32 v162, v132, v133
    v_cvt_pk_bf16_f32 v163, v134, v135
    buffer_store_dwordx4 v[160:163], v100, s[4:7], s62 offen offset:0 sc1
    v_cvt_pk_bf16_f32 v164, v136, v137
    v_cvt_pk_bf16_f32 v165, v138, v139
    v_cvt_pk_bf16_f32 v166, v140, v141
    v_cvt_pk_bf16_f32 v167, v142, v143
    buffer_store_dwordx4 v[164:167], v101, s[4:7], s62 offen offset:0 sc1
    v_cvt_pk_bf16_f32 v168, v144, v145
    v_cvt_pk_bf16_f32 v169, v146, v147
    v_cvt_pk_bf16_f32 v170, v148, v149
    v_cvt_pk_bf16_f32 v171, v150, v151
    buffer_store_dwordx4 v[168:171], v100, s[4:7], s62 offen offset:512 sc1
    v_cvt_pk_bf16_f32 v172, v152, v153
    v_cvt_pk_bf16_f32 v173, v154, v155
    v_cvt_pk_bf16_f32 v174, v156, v157
    v_cvt_pk_bf16_f32 v175, v158, v159
    buffer_store_dwordx4 v[172:175], v101, s[4:7], s62 offen offset:512 sc1
    s_waitcnt vmcnt(16)
    v_mfma_f32_16x16x32_bf16 v[128:131], v[32:35], v[224:227], 0
    v_mfma_f32_16x16x32_bf16 v[136:139], v[32:35], v[228:231], 0
    v_mfma_f32_16x16x32_bf16 v[132:135], v[36:39], v[224:227], 0
    v_mfma_f32_16x16x32_bf16 v[140:143], v[36:39], v[228:231], 0
    v_mfma_f32_16x16x32_bf16 v[144:147], v[40:43], v[224:227], 0
    v_mfma_f32_16x16x32_bf16 v[152:155], v[40:43], v[228:231], 0
    v_mfma_f32_16x16x32_bf16 v[148:151], v[44:47], v[224:227], 0
    v_mfma_f32_16x16x32_bf16 v[156:159], v[44:47], v[228:231], 0
    s_nop 0
    v_cvt_pk_bf16_f32 v176, v128, v129
    v_cvt_pk_bf16_f32 v177, v130, v131
    v_cvt_pk_bf16_f32 v178, v132, v133
    v_cvt_pk_bf16_f32 v179, v134, v135
    buffer_store_dwordx4 v[176:179], v102, s[4:7], s62 offen offset:0 sc1
    v_cvt_pk_bf16_f32 v180, v136, v137
    v_cvt_pk_bf16_f32 v181, v138, v139
    v_cvt_pk_bf16_f32 v182, v140, v141
    v_cvt_pk_bf16_f32 v183, v142, v143
    buffer_store_dwordx4 v[180:183], v103, s[4:7], s62 offen offset:0 sc1
    v_cvt_pk_bf16_f32 v184, v144, v145
    v_cvt_pk_bf16_f32 v185, v146, v147
    v_cvt_pk_bf16_f32 v186, v148, v149
    v_cvt_pk_bf16_f32 v187, v150, v151
    buffer_store_dwordx4 v[184:187], v102, s[4:7], s62 offen offset:512 sc1
    v_cvt_pk_bf16_f32 v188, v152, v153
    v_cvt_pk_bf16_f32 v189, v154, v155
    v_cvt_pk_bf16_f32 v190, v156, v157
    v_cvt_pk_bf16_f32 v191, v158, v159
    buffer_store_dwordx4 v[188:191], v103, s[4:7], s62 offen offset:512 sc1
    s_waitcnt vmcnt(16)
    v_mfma_f32_16x16x32_bf16 v[128:131], v[48:51], v[224:227], 0
    v_mfma_f32_16x16x32_bf16 v[136:139], v[48:51], v[228:231], 0
    v_mfma_f32_16x16x32_bf16 v[132:135], v[52:55], v[224:227], 0
    v_mfma_f32_16x16x32_bf16 v[140:143], v[52:55], v[228:231], 0
    v_mfma_f32_16x16x32_bf16 v[144:147], v[56:59], v[224:227], 0
    v_mfma_f32_16x16x32_bf16 v[152:155], v[56:59], v[228:231], 0
    v_mfma_f32_16x16x32_bf16 v[148:151], v[60:63], v[224:227], 0
    v_mfma_f32_16x16x32_bf16 v[156:159], v[60:63], v[228:231], 0
    s_nop 0
    v_cvt_pk_bf16_f32 v160, v128, v129
    v_cvt_pk_bf16_f32 v161, v130, v131
    v_cvt_pk_bf16_f32 v162, v132, v133
    v_cvt_pk_bf16_f32 v163, v134, v135
    buffer_store_dwordx4 v[160:163], v104, s[4:7], s62 offen offset:0 sc1
    v_cvt_pk_bf16_f32 v164, v136, v137
    v_cvt_pk_bf16_f32 v165, v138, v139
    v_cvt_pk_bf16_f32 v166, v140, v141
    v_cvt_pk_bf16_f32 v167, v142, v143
    buffer_store_dwordx4 v[164:167], v105, s[4:7], s62 offen offset:0 sc1
    v_cvt_pk_bf16_f32 v168, v144, v145
    v_cvt_pk_bf16_f32 v169, v146, v147
    v_cvt_pk_bf16_f32 v170, v148, v149
    v_cvt_pk_bf16_f32 v171, v150, v151
    buffer_store_dwordx4 v[168:171], v104, s[4:7], s62 offen offset:512 sc1
    v_cvt_pk_bf16_f32 v172, v152, v153
    v_cvt_pk_bf16_f32 v173, v154, v155
    v_cvt_pk_bf16_f32 v174, v156, v157
    v_cvt_pk_bf16_f32 v175, v158, v159
    buffer_store_dwordx4 v[172:175], v105, s[4:7], s62 offen offset:512 sc1
    s_waitcnt vmcnt(16)
    v_mfma_f32_16x16x32_bf16 v[128:131], v[64:67], v[224:227], 0
    v_mfma_f32_16x16x32_bf16 v[136:139], v[64:67], v[228:231], 0
    v_mfma_f32_16x16x32_bf16 v[132:135], v[68:71], v[224:227], 0
    v_mfma_f32_16x16x32_bf16 v[140:143], v[68:71], v[228:231], 0
    v_mfma_f32_16x16x32_bf16 v[144:147], v[72:75], v[224:227], 0
    v_mfma_f32_16x16x32_bf16 v[152:155], v[72:75], v[228:231], 0
    v_mfma_f32_16x16x32_bf16 v[148:151], v[76:79], v[224:227], 0
    v_mfma_f32_16x16x32_bf16 v[156:159], v[76:79], v[228:231], 0
    s_nop 0
    v_cvt_pk_bf16_f32 v176, v128, v129
    v_cvt_pk_bf16_f32 v177, v130, v131
    v_cvt_pk_bf16_f32 v178, v132, v133
    v_cvt_pk_bf16_f32 v179, v134, v135
    buffer_store_dwordx4 v[176:179], v106, s[4:7], s62 offen offset:0 sc1
    v_cvt_pk_bf16_f32 v180, v136, v137
    v_cvt_pk_bf16_f32 v181, v138, v139
    v_cvt_pk_bf16_f32 v182, v140, v141
    v_cvt_pk_bf16_f32 v183, v142, v143
    buffer_store_dwordx4 v[180:183], v107, s[4:7], s62 offen offset:0 sc1
    v_cvt_pk_bf16_f32 v184, v144, v145
    v_cvt_pk_bf16_f32 v185, v146, v147
    v_cvt_pk_bf16_f32 v186, v148, v149
    v_cvt_pk_bf16_f32 v187, v150, v151
    buffer_store_dwordx4 v[184:187], v106, s[4:7], s62 offen offset:512 sc1
    v_cvt_pk_bf16_f32 v188, v152, v153
    v_cvt_pk_bf16_f32 v189, v154, v155
    v_cvt_pk_bf16_f32 v190, v156, v157
    v_cvt_pk_bf16_f32 v191, v158, v159
    buffer_store_dwordx4 v[188:191], v107, s[4:7], s62 offen offset:512 sc1
    s_waitcnt vmcnt(16)
    v_mfma_f32_16x16x32_bf16 v[128:131], v[80:83], v[224:227], 0
    v_mfma_f32_16x16x32_bf16 v[136:139], v[80:83], v[228:231], 0
    v_mfma_f32_16x16x32_bf16 v[132:135], v[84:87], v[224:227], 0
    v_mfma_f32_16x16x32_bf16 v[140:143], v[84:87], v[228:231], 0
    v_mfma_f32_16x16x32_bf16 v[144:147], v[88:91], v[224:227], 0
    v_mfma_f32_16x16x32_bf16 v[152:155], v[88:91], v[228:231], 0
    v_mfma_f32_16x16x32_bf16 v[148:151], v[92:95], v[224:227], 0
    v_mfma_f32_16x16x32_bf16 v[156:159], v[92:95], v[228:231], 0
    s_nop 0
    v_cvt_pk_bf16_f32 v160, v128, v129
    v_cvt_pk_bf16_f32 v161, v130, v131
    v_cvt_pk_bf16_f32 v162, v132, v133
    v_cvt_pk_bf16_f32 v163, v134, v135
    buffer_store_dwordx4 v[160:163], v108, s[4:7], s62 offen offset:0 sc1
    v_cvt_pk_bf16_f32 v164, v136, v137
    v_cvt_pk_bf16_f32 v165, v138, v139
    v_cvt_pk_bf16_f32 v166, v140, v141
    v_cvt_pk_bf16_f32 v167, v142, v143
    buffer_store_dwordx4 v[164:167], v109, s[4:7], s62 offen offset:0 sc1
    v_cvt_pk_bf16_f32 v168, v144, v145
    v_cvt_pk_bf16_f32 v169, v146, v147
    v_cvt_pk_bf16_f32 v170, v148, v149
    v_cvt_pk_bf16_f32 v171, v150, v151
    buffer_store_dwordx4 v[168:171], v108, s[4:7], s62 offen offset:512 sc1
    v_cvt_pk_bf16_f32 v172, v152, v153
    v_cvt_pk_bf16_f32 v173, v154, v155
    v_cvt_pk_bf16_f32 v174, v156, v157
    v_cvt_pk_bf16_f32 v175, v158, v159
    buffer_store_dwordx4 v[172:175], v109, s[4:7], s62 offen offset:512 sc1
h_ones:
    s_mul_hi_u32 s56, s51, 0x1999999a
    s_mul_i32 s57, s56, 10
    s_sub_u32 s57, s51, s57
    s_mul_i32 s56, s56, 286720
    s_mul_i32 s57, s57, 8192
    s_add_u32 s56, s56, s57
    s_add_u32 s56, s56, 6291648
    s_cmp_lt_u32 s51, 160
    s_cselect_b32 s56, s56, 0x7f000000
    v_mul_u32_u24 v2, 2048, v7
    v_lshrrev_b32 v3, 2, v6
    v_lshl_add_u32 v2, v3, 8, v2
    v_and_b32 v3, 3, v6
    v_lshl_add_u32 v2, v3, 4, v2
    buffer_store_dwordx4 v[236:239], v2, s[4:7], s56 offen sc1
    s_waitcnt vmcnt(0)
    s_lshl_b32 s58, s48, 4
    s_add_u32 s58, s58, 16
    s_and_b32 s56, s2, 15
    s_lshl_b32 s56, s56, 7
    s_add_u32 s56, s56, 8192
    v_mov_b32 v2, 1
    v_mov_b32 v3, 0
    s_mov_b64 exec, 1
    buffer_atomic_add v2, v3, s[4:7], s56 offen sc1
    s_mov_b64 exec, -1
    s_cmp_eq_u32 s3, 3
    s_cbranch_scc1 h_w3
h_w2:
    s_cmp_lg_u32 s51, 397
    s_cbranch_scc1 nomaster_20
    v_min_u32 v8, 15, v1
    v_mov_b32 v9, 16
    v_lshrrev_b32 v9, 3, v8
    v_lshlrev_b32 v9, 4, v9
    v_add_u32 v9, 16, v9
    v_lshlrev_b32 v8, 7, v8
    v_add_u32 v8, 8192, v8
    s_mov_b32 s57, 0
poll_21:
    buffer_load_dword v10, v8, s[4:7], 0 offen sc1
    s_add_u32 s57, s57, 1
    s_cmp_ge_u32 s57, 100000
    s_waitcnt vmcnt(0)
    s_cbranch_scc1 pdone_22
    v_cmp_gt_u32 vcc, v9, v10
    s_cbranch_vccz pdone_22
    s_sleep 1
    s_branch poll_21
pdone_22:
    v_mov_b32 v2, 1
    v_lshlrev_b32 v3, 7, v1
    s_mov_b32 s56, 12288
    s_mov_b32 exec_hi, 0
    buffer_store_dword v2, v3, s[4:7], s56 offen sc1
    s_mov_b32 exec_hi, -1
nomaster_20:
    v_mov_b32 v2, 25360
    s_mov_b32 s57, 0
lw_23:
    ds_read_b32 v3, v2
    s_add_u32 s57, s57, 1
    s_cmp_ge_u32 s57, 2000000
    s_waitcnt lgkmcnt(0)
    s_cbranch_scc1 lwd_24
    v_cmp_gt_u32 vcc, 1, v3
    s_cbranch_vccnz lw_23
lwd_24:
    s_mul_i32 s57, s3, 6
    s_mul_i32 s23, s55, 56
    s_add_u32 s23, s23, s57
    s_mul_i32 s23, s23, 5120
    s_add_u32 s23, s23, 10878976
    s_add_u32 s59, s23, 0
    buffer_load_dwordx4 a[160:163], v4, s[4:7], s59 offen offset:0 sc1
    buffer_load_dwordx4 a[164:167], v4, s[4:7], s59 offen offset:1024 sc1
    buffer_load_dwordx4 a[168:171], v4, s[4:7], s59 offen offset:2048 sc1
    buffer_load_dwordx4 a[172:175], v4, s[4:7], s59 offen offset:3072 sc1
    s_add_u32 s59, s23, 4096
    buffer_load_dwordx4 a[176:179], v4, s[4:7], s59 offen offset:0 sc1
    buffer_load_dwordx4 a[180:183], v4, s[4:7], s59 offen offset:1024 sc1
    buffer_load_dwordx4 a[184:187], v4, s[4:7], s59 offen offset:2048 sc1
    buffer_load_dwordx4 a[188:191], v4, s[4:7], s59 offen offset:3072 sc1
    s_add_u32 s59, s23, 8192
    buffer_load_dwordx4 a[192:195], v4, s[4:7], s59 offen offset:0 sc1
    buffer_load_dwordx4 a[196:199], v4, s[4:7], s59 offen offset:1024 sc1
    buffer_load_dwordx4 a[200:203], v4, s[4:7], s59 offen offset:2048 sc1
    buffer_load_dwordx4 a[204:207], v4, s[4:7], s59 offen offset:3072 sc1
    s_add_u32 s59, s23, 12288
    buffer_load_dwordx4 a[208:211], v4, s[4:7], s59 offen offset:0 sc1
    buffer_load_dwordx4 a[212:215], v4, s[4:7], s59 offen offset:1024 sc1
    buffer_load_dwordx4 a[216:219], v4, s[4:7], s59 offen offset:2048 sc1
    buffer_load_dwordx4 a[220:223], v4, s[4:7], s59 offen offset:3072 sc1
    s_add_u32 s59, s23, 16384
    buffer_load_dwordx4 a[224:227], v4, s[4:7], s59 offen offset:0 sc1
    buffer_load_dwordx4 a[228:231], v4, s[4:7], s59 offen offset:1024 sc1
    buffer_load_dwordx4 a[232:235], v4, s[4:7], s59 offen offset:2048 sc1
    buffer_load_dwordx4 a[236:239], v4, s[4:7], s59 offen offset:3072 sc1
    s_add_u32 s59, s23, 20480
    buffer_load_dwordx4 a[240:243], v4, s[4:7], s59 offen offset:0 sc1
    buffer_load_dwordx4 a[244:247], v4, s[4:7], s59 offen offset:1024 sc1
    buffer_load_dwordx4 a[248:251], v4, s[4:7], s59 offen offset:2048 sc1
    buffer_load_dwordx4 a[252:255], v4, s[4:7], s59 offen offset:3072 sc1
    s_add_u32 s59, s23, 24576
    buffer_load_dwordx4 v[224:227], v4, s[4:7], s59 offen offset:0 sc1
    buffer_load_dwordx4 v[228:231], v4, s[4:7], s59 offen offset:1024 sc1
    buffer_load_dwordx4 v[232:235], v4, s[4:7], s59 offen offset:2048 sc1
    buffer_load_dwordx4 v[236:239], v4, s[4:7], s59 offen offset:3072 sc1
    s_add_u32 s59, s23, 28672
    buffer_load_dwordx4 v[240:243], v4, s[4:7], s59 offen offset:0 sc1
    buffer_load_dwordx4 v[244:247], v4, s[4:7], s59 offen offset:1024 sc1
    s_branch sync2
h_w3:
    s_and_b32 s63, s2, 31
    s_lshl_b32 s63, s63, 7
    s_add_u32 s63, s63, 12288
    v_mov_b32 v8, s63
    v_mov_b32 v9, 1
    s_mov_b32 s57, 0
poll_25:
    buffer_load_dword v10, v8, s[4:7], 0 offen sc1
    s_add_u32 s57, s57, 1
    s_cmp_ge_u32 s57, 100000
    s_waitcnt vmcnt(0)
    s_cbranch_scc1 pdone_26
    v_cmp_gt_u32 vcc, v9, v10
    s_cbranch_vccz pdone_26
    s_sleep 4
    s_branch poll_25
pdone_26:
c2_seen:
    v_mov_b32 v2, 25360
    v_mov_b32 v3, 1
    s_mov_b64 exec, 1
    ds_add_u32 v2, v3
    s_mov_b64 exec, -1
    v_mov_b32 v2, 25348
    s_mov_b32 s57, 0
lw_27:
    ds_read_b32 v3, v2
    s_add_u32 s57, s57, 1
    s_cmp_ge_u32 s57, 2000000
    s_waitcnt lgkmcnt(0)
    s_cbranch_scc1 lwd_28
    v_cmp_gt_u32 vcc, s49, v3
    s_cbranch_vccnz lw_27
lwd_28:
    s_mul_i32 s60, s53, 286720
    s_add_u32 s60, s60, 6291456
    s_and_b32 s61, s52, 7
    s_mul_i32 s61, s61, 0
    s_lshr_b32 s61, s61, 1
    s_lshl_b32 s62, s61, 12
    s_add_u32 m0, s62, 81920
    s_add_u32 s62, s62, s60
    s_add_u32 s61, s61, 1
    s_cmp_eq_u32 s61, 20
    s_cselect_b32 s61, 0, s61
    buffer_load_dwordx4 v4, s[4:7], s62 offen offset:0 sc1 lds
    buffer_load_dwordx4 v4, s[4:7], s62 offen offset:1024 sc1 lds
    buffer_load_dwordx4 v4, s[4:7], s62 offen offset:2048 sc1 lds
    buffer_load_dwordx4 v4, s[4:7], s62 offen offset:3072 sc1 lds
    s_lshl_b32 s62, s61, 12
    s_add_u32 m0, s62, 81920
    s_add_u32 s62, s62, s60
    s_add_u32 s61, s61, 1
    s_cmp_eq_u32 s61, 20
    s_cselect_b32 s61, 0, s61
    buffer_load_dwordx4 v4, s[4:7], s62 offen offset:0 sc1 lds
    buffer_load_dwordx4 v4, s[4:7], s62 offen offset:1024 sc1 lds
    buffer_load_dwordx4 v4, s[4:7], s62 offen offset:2048 sc1 lds
    buffer_load_dwordx4 v4, s[4:7], s62 offen offset:3072 sc1 lds
    s_lshl_b32 s62, s61, 12
    s_add_u32 m0, s62, 81920
    s_add_u32 s62, s62, s60
    s_add_u32 s61, s61, 1
    s_cmp_eq_u32 s61, 20
    s_cselect_b32 s61, 0, s61
    buffer_load_dwordx4 v4, s[4:7], s62 offen offset:0 sc1 lds
    buffer_load_dwordx4 v4, s[4:7], s62 offen offset:1024 sc1 lds
    buffer_load_dwordx4 v4, s[4:7], s62 offen offset:2048 sc1 lds
    buffer_load_dwordx4 v4, s[4:7], s62 offen offset:3072 sc1 lds
    s_lshl_b32 s62, s61, 12
    s_add_u32 m0, s62, 81920
    s_add_u32 s62, s62, s60
    s_add_u32 s61, s61, 1
    s_cmp_eq_u32 s61, 20
    s_cselect_b32 s61, 0, s61
    buffer_load_dwordx4 v4, s[4:7], s62 offen offset:0 sc1 lds
    buffer_load_dwordx4 v4, s[4:7], s62 offen offset:1024 sc1 lds
    buffer_load_dwordx4 v4, s[4:7], s62 offen offset:2048 sc1 lds
    buffer_load_dwordx4 v4, s[4:7], s62 offen offset:3072 sc1 lds
    s_lshl_b32 s62, s61, 12
    s_add_u32 m0, s62, 81920
    s_add_u32 s62, s62, s60
    s_add_u32 s61, s61, 1
    s_cmp_eq_u32 s61, 20
    s_cselect_b32 s61, 0, s61
    buffer_load_dwordx4 v4, s[4:7], s62 offen offset:0 sc1 lds
    buffer_load_dwordx4 v4, s[4:7], s62 offen offset:1024 sc1 lds
    buffer_load_dwordx4 v4, s[4:7], s62 offen offset:2048 sc1 lds
    buffer_load_dwordx4 v4, s[4:7], s62 offen offset:3072 sc1 lds
    s_lshl_b32 s62, s61, 12
    s_add_u32 m0, s62, 81920
    s_add_u32 s62, s62, s60
    s_add_u32 s61, s61, 1
    s_cmp_eq_u32 s61, 20
    s_cselect_b32 s61, 0, s61
    buffer_load_dwordx4 v4, s[4:7], s62 offen offset:0 sc1 lds
    buffer_load_dwordx4 v4, s[4:7], s62 offen offset:1024 sc1 lds
    buffer_load_dwordx4 v4, s[4:7], s62 offen offset:2048 sc1 lds
    buffer_load_dwordx4 v4, s[4:7], s62 offen offset:3072 sc1 lds
    s_lshl_b32 s62, s61, 12
    s_add_u32 m0, s62, 81920
    s_add_u32 s62, s62, s60
    s_add_u32 s61, s61, 1
    s_cmp_eq_u32 s61, 20
    s_cselect_b32 s61, 0, s61
    buffer_load_dwordx4 v4, s[4:7], s62 offen offset:0 sc1 lds
    buffer_load_dwordx4 v4, s[4:7], s62 offen offset:1024 sc1 lds
    buffer_load_dwordx4 v4, s[4:7], s62 offen offset:2048 sc1 lds
    buffer_load_dwordx4 v4, s[4:7], s62 offen offset:3072 sc1 lds
    s_lshl_b32 s62, s61, 12
    s_add_u32 m0, s62, 81920
    s_add_u32 s62, s62, s60
    s_add_u32 s61, s61, 1
    s_cmp_eq_u32 s61, 20
    s_cselect_b32 s61, 0, s61
    buffer_load_dwordx4 v4, s[4:7], s62 offen offset:0 sc1 lds
    buffer_load_dwordx4 v4, s[4:7], s62 offen offset:1024 sc1 lds
    buffer_load_dwordx4 v4, s[4:7], s62 offen offset:2048 sc1 lds
    buffer_load_dwordx4 v4, s[4:7], s62 offen offset:3072 sc1 lds
    s_lshl_b32 s62, s61, 12
    s_add_u32 m0, s62, 81920
    s_add_u32 s62, s62, s60
    s_add_u32 s61, s61, 1
    s_cmp_eq_u32 s61, 20
    s_cselect_b32 s61, 0, s61
    buffer_load_dwordx4 v4, s[4:7], s62 offen offset:0 sc1 lds
    buffer_load_dwordx4 v4, s[4:7], s62 offen offset:1024 sc1 lds
    buffer_load_dwordx4 v4, s[4:7], s62 offen offset:2048 sc1 lds
    buffer_load_dwordx4 v4, s[4:7], s62 offen offset:3072 sc1 lds
    s_lshl_b32 s62, s61, 12
    s_add_u32 m0, s62, 81920
    s_add_u32 s62, s62, s60
    s_add_u32 s61, s61, 1
    s_cmp_eq_u32 s61, 20
    s_cselect_b32 s61, 0, s61
    buffer_load_dwordx4 v4, s[4:7], s62 offen offset:0 sc1 lds
    buffer_load_dwordx4 v4, s[4:7], s62 offen offset:1024 sc1 lds
    buffer_load_dwordx4 v4, s[4:7], s62 offen offset:2048 sc1 lds
    buffer_load_dwordx4 v4, s[4:7], s62 offen offset:3072 sc1 lds
    s_lshl_b32 s62, s61, 12
    s_add_u32 m0, s62, 81920
    s_add_u32 s62, s62, s60
    s_add_u32 s61, s61, 1
    s_cmp_eq_u32 s61, 20
    s_cselect_b32 s61, 0, s61
    buffer_load_dwordx4 v4, s[4:7], s62 offen offset:0 sc1 lds
    buffer_load_dwordx4 v4, s[4:7], s62 offen offset:1024 sc1 lds
    buffer_load_dwordx4 v4, s[4:7], s62 offen offset:2048 sc1 lds
    buffer_load_dwordx4 v4, s[4:7], s62 offen offset:3072 sc1 lds
    s_lshl_b32 s62, s61, 12
    s_add_u32 m0, s62, 81920
    s_add_u32 s62, s62, s60
    s_add_u32 s61, s61, 1
    s_cmp_eq_u32 s61, 20
    s_cselect_b32 s61, 0, s61
    buffer_load_dwordx4 v4, s[4:7], s62 offen offset:0 sc1 lds
    buffer_load_dwordx4 v4, s[4:7], s62 offen offset:1024 sc1 lds
    buffer_load_dwordx4 v4, s[4:7], s62 offen offset:2048 sc1 lds
    buffer_load_dwordx4 v4, s[4:7], s62 offen offset:3072 sc1 lds
    s_lshl_b32 s62, s61, 12
    s_add_u32 m0, s62, 81920
    s_add_u32 s62, s62, s60
    s_add_u32 s61, s61, 1
    s_cmp_eq_u32 s61, 20
    s_cselect_b32 s61, 0, s61
    buffer_load_dwordx4 v4, s[4:7], s62 offen offset:0 sc1 lds
    buffer_load_dwordx4 v4, s[4:7], s62 offen offset:1024 sc1 lds
    buffer_load_dwordx4 v4, s[4:7], s62 offen offset:2048 sc1 lds
    buffer_load_dwordx4 v4, s[4:7], s62 offen offset:3072 sc1 lds
    s_lshl_b32 s62, s61, 12
    s_add_u32 m0, s62, 81920
    s_add_u32 s62, s62, s60
    s_add_u32 s61, s61, 1
    s_cmp_eq_u32 s61, 20
    s_cselect_b32 s61, 0, s61
    buffer_load_dwordx4 v4, s[4:7], s62 offen offset:0 sc1 lds
    buffer_load_dwordx4 v4, s[4:7], s62 offen offset:1024 sc1 lds
    buffer_load_dwordx4 v4, s[4:7], s62 offen offset:2048 sc1 lds
    buffer_load_dwordx4 v4, s[4:7], s62 offen offset:3072 sc1 lds
    s_waitcnt vmcnt(32)
    s_lshl_b32 s62, s61, 12
    s_add_u32 m0, s62, 81920
    s_add_u32 s62, s62, s60
    s_add_u32 s61, s61, 1
    s_cmp_eq_u32 s61, 20
    s_cselect_b32 s61, 0, s61
    buffer_load_dwordx4 v4, s[4:7], s62 offen offset:0 sc1 lds
    buffer_load_dwordx4 v4, s[4:7], s62 offen offset:1024 sc1 lds
    buffer_load_dwordx4 v4, s[4:7], s62 offen offset:2048 sc1 lds
    buffer_load_dwordx4 v4, s[4:7], s62 offen offset:3072 sc1 lds
    s_lshl_b32 s62, s61, 12
    s_add_u32 m0, s62, 81920
    s_add_u32 s62, s62, s60
    s_add_u32 s61, s61, 1
    s_cmp_eq_u32 s61, 20
    s_cselect_b32 s61, 0, s61
    buffer_load_dwordx4 v4, s[4:7], s62 offen offset:0 sc1 lds
    buffer_load_dwordx4 v4, s[4:7], s62 offen offset:1024 sc1 lds
    buffer_load_dwordx4 v4, s[4:7], s62 offen offset:2048 sc1 lds
    buffer_load_dwordx4 v4, s[4:7], s62 offen offset:3072 sc1 lds
    s_lshl_b32 s62, s61, 12
    s_add_u32 m0, s62, 81920
    s_add_u32 s62, s62, s60
    s_add_u32 s61, s61, 1
    s_cmp_eq_u32 s61, 20
    s_cselect_b32 s61, 0, s61
    buffer_load_dwordx4 v4, s[4:7], s62 offen offset:0 sc1 lds
    buffer_load_dwordx4 v4, s[4:7], s62 offen offset:1024 sc1 lds
    buffer_load_dwordx4 v4, s[4:7], s62 offen offset:2048 sc1 lds
    buffer_load_dwordx4 v4, s[4:7], s62 offen offset:3072 sc1 lds
    s_lshl_b32 s62, s61, 12
    s_add_u32 m0, s62, 81920
    s_add_u32 s62, s62, s60
    s_add_u32 s61, s61, 1
    s_cmp_eq_u32 s61, 20
    s_cselect_b32 s61, 0, s61
    buffer_load_dwordx4 v4, s[4:7], s62 offen offset:0 sc1 lds
    buffer_load_dwordx4 v4, s[4:7], s62 offen offset:1024 sc1 lds
    buffer_load_dwordx4 v4, s[4:7], s62 offen offset:2048 sc1 lds
    buffer_load_dwordx4 v4, s[4:7], s62 offen offset:3072 sc1 lds
    s_lshl_b32 s62, s61, 12
    s_add_u32 m0, s62, 81920
    s_add_u32 s62, s62, s60
    s_add_u32 s61, s61, 1
    s_cmp_eq_u32 s61, 20
    s_cselect_b32 s61, 0, s61
    buffer_load_dwordx4 v4, s[4:7], s62 offen offset:0 sc1 lds
    buffer_load_dwordx4 v4, s[4:7], s62 offen offset:1024 sc1 lds
    buffer_load_dwordx4 v4, s[4:7], s62 offen offset:2048 sc1 lds
    buffer_load_dwordx4 v4, s[4:7], s62 offen offset:3072 sc1 lds
    s_lshl_b32 s62, s61, 12
    s_add_u32 m0, s62, 81920
    s_add_u32 s62, s62, s60
    s_add_u32 s61, s61, 1
    s_cmp_eq_u32 s61, 20
    s_cselect_b32 s61, 0, s61
    buffer_load_dwordx4 v4, s[4:7], s62 offen offset:0 sc1 lds
    buffer_load_dwordx4 v4, s[4:7], s62 offen offset:1024 sc1 lds
    buffer_load_dwordx4 v4, s[4:7], s62 offen offset:2048 sc1 lds
    buffer_load_dwordx4 v4, s[4:7], s62 offen offset:3072 sc1 lds
    s_waitcnt vmcnt(30)
    s_mul_i32 s57, s3, 6
    s_mul_i32 s23, s55, 56
    s_add_u32 s23, s23, s57
    s_mul_i32 s23, s23, 5120
    s_add_u32 s23, s23, 10878976
    s_add_u32 s59, s23, 0
    buffer_load_dwordx4 a[160:163], v4, s[4:7], s59 offen offset:0 sc1
    buffer_load_dwordx4 a[164:167], v4, s[4:7], s59 offen offset:1024 sc1
    buffer_load_dwordx4 a[168:171], v4, s[4:7], s59 offen offset:2048 sc1
    buffer_load_dwordx4 a[172:175], v4, s[4:7], s59 offen offset:3072 sc1
    s_add_u32 s59, s23, 4096
    buffer_load_dwordx4 a[176:179], v4, s[4:7], s59 offen offset:0 sc1
    buffer_load_dwordx4 a[180:183], v4, s[4:7], s59 offen offset:1024 sc1
    buffer_load_dwordx4 a[184:187], v4, s[4:7], s59 offen offset:2048 sc1
    buffer_load_dwordx4 a[188:191], v4, s[4:7], s59 offen offset:3072 sc1
    s_add_u32 s59, s23, 8192
    buffer_load_dwordx4 a[192:195], v4, s[4:7], s59 offen offset:0 sc1
    buffer_load_dwordx4 a[196:199], v4, s[4:7], s59 offen offset:1024 sc1
    buffer_load_dwordx4 a[200:203], v4, s[4:7], s59 offen offset:2048 sc1
    buffer_load_dwordx4 a[204:207], v4, s[4:7], s59 offen offset:3072 sc1
    s_add_u32 s59, s23, 12288
    buffer_load_dwordx4 a[208:211], v4, s[4:7], s59 offen offset:0 sc1
    buffer_load_dwordx4 a[212:215], v4, s[4:7], s59 offen offset:1024 sc1
    buffer_load_dwordx4 a[216:219], v4, s[4:7], s59 offen offset:2048 sc1
    buffer_load_dwordx4 a[220:223], v4, s[4:7], s59 offen offset:3072 sc1
    s_add_u32 s59, s23, 16384
    buffer_load_dwordx4 a[224:227], v4, s[4:7], s59 offen offset:0 sc1
    buffer_load_dwordx4 a[228:231], v4, s[4:7], s59 offen offset:1024 sc1
    buffer_load_dwordx4 a[232:235], v4, s[4:7], s59 offen offset:2048 sc1
    buffer_load_dwordx4 a[236:239], v4, s[4:7], s59 offen offset:3072 sc1
    s_add_u32 s59, s23, 20480
    buffer_load_dwordx4 a[240:243], v4, s[4:7], s59 offen offset:0 sc1
    buffer_load_dwordx4 a[244:247], v4, s[4:7], s59 offen offset:1024 sc1
    buffer_load_dwordx4 a[248:251], v4, s[4:7], s59 offen offset:2048 sc1
    buffer_load_dwordx4 a[252:255], v4, s[4:7], s59 offen offset:3072 sc1
    s_add_u32 s59, s23, 24576
    buffer_load_dwordx4 v[224:227], v4, s[4:7], s59 offen offset:0 sc1
    buffer_load_dwordx4 v[228:231], v4, s[4:7], s59 offen offset:1024 sc1
    buffer_load_dwordx4 v[232:235], v4, s[4:7], s59 offen offset:2048 sc1
    buffer_load_dwordx4 v[236:239], v4, s[4:7], s59 offen offset:3072 sc1
    s_add_u32 s59, s23, 28672
    buffer_load_dwordx4 v[240:243], v4, s[4:7], s59 offen offset:0 sc1
    buffer_load_dwordx4 v[244:247], v4, s[4:7], s59 offen offset:1024 sc1
    s_waitcnt vmcnt(30)
sync2:
    s_lshl_b32 s56, s52, 2
    s_add_u32 s56, s56, s3
    s_mul_i32 s16, s56, 40960
    s_add_u32 s16, s16, 3670016
    s_mul_i32 s17, s3, 16384
    s_mov_b32 m0, s17
    v_lshlrev_b32 v4, 4, v1
    v_and_b32 v6, 15, v1
    v_lshrrev_b32 v7, 4, v1
    v_bfe_u32 v2, v1, 2, 2
    v_and_b32 v3, 3, v1
    v_lshlrev_b32 v2, 6, v2
    v_lshl_add_u32 v2, v3, 3, v2
    v_add_u32 v2, s17, v2
    v_lshl_add_u32 v9, v7, 8, v2
    v_lshrrev_b32 v5, 5, v1
    v_lshl_add_u32 v8, v5, 9, v2
    v_and_b32 v2, 1, v7
    v_lshl_add_u32 v8, v2, 5, v8
    v_add_u32 v10, 81920, v4
    v_add_u32 v11, 122880, v4
    v_and_b32 v13, 31, v1
    v_lshlrev_b32 v13, 4, v13
    v_add_u32 v13, 71680, v13
    v_lshlrev_b32 v15, 4, v6
    v_lshl_add_u32 v15, v5, 8, v15
    v_mul_u32_u24 v14, 25088, v2
    v_add_u32 v14, v14, v15
    v_mul_u32_u24 v5, 33280, v2
    v_add_u32 v15, v5, v15
    s_mul_i32 s18, s53, 286720
    s_mul_i32 s57, s3, 5120
    s_add_u32 s18, s18, s57
    s_add_u32 s18, s18, 6291456
    s_mov_b32 s19, s57
    s_lshl_b32 s56, s56, 1
    s_mul_i32 s20, s56, 25088
    s_add_u32 s20, s20, 17432576
    s_mul_i32 s22, s56, 33280
    s_lshl_b32 s57, s53, 10
    s_add_u32 s22, s22, s57
    s_add_u32 s22, s22, 13172736
    s_add_u32 s39, s22, 16384
    s_mul_i32 s57, s53, 1536
    s_add_u32 s20, s20, s57
    s_mul_i32 s57, s3, 6
    s_lshl_b32 s60, s3, 2
    s_add_u32 s60, s60, 24
    s_mul_i32 s61, s55, 56
    s_add_u32 s23, s61, s57
    s_mul_i32 s23, s23, 5120
    s_add_u32 s23, s23, 10878976
    s_add_u32 s36, s61, s60
    s_mul_i32 s36, s36, 5120
    s_add_u32 s36, s36, 10878976
    s_sub_u32 s38, s60, s57
    s_lshl_b32 s38, s38, 10
    s_lshl_b32 s37, s52, 9
    s_add_u32 s37, s37, 24576
    s_lshl_b32 s40, s98, 9
    s_add_u32 s40, s40, 24576
    s_lshl_b32 s41, s52, 2
    s_add_u32 s41, s41, s3
    s_lshl_b32 s41, s41, 7
    s_add_u32 s41, s41, 253952
    s_cmp_eq_u32 s53, 0
    s_cselect_b32 s41, s41, 0x7f000000
    s_lshr_b32 s44, s2, 3
    s_lshl_b32 s44, s44, 2
    s_add_u32 s44, s44, s3
    s_and_b32 s44, s44, 0
    v_mov_b32 v216, 1
    v_mov_b32 v217, 0
    s_lshl_b32 s58, s98, 1
    s_add_u32 s58, s58, s54
    s_lshl_b32 s58, s58, 2
    s_add_u32 s59, s3, 0
    s_and_b32 s59, s59, 3
    s_add_u32 s59, s59, s58
    s_mul_i32 s61, s59, 33280
    s_lshl_b32 s62, s3, 12
    s_add_u32 s61, s61, s62
    s_add_u32 s12, s61, 13172736
    s_mul_i32 s59, s59, 25088
    s_lshl_b32 s62, s57, 10
    s_add_u32 s59, s59, s62
    s_add_u32 s24, s59, 17432576
    s_add_u32 s59, s3, 1
    s_and_b32 s59, s59, 3
    s_add_u32 s59, s59, s58
    s_mul_i32 s61, s59, 33280
    s_lshl_b32 s62, s3, 12
    s_add_u32 s61, s61, s62
    s_add_u32 s13, s61, 13172736
    s_mul_i32 s59, s59, 25088
    s_lshl_b32 s62, s57, 10
    s_add_u32 s59, s59, s62
    s_add_u32 s25, s59, 17432576
    s_add_u32 s59, s3, 2
    s_and_b32 s59, s59, 3
    s_add_u32 s59, s59, s58
    s_mul_i32 s61, s59, 33280
    s_lshl_b32 s62, s3, 12
    s_add_u32 s61, s61, s62
    s_add_u32 s14, s61, 13172736
    s_mul_i32 s59, s59, 25088
    s_lshl_b32 s62, s57, 10
    s_add_u32 s59, s59, s62
    s_add_u32 s26, s59, 17432576
    s_add_u32 s59, s3, 3
    s_and_b32 s59, s59, 3
    s_add_u32 s59, s59, s58
    s_mul_i32 s61, s59, 33280
    s_lshl_b32 s62, s3, 12
    s_add_u32 s61, s61, s62
    s_add_u32 s15, s61, 13172736
    s_mul_i32 s59, s59, 25088
    s_lshl_b32 s62, s57, 10
    s_add_u32 s59, s59, s62
    s_add_u32 s27, s59, 17432576
    v_cmp_eq_u32 s[28:29], 1, v3
    v_cmp_eq_u32 s[30:31], 2, v3
    v_cmp_eq_u32 s[32:33], 3, v3
    v_cmp_eq_u32 s[34:35], 1, v2
    v_lshrrev_b32 v2, 2, v6
    v_lshl_add_u32 v2, v2, 4, v6
    v_lshlrev_b32 v12, 2, v2
    s_cmp_lg_u32 s3, 0
    s_cbranch_scc1 s2_bar
    v_min_u32 v220, 15, v1
    v_mov_b32 v221, 16
    v_lshlrev_b32 v220, 7, v220
    v_add_u32 v220, 16384, v220
    buffer_load_dword v222, v220, s[4:7], 0 offen sc1
    s_waitcnt vmcnt(0)
    v_cmp_gt_u32 vcc, v221, v222
    s_cbranch_vccz s2_bar
    s_mov_b32 s57, 0
poll_29:
    buffer_load_dword v222, v220, s[4:7], 0 offen sc1
    s_add_u32 s57, s57, 1
    s_cmp_ge_u32 s57, 100000
    s_waitcnt vmcnt(0)
    s_cbranch_scc1 pdone_30
    v_cmp_gt_u32 vcc, v221, v222
    s_cbranch_vccz pdone_30
    s_sleep 2
    s_branch poll_29
pdone_30:
s2_bar:
    s_barrier
    buffer_load_dwordx4 v4, s[4:7], s16 offen offset:0 sc1 lds
    buffer_load_dwordx4 v4, s[4:7], s16 offen offset:1024 sc1 lds
    buffer_load_dwordx4 v4, s[4:7], s16 offen offset:2048 sc1 lds
    buffer_load_dwordx4 v4, s[4:7], s16 offen offset:3072 sc1 lds
    s_add_u32 s57, s16, 4096
    s_add_u32 m0, s17, 4096
    s_nop 0
    buffer_load_dwordx4 v4, s[4:7], s57 offen offset:0 sc1 lds
    buffer_load_dwordx4 v4, s[4:7], s57 offen offset:1024 sc1 lds
    buffer_load_dwordx4 v4, s[4:7], s57 offen offset:2048 sc1 lds
    buffer_load_dwordx4 v4, s[4:7], s57 offen offset:3072 sc1 lds
    s_add_u32 s57, s16, 8192
    s_add_u32 m0, s17, 8192
    s_nop 0
    buffer_load_dwordx4 v4, s[4:7], s57 offen offset:0 sc1 lds
    buffer_load_dwordx4 v4, s[4:7], s57 offen offset:1024 sc1 lds
    buffer_load_dwordx4 v4, s[4:7], s57 offen offset:2048 sc1 lds
    buffer_load_dwordx4 v4, s[4:7], s57 offen offset:3072 sc1 lds
    s_add_u32 s57, s16, 12288
    s_add_u32 m0, s17, 12288
    s_nop 0
    buffer_load_dwordx4 v4, s[4:7], s57 offen offset:0 sc1 lds
    buffer_load_dwordx4 v4, s[4:7], s57 offen offset:1024 sc1 lds
    buffer_load_dwordx4 v4, s[4:7], s57 offen offset:2048 sc1 lds
    buffer_load_dwordx4 v4, s[4:7], s57 offen offset:3072 sc1 lds
    s_waitcnt vmcnt(14)
    ds_read_b64_tr_b16 a[0:1], v8 offset:0
    ds_read_b64_tr_b16 a[2:3], v8 offset:256
    ds_read_b64_tr_b16 a[4:5], v8 offset:1024
    ds_read_b64_tr_b16 a[6:7], v8 offset:1280
    ds_read_b128 v[128:131], v10 offset:0
    ds_read_b128 v[132:135], v10 offset:1024
    ds_read_b128 v[136:139], v10 offset:2048
    ds_read_b128 v[140:143], v10 offset:3072
    ds_read_b128 v[144:147], v10 offset:4096
    ds_read_b128 v[148:151], v10 offset:5120
    s_waitcnt lgkmcnt(3)
    v_mfma_f32_32x32x16_bf16 v[16:31], v[128:131], a[0:3], 0
    ds_read_b128 v[152:155], v10 offset:6144
    s_waitcnt vmcnt(12)
    ds_read_b64_tr_b16 a[8:9], v8 offset:2048
    ds_read_b64_tr_b16 a[10:11], v8 offset:2304
    s_add_u32 s59, s36, 0
    buffer_load_dwordx4 v[248:251], v4, s[4:7], s59 offen offset:0 sc1
    v_mfma_f32_32x32x16_bf16 v[32:47], v[132:135], a[0:3], 0
    ds_read_b128 v[156:159], v10 offset:7168
    ds_read_b64_tr_b16 a[12:13], v8 offset:3072
    ds_read_b64_tr_b16 a[14:15], v8 offset:3328
    v_mfma_f32_32x32x16_bf16 v[16:31], v[136:139], a[4:7], v[16:31]
    ds_read_b128 v[128:131], v10 offset:8192
    ds_read_b64_tr_b16 v[160:161], v9 offset:0
    buffer_load_dwordx4 v[252:255], v4, s[4:7], s59 offen offset:1024 sc1
    s_waitcnt lgkmcnt(8)
    v_mfma_f32_32x32x16_bf16 v[32:47], v[140:143], a[4:7], v[32:47]
    ds_read_b128 v[132:135], v10 offset:9216
    ds_read_b64_tr_b16 v[162:163], v9 offset:1024
    ds_read_b64_tr_b16 v[164:165], v9 offset:32
    s_waitcnt lgkmcnt(8)
    v_mfma_f32_32x32x16_bf16 v[16:31], v[144:147], a[8:11], v[16:31]
    ds_read_b128 v[136:139], v10 offset:10240
    ds_read_b64_tr_b16 v[166:167], v9 offset:1056
    v_mfma_f32_32x32x16_bf16 v[32:47], v[148:151], a[8:11], v[32:47]
    ds_read_b128 v[140:143], v10 offset:11264
    s_waitcnt vmcnt(12)
    ds_read_b64_tr_b16 a[16:17], v8 offset:4096
    ds_read_b64_tr_b16 a[18:19], v8 offset:4352
    s_waitcnt lgkmcnt(10)
    v_mfma_f32_32x32x16_bf16 v[16:31], v[152:155], a[12:15], v[16:31]
    ds_read_b128 v[144:147], v10 offset:12288
    ds_read_b64_tr_b16 a[20:21], v8 offset:5120
    v_mfma_f32_32x32x16_bf16 v[32:47], v[156:159], a[12:15], v[32:47]
    ds_read_b128 v[148:151], v10 offset:13312
    ds_read_b64_tr_b16 a[22:23], v8 offset:5376
    ds_read_b64_tr_b16 v[168:169], v9 offset:2048
    s_waitcnt lgkmcnt(11)
    v_mfma_f32_16x16x32_bf16 v[176:179], v[160:163], v[160:163], 0
    ds_read_b64_tr_b16 v[170:171], v9 offset:3072
    s_waitcnt lgkmcnt(9)
    v_mfma_f32_16x16x32_bf16 v[180:183], v[164:167], v[164:167], 0
    ds_read_b64_tr_b16 v[172:173], v9 offset:2080
    s_waitcnt lgkmcnt(7)
    v_mfma_f32_32x32x16_bf16 v[16:31], v[128:131], a[16:19], v[16:31]
    ds_read_b128 v[152:155], v10 offset:14336
    ds_read_b64_tr_b16 v[174:175], v9 offset:3104
    s_add_u32 s58, s16, 16384
    s_add_u32 m0, s17, 0
    s_nop 0
    buffer_load_dwordx4 v4, s[4:7], s58 offen offset:0 sc1 lds
    v_mfma_f32_32x32x16_bf16 v[32:47], v[132:135], a[16:19], v[32:47]
    ds_read_b128 v[156:159], v10 offset:15360
    s_waitcnt vmcnt(11)
    ds_read_b64_tr_b16 a[24:25], v8 offset:6144
    ds_read_b64_tr_b16 a[26:27], v8 offset:6400
    s_waitcnt lgkmcnt(8)
    v_mfma_f32_32x32x16_bf16 v[16:31], v[136:139], a[20:23], v[16:31]
    ds_read_b128 v[128:131], v10 offset:16384
    ds_read_b64_tr_b16 a[28:29], v8 offset:7168
    buffer_load_dwordx4 v4, s[4:7], s58 offen offset:1024 sc1 lds
    v_mfma_f32_32x32x16_bf16 v[32:47], v[140:143], a[20:23], v[32:47]
    ds_read_b128 v[132:135], v10 offset:17408
    ds_read_b64_tr_b16 a[30:31], v8 offset:7424
    ds_read_b64_tr_b16 v[160:161], v9 offset:4096
    s_waitcnt lgkmcnt(11)
    v_mfma_f32_16x16x32_bf16 v[176:179], v[168:171], v[168:171], v[176:179]
    ds_read_b64_tr_b16 v[162:163], v9 offset:5120
    s_waitcnt lgkmcnt(9)
    v_mfma_f32_16x16x32_bf16 v[180:183], v[172:175], v[172:175], v[180:183]
    ds_read_b64_tr_b16 v[164:165], v9 offset:4128
    s_waitcnt lgkmcnt(7)
    v_mfma_f32_32x32x16_bf16 v[16:31], v[144:147], a[24:27], v[16:31]
    ds_read_b128 v[136:139], v10 offset:18432
    ds_read_b64_tr_b16 v[166:167], v9 offset:5152
    buffer_load_dwordx4 v4, s[4:7], s58 offen offset:2048 sc1 lds
    v_mfma_f32_32x32x16_bf16 v[32:47], v[148:151], a[24:27], v[32:47]
    ds_read_b128 v[140:143], v10 offset:19456
    s_waitcnt vmcnt(11)
    ds_read_b64_tr_b16 a[32:33], v8 offset:8192
    ds_read_b64_tr_b16 a[34:35], v8 offset:8448
    s_waitcnt lgkmcnt(8)
    v_mfma_f32_32x32x16_bf16 v[16:31], v[152:155], a[28:31], v[16:31]
    ds_read_b128 v[144:147], v10 offset:20480
    ds_read_b64_tr_b16 a[36:37], v8 offset:9216
    buffer_load_dwordx4 v4, s[4:7], s58 offen offset:3072 sc1 lds
    v_mfma_f32_32x32x16_bf16 v[32:47], v[156:159], a[28:31], v[32:47]
    ds_read_b128 v[148:151], v10 offset:21504
    ds_read_b64_tr_b16 a[38:39], v8 offset:9472
    ds_read_b64_tr_b16 v[168:169], v9 offset:6144
    s_waitcnt lgkmcnt(11)
    v_mfma_f32_16x16x32_bf16 v[176:179], v[160:163], v[160:163], v[176:179]
    ds_read_b64_tr_b16 v[170:171], v9 offset:7168
    s_waitcnt lgkmcnt(9)
    v_mfma_f32_16x16x32_bf16 v[180:183], v[164:167], v[164:167], v[180:183]
    ds_read_b64_tr_b16 v[172:173], v9 offset:6176
    s_waitcnt lgkmcnt(7)
    v_mfma_f32_32x32x16_bf16 v[16:31], v[128:131], a[32:35], v[16:31]
    ds_read_b128 v[152:155], v10 offset:22528
    ds_read_b64_tr_b16 v[174:175], v9 offset:7200
    s_add_u32 s58, s16, 20480
    s_add_u32 m0, s17, 4096
    s_nop 0
    buffer_load_dwordx4 v4, s[4:7], s58 offen offset:0 sc1 lds
    v_mfma_f32_32x32x16_bf16 v[32:47], v[132:135], a[32:35], v[32:47]
    ds_read_b128 v[156:159], v10 offset:23552
    s_waitcnt vmcnt(11)
    ds_read_b64_tr_b16 a[40:41], v8 offset:10240
    ds_read_b64_tr_b16 a[42:43], v8 offset:10496
    s_waitcnt lgkmcnt(8)
    v_mfma_f32_32x32x16_bf16 v[16:31], v[136:139], a[36:39], v[16:31]
    ds_read_b128 v[128:131], v10 offset:24576
    ds_read_b64_tr_b16 a[44:45], v8 offset:11264
    buffer_load_dwordx4 v4, s[4:7], s58 offen offset:1024 sc1 lds
    v_mfma_f32_32x32x16_bf16 v[32:47], v[140:143], a[36:39], v[32:47]
    ds_read_b128 v[132:135], v10 offset:25600
    ds_read_b64_tr_b16 a[46:47], v8 offset:11520
    ds_read_b64_tr_b16 v[160:161], v9 offset:8192
    s_waitcnt lgkmcnt(11)
    v_mfma_f32_16x16x32_bf16 v[176:179], v[168:171], v[168:171], v[176:179]
    ds_read_b64_tr_b16 v[162:163], v9 offset:9216
    s_waitcnt lgkmcnt(9)
    v_mfma_f32_16x16x32_bf16 v[180:183], v[172:175], v[172:175], v[180:183]
    ds_read_b64_tr_b16 v[164:165], v9 offset:8224
    s_waitcnt lgkmcnt(7)
    v_mfma_f32_32x32x16_bf16 v[16:31], v[144:147], a[40:43], v[16:31]
    ds_read_b128 v[136:139], v10 offset:26624
    ds_read_b64_tr_b16 v[166:167], v9 offset:9248
    buffer_load_dwordx4 v4, s[4:7], s58 offen offset:2048 sc1 lds
    v_mfma_f32_32x32x16_bf16 v[32:47], v[148:151], a[40:43], v[32:47]
    ds_read_b128 v[140:143], v10 offset:27648
    s_waitcnt vmcnt(11)
    ds_read_b64_tr_b16 a[48:49], v8 offset:12288
    ds_read_b64_tr_b16 a[50:51], v8 offset:12544
    s_waitcnt lgkmcnt(8)
    v_mfma_f32_32x32x16_bf16 v[16:31], v[152:155], a[44:47], v[16:31]
    ds_read_b128 v[144:147], v10 offset:28672
    ds_read_b64_tr_b16 a[52:53], v8 offset:13312
    buffer_load_dwordx4 v4, s[4:7], s58 offen offset:3072 sc1 lds
    v_mfma_f32_32x32x16_bf16 v[32:47], v[156:159], a[44:47], v[32:47]
    ds_read_b128 v[148:151], v10 offset:29696
    ds_read_b64_tr_b16 a[54:55], v8 offset:13568
    ds_read_b64_tr_b16 v[168:169], v9 offset:10240
    s_waitcnt lgkmcnt(11)
    v_mfma_f32_16x16x32_bf16 v[176:179], v[160:163], v[160:163], v[176:179]
    ds_read_b64_tr_b16 v[170:171], v9 offset:11264
    s_waitcnt lgkmcnt(9)
    v_mfma_f32_16x16x32_bf16 v[180:183], v[164:167], v[164:167], v[180:183]
    ds_read_b64_tr_b16 v[172:173], v9 offset:10272
    s_waitcnt lgkmcnt(7)
    v_mfma_f32_32x32x16_bf16 v[16:31], v[128:131], a[48:51], v[16:31]
    ds_read_b128 v[152:155], v10 offset:30720
    ds_read_b64_tr_b16 v[174:175], v9 offset:11296
    s_add_u32 s58, s16, 24576
    s_add_u32 m0, s17, 8192
    s_nop 0
    buffer_load_dwordx4 v4, s[4:7], s58 offen offset:0 sc1 lds
    v_mfma_f32_32x32x16_bf16 v[32:47], v[132:135], a[48:51], v[32:47]
    ds_read_b128 v[156:159], v10 offset:31744
    s_waitcnt vmcnt(11)
    ds_read_b64_tr_b16 a[56:57], v8 offset:14336
    ds_read_b64_tr_b16 a[58:59], v8 offset:14592
    s_waitcnt lgkmcnt(8)
    v_mfma_f32_32x32x16_bf16 v[16:31], v[136:139], a[52:55], v[16:31]
    ds_read_b128 v[128:131], v10 offset:32768
    ds_read_b64_tr_b16 a[60:61], v8 offset:15360
    buffer_load_dwordx4 v4, s[4:7], s58 offen offset:1024 sc1 lds
    v_mfma_f32_32x32x16_bf16 v[32:47], v[140:143], a[52:55], v[32:47]
    ds_read_b128 v[132:135], v10 offset:33792
    ds_read_b64_tr_b16 a[62:63], v8 offset:15616
    ds_read_b64_tr_b16 v[160:161], v9 offset:12288
    s_waitcnt lgkmcnt(11)
    v_mfma_f32_16x16x32_bf16 v[176:179], v[168:171], v[168:171], v[176:179]
    ds_read_b64_tr_b16 v[162:163], v9 offset:13312
    s_waitcnt lgkmcnt(9)
    v_mfma_f32_16x16x32_bf16 v[180:183], v[172:175], v[172:175], v[180:183]
    ds_read_b64_tr_b16 v[164:165], v9 offset:12320
    s_waitcnt lgkmcnt(7)
    v_mfma_f32_32x32x16_bf16 v[16:31], v[144:147], a[56:59], v[16:31]
    ds_read_b128 v[136:139], v10 offset:34816
    ds_read_b64_tr_b16 v[166:167], v9 offset:13344
    buffer_load_dwordx4 v4, s[4:7], s58 offen offset:2048 sc1 lds
    v_mfma_f32_32x32x16_bf16 v[32:47], v[148:151], a[56:59], v[32:47]
    ds_read_b128 v[140:143], v10 offset:35840
    s_waitcnt vmcnt(9)
    ds_read_b64_tr_b16 a[64:65], v8 offset:0
    ds_read_b64_tr_b16 a[66:67], v8 offset:256
    s_waitcnt lgkmcnt(8)
    v_mfma_f32_32x32x16_bf16 v[16:31], v[152:155], a[60:63], v[16:31]
    ds_read_b128 v[144:147], v10 offset:36864
    ds_read_b64_tr_b16 a[68:69], v8 offset:1024
    buffer_load_dwordx4 v4, s[4:7], s58 offen offset:3072 sc1 lds
    v_mfma_f32_32x32x16_bf16 v[32:47], v[156:159], a[60:63], v[32:47]
    ds_read_b128 v[148:151], v10 offset:37888
    ds_read_b64_tr_b16 a[70:71], v8 offset:1280
    ds_read_b64_tr_b16 v[168:169], v9 offset:14336
    s_waitcnt lgkmcnt(11)
    v_mfma_f32_16x16x32_bf16 v[176:179], v[160:163], v[160:163], v[176:179]
    ds_read_b64_tr_b16 v[170:171], v9 offset:15360
    s_waitcnt lgkmcnt(9)
    v_mfma_f32_16x16x32_bf16 v[180:183], v[164:167], v[164:167], v[180:183]
    ds_read_b64_tr_b16 v[172:173], v9 offset:14368
    s_waitcnt lgkmcnt(7)
    v_mfma_f32_32x32x16_bf16 v[16:31], v[128:131], a[64:67], v[16:31]
    ds_read_b128 v[152:155], v10 offset:38912
    ds_read_b64_tr_b16 v[174:175], v9 offset:15392
    s_add_u32 s58, s16, 28672
    s_add_u32 m0, s17, 12288
    s_nop 0
    buffer_load_dwordx4 v4, s[4:7], s58 offen offset:0 sc1 lds
    v_mfma_f32_32x32x16_bf16 v[32:47], v[132:135], a[64:67], v[32:47]
    ds_read_b128 v[156:159], v10 offset:39936
    s_waitcnt vmcnt(9)
    ds_read_b64_tr_b16 a[72:73], v8 offset:2048
    ds_read_b64_tr_b16 a[74:75], v8 offset:2304
    s_waitcnt lgkmcnt(8)
    v_mfma_f32_32x32x16_bf16 v[16:31], v[136:139], a[68:71], v[16:31]
    s_barrier
    ds_read_b128 v[128:131], v11 offset:0
    ds_read_b64_tr_b16 a[76:77], v8 offset:3072
    buffer_load_dwordx4 v4, s[4:7], s58 offen offset:1024 sc1 lds
    v_mfma_f32_32x32x16_bf16 v[32:47], v[140:143], a[68:71], v[32:47]
    ds_read_b128 v[132:135], v11 offset:1024
    ds_read_b64_tr_b16 a[78:79], v8 offset:3328
    ds_read_b64_tr_b16 v[160:161], v9 offset:0
    s_waitcnt lgkmcnt(11)
    v_mfma_f32_16x16x32_bf16 v[176:179], v[168:171], v[168:171], v[176:179]
    ds_read_b64_tr_b16 v[162:163], v9 offset:1024
    s_waitcnt lgkmcnt(9)
    v_mfma_f32_16x16x32_bf16 v[180:183], v[172:175], v[172:175], v[180:183]
    ds_read_b64_tr_b16 v[164:165], v9 offset:32
    s_waitcnt lgkmcnt(7)
    v_mfma_f32_32x32x16_bf16 v[16:31], v[144:147], a[72:75], v[16:31]
    ds_read_b128 v[136:139], v11 offset:2048
    ds_read_b64_tr_b16 v[166:167], v9 offset:1056
    buffer_load_dwordx4 v4, s[4:7], s58 offen offset:2048 sc1 lds
    v_mfma_f32_32x32x16_bf16 v[32:47], v[148:151], a[72:75], v[32:47]
    ds_read_b128 v[140:143], v11 offset:3072
    s_waitcnt vmcnt(9)
    ds_read_b64_tr_b16 a[80:81], v8 offset:4096
    ds_read_b64_tr_b16 a[82:83], v8 offset:4352
    s_waitcnt lgkmcnt(8)
    v_mfma_f32_32x32x16_bf16 v[16:31], v[152:155], a[76:79], v[16:31]
    ds_read_b128 v[144:147], v11 offset:4096
    ds_read_b64_tr_b16 a[84:85], v8 offset:5120
    buffer_load_dwordx4 v4, s[4:7], s58 offen offset:3072 sc1 lds
    v_mfma_f32_32x32x16_bf16 v[32:47], v[156:159], a[76:79], v[32:47]
    ds_read_b128 v[148:151], v11 offset:5120
    ds_read_b64_tr_b16 a[86:87], v8 offset:5376
    ds_read_b64_tr_b16 v[168:169], v9 offset:2048
    s_waitcnt lgkmcnt(11)
    v_mfma_f32_16x16x32_bf16 v[176:179], v[160:163], v[160:163], v[176:179]
    ds_read_b64_tr_b16 v[170:171], v9 offset:3072
    s_waitcnt lgkmcnt(9)
    v_mfma_f32_16x16x32_bf16 v[180:183], v[164:167], v[164:167], v[180:183]
    ds_read_b64_tr_b16 v[172:173], v9 offset:2080
    s_waitcnt lgkmcnt(7)
    v_mfma_f32_32x32x16_bf16 v[16:31], v[128:131], a[80:83], v[16:31]
    ds_read_b128 v[152:155], v11 offset:6144
    ds_read_b64_tr_b16 v[174:175], v9 offset:3104
    s_add_u32 s58, s16, 32768
    s_add_u32 m0, s17, 0
    s_nop 0
    buffer_load_dwordx4 v4, s[4:7], s58 offen offset:0 sc1 lds
    v_mfma_f32_32x32x16_bf16 v[32:47], v[132:135], a[80:83], v[32:47]
    ds_read_b128 v[156:159], v11 offset:7168
    s_waitcnt vmcnt(9)
    ds_read_b64_tr_b16 a[88:89], v8 offset:6144
    ds_read_b64_tr_b16 a[90:91], v8 offset:6400
    s_waitcnt lgkmcnt(8)
    v_mfma_f32_32x32x16_bf16 v[16:31], v[136:139], a[84:87], v[16:31]
    ds_read_b128 v[128:131], v11 offset:8192
    ds_read_b64_tr_b16 a[92:93], v8 offset:7168
    buffer_load_dwordx4 v4, s[4:7], s58 offen offset:1024 sc1 lds
    v_mfma_f32_32x32x16_bf16 v[32:47], v[140:143], a[84:87], v[32:47]
    ds_read_b128 v[132:135], v11 offset:9216
    ds_read_b64_tr_b16 a[94:95], v8 offset:7424
    ds_read_b64_tr_b16 v[160:161], v9 offset:4096
    s_waitcnt lgkmcnt(11)
    v_mfma_f32_16x16x32_bf16 v[176:179], v[168:171], v[168:171], v[176:179]
    ds_read_b64_tr_b16 v[162:163], v9 offset:5120
    s_waitcnt lgkmcnt(9)
    v_mfma_f32_16x16x32_bf16 v[180:183], v[172:175], v[172:175], v[180:183]
    ds_read_b64_tr_b16 v[164:165], v9 offset:4128
    s_waitcnt lgkmcnt(7)
    v_mfma_f32_32x32x16_bf16 v[16:31], v[144:147], a[88:91], v[16:31]
    ds_read_b128 v[136:139], v11 offset:10240
    ds_read_b64_tr_b16 v[166:167], v9 offset:5152
    buffer_load_dwordx4 v4, s[4:7], s58 offen offset:2048 sc1 lds
    v_mfma_f32_32x32x16_bf16 v[32:47], v[148:151], a[88:91], v[32:47]
    ds_read_b128 v[140:143], v11 offset:11264
    s_waitcnt vmcnt(9)
    ds_read_b64_tr_b16 a[96:97], v8 offset:8192
    ds_read_b64_tr_b16 a[98:99], v8 offset:8448
    s_waitcnt lgkmcnt(8)
    v_mfma_f32_32x32x16_bf16 v[16:31], v[152:155], a[92:95], v[16:31]
    ds_read_b128 v[144:147], v11 offset:12288
    ds_read_b64_tr_b16 a[100:101], v8 offset:9216
    buffer_load_dwordx4 v4, s[4:7], s58 offen offset:3072 sc1 lds
    v_mfma_f32_32x32x16_bf16 v[32:47], v[156:159], a[92:95], v[32:47]
    ds_read_b128 v[148:151], v11 offset:13312
    ds_read_b64_tr_b16 a[102:103], v8 offset:9472
    ds_read_b64_tr_b16 v[168:169], v9 offset:6144
    s_waitcnt lgkmcnt(11)
    v_mfma_f32_16x16x32_bf16 v[176:179], v[160:163], v[160:163], v[176:179]
    ds_read_b64_tr_b16 v[170:171], v9 offset:7168
    s_waitcnt lgkmcnt(9)
    v_mfma_f32_16x16x32_bf16 v[180:183], v[164:167], v[164:167], v[180:183]
    ds_read_b64_tr_b16 v[172:173], v9 offset:6176
    s_waitcnt lgkmcnt(7)
    v_mfma_f32_32x32x16_bf16 v[16:31], v[128:131], a[96:99], v[16:31]
    ds_read_b128 v[152:155], v11 offset:14336
    ds_read_b64_tr_b16 v[174:175], v9 offset:7200
    s_add_u32 s58, s16, 36864
    s_add_u32 m0, s17, 4096
    s_nop 0
    buffer_load_dwordx4 v4, s[4:7], s58 offen offset:0 sc1 lds
    v_mfma_f32_32x32x16_bf16 v[32:47], v[132:135], a[96:99], v[32:47]
    ds_read_b128 v[156:159], v11 offset:15360
    s_waitcnt vmcnt(9)
    ds_read_b64_tr_b16 a[104:105], v8 offset:10240
    ds_read_b64_tr_b16 a[106:107], v8 offset:10496
    s_waitcnt lgkmcnt(8)
    v_mfma_f32_32x32x16_bf16 v[16:31], v[136:139], a[100:103], v[16:31]
    ds_read_b128 v[128:131], v11 offset:16384
    ds_read_b64_tr_b16 a[108:109], v8 offset:11264
    buffer_load_dwordx4 v4, s[4:7], s58 offen offset:1024 sc1 lds
    v_mfma_f32_32x32x16_bf16 v[32:47], v[140:143], a[100:103], v[32:47]
    ds_read_b128 v[132:135], v11 offset:17408
    ds_read_b64_tr_b16 a[110:111], v8 offset:11520
    ds_read_b64_tr_b16 v[160:161], v9 offset:8192
    s_waitcnt lgkmcnt(11)
    v_mfma_f32_16x16x32_bf16 v[176:179], v[168:171], v[168:171], v[176:179]
    ds_read_b64_tr_b16 v[162:163], v9 offset:9216
    s_waitcnt lgkmcnt(9)
    v_mfma_f32_16x16x32_bf16 v[180:183], v[172:175], v[172:175], v[180:183]
    ds_read_b64_tr_b16 v[164:165], v9 offset:8224
    s_waitcnt lgkmcnt(7)
    v_mfma_f32_32x32x16_bf16 v[16:31], v[144:147], a[104:107], v[16:31]
    ds_read_b128 v[136:139], v11 offset:18432
    ds_read_b64_tr_b16 v[166:167], v9 offset:9248
    buffer_load_dwordx4 v4, s[4:7], s58 offen offset:2048 sc1 lds
    v_mfma_f32_32x32x16_bf16 v[32:47], v[148:151], a[104:107], v[32:47]
    ds_read_b128 v[140:143], v11 offset:19456
    s_waitcnt vmcnt(9)
    ds_read_b64_tr_b16 a[112:113], v8 offset:12288
    ds_read_b64_tr_b16 a[114:115], v8 offset:12544
    s_waitcnt lgkmcnt(8)
    v_mfma_f32_32x32x16_bf16 v[16:31], v[152:155], a[108:111], v[16:31]
    s_barrier
    ds_read_b128 v[144:147], v11 offset:20480
    ds_read_b64_tr_b16 a[116:117], v8 offset:13312
    buffer_load_dwordx4 v4, s[4:7], s58 offen offset:3072 sc1 lds
    v_mfma_f32_32x32x16_bf16 v[32:47], v[156:159], a[108:111], v[32:47]
    ds_read_b128 v[148:151], v11 offset:21504
    ds_read_b64_tr_b16 a[118:119], v8 offset:13568
    ds_read_b64_tr_b16 v[168:169], v9 offset:10240
    s_waitcnt lgkmcnt(11)
    v_mfma_f32_16x16x32_bf16 v[176:179], v[160:163], v[160:163], v[176:179]
    ds_read_b64_tr_b16 v[170:171], v9 offset:11264
    s_waitcnt lgkmcnt(9)
    v_mfma_f32_16x16x32_bf16 v[180:183], v[164:167], v[164:167], v[180:183]
    ds_read_b64_tr_b16 v[172:173], v9 offset:10272
    s_waitcnt lgkmcnt(7)
    v_mfma_f32_32x32x16_bf16 v[16:31], v[128:131], a[112:115], v[16:31]
    ds_read_b128 v[152:155], v11 offset:22528
    ds_read_b64_tr_b16 v[174:175], v9 offset:11296
    s_add_u32 s56, s18, 81920
    s_add_u32 m0, s19, 81920
    s_nop 0
    buffer_load_dwordx4 v4, s[4:7], s56 offen offset:0 sc1 lds
    v_mfma_f32_32x32x16_bf16 v[32:47], v[132:135], a[112:115], v[32:47]
    ds_read_b128 v[156:159], v11 offset:23552
    s_waitcnt vmcnt(9)
    ds_read_b64_tr_b16 a[120:121], v8 offset:14336
    ds_read_b64_tr_b16 a[122:123], v8 offset:14592
    s_waitcnt lgkmcnt(8)
    v_mfma_f32_32x32x16_bf16 v[16:31], v[136:139], a[116:119], v[16:31]
    ds_read_b128 v[128:131], v11 offset:24576
    ds_read_b64_tr_b16 a[124:125], v8 offset:15360
    buffer_load_dwordx4 v4, s[4:7], s56 offen offset:1024 sc1 lds
    v_mfma_f32_32x32x16_bf16 v[32:47], v[140:143], a[116:119], v[32:47]
    ds_read_b128 v[132:135], v11 offset:25600
    ds_read_b64_tr_b16 a[126:127], v8 offset:15616
    ds_read_b64_tr_b16 v[160:161], v9 offset:12288
    s_waitcnt lgkmcnt(11)
    v_mfma_f32_16x16x32_bf16 v[176:179], v[168:171], v[168:171], v[176:179]
    ds_read_b64_tr_b16 v[162:163], v9 offset:13312
    s_waitcnt lgkmcnt(9)
    v_mfma_f32_16x16x32_bf16 v[180:183], v[172:175], v[172:175], v[180:183]
    ds_read_b64_tr_b16 v[164:165], v9 offset:12320
    s_waitcnt lgkmcnt(7)
    v_mfma_f32_32x32x16_bf16 v[16:31], v[144:147], a[120:123], v[16:31]
    ds_read_b128 v[136:139], v11 offset:26624
    ds_read_b64_tr_b16 v[166:167], v9 offset:13344
    buffer_load_dwordx4 v4, s[4:7], s56 offen offset:2048 sc1 lds
    v_mfma_f32_32x32x16_bf16 v[32:47], v[148:151], a[120:123], v[32:47]
    ds_read_b128 v[140:143], v11 offset:27648
    s_waitcnt vmcnt(9)
    ds_read_b64_tr_b16 a[128:129], v8 offset:0
    ds_read_b64_tr_b16 a[130:131], v8 offset:256
    s_waitcnt lgkmcnt(8)
    v_mfma_f32_32x32x16_bf16 v[16:31], v[152:155], a[124:127], v[16:31]
    ds_read_b128 v[144:147], v11 offset:28672
    ds_read_b64_tr_b16 a[132:133], v8 offset:1024
    buffer_load_dwordx4 v4, s[4:7], s56 offen offset:3072 sc1 lds
    v_mfma_f32_32x32x16_bf16 v[32:47], v[156:159], a[124:127], v[32:47]
    ds_read_b128 v[148:151], v11 offset:29696
    ds_read_b64_tr_b16 a[134:135], v8 offset:1280
    ds_read_b64_tr_b16 v[168:169], v9 offset:14336
    s_waitcnt lgkmcnt(11)
    v_mfma_f32_16x16x32_bf16 v[176:179], v[160:163], v[160:163], v[176:179]
    ds_read_b64_tr_b16 v[170:171], v9 offset:15360
    s_waitcnt lgkmcnt(9)
    v_mfma_f32_16x16x32_bf16 v[180:183], v[164:167], v[164:167], v[180:183]
    ds_read_b64_tr_b16 v[172:173], v9 offset:14368
    s_waitcnt lgkmcnt(7)
    v_mfma_f32_32x32x16_bf16 v[16:31], v[128:131], a[128:131], v[16:31]
    ds_read_b128 v[152:155], v11 offset:30720
    ds_read_b64_tr_b16 v[174:175], v9 offset:15392
    s_add_u32 s56, s18, 86016
    s_add_u32 m0, s19, 86016
    s_nop 0
    buffer_load_dwordx4 v4, s[4:7], s56 offen offset:0 sc1 lds
    v_mfma_f32_32x32x16_bf16 v[32:47], v[132:135], a[128:131], v[32:47]
    ds_read_b128 v[156:159], v11 offset:31744
    s_waitcnt vmcnt(9)
    ds_read_b64_tr_b16 a[136:137], v8 offset:2048
    ds_read_b64_tr_b16 a[138:139], v8 offset:2304
    s_waitcnt lgkmcnt(8)
    v_mfma_f32_32x32x16_bf16 v[16:31], v[136:139], a[132:135], v[16:31]
    ds_read_b128 v[128:131], v11 offset:32768
    ds_read_b64_tr_b16 a[140:141], v8 offset:3072
    s_add_u32 s56, s18, 102400
    s_add_u32 m0, s19, 102400
    s_nop 0
    buffer_load_dwordx4 v4, s[4:7], s56 offen offset:0 sc1 lds
    v_mfma_f32_32x32x16_bf16 v[32:47], v[140:143], a[132:135], v[32:47]
    ds_read_b128 v[132:135], v11 offset:33792
    ds_read_b64_tr_b16 a[142:143], v8 offset:3328
    ds_read_b64_tr_b16 v[160:161], v9 offset:0
    s_waitcnt lgkmcnt(11)
    v_mfma_f32_16x16x32_bf16 v[176:179], v[168:171], v[168:171], v[176:179]
    ds_read_b64_tr_b16 v[162:163], v9 offset:1024
    s_waitcnt lgkmcnt(9)
    v_mfma_f32_16x16x32_bf16 v[180:183], v[172:175], v[172:175], v[180:183]
    ds_read_b64_tr_b16 v[164:165], v9 offset:32
    s_waitcnt lgkmcnt(7)
    v_mfma_f32_32x32x16_bf16 v[16:31], v[144:147], a[136:139], v[16:31]
    ds_read_b128 v[136:139], v11 offset:34816
    ds_read_b64_tr_b16 v[166:167], v9 offset:1056
    buffer_load_dwordx4 v4, s[4:7], s56 offen offset:1024 sc1 lds
    v_mfma_f32_32x32x16_bf16 v[32:47], v[148:151], a[136:139], v[32:47]
    ds_read_b128 v[140:143], v11 offset:35840
    s_waitcnt vmcnt(9)
    ds_read_b64_tr_b16 a[144:145], v8 offset:4096
    ds_read_b64_tr_b16 a[146:147], v8 offset:4352
    s_waitcnt lgkmcnt(8)
    v_mfma_f32_32x32x16_bf16 v[16:31], v[152:155], a[140:143], v[16:31]
    ds_read_b128 v[144:147], v11 offset:36864
    ds_read_b64_tr_b16 a[148:149], v8 offset:5120
    buffer_load_dwordx4 v4, s[4:7], s56 offen offset:2048 sc1 lds
    v_mfma_f32_32x32x16_bf16 v[32:47], v[156:159], a[140:143], v[32:47]
    ds_read_b128 v[148:151], v11 offset:37888
    ds_read_b64_tr_b16 a[150:151], v8 offset:5376
    ds_read_b64_tr_b16 v[168:169], v9 offset:2048
    s_waitcnt lgkmcnt(11)
    v_mfma_f32_16x16x32_bf16 v[176:179], v[160:163], v[160:163], v[176:179]
    ds_read_b64_tr_b16 v[170:171], v9 offset:3072
    s_waitcnt lgkmcnt(9)
    v_mfma_f32_16x16x32_bf16 v[180:183], v[164:167], v[164:167], v[180:183]
    ds_read_b64_tr_b16 v[172:173], v9 offset:2080
    s_waitcnt lgkmcnt(7)
    v_mfma_f32_32x32x16_bf16 v[16:31], v[128:131], a[144:147], v[16:31]
    ds_read_b128 v[152:155], v11 offset:38912
    ds_read_b64_tr_b16 v[174:175], v9 offset:3104
    buffer_load_dwordx4 v4, s[4:7], s56 offen offset:3072 sc1 lds
    v_mfma_f32_32x32x16_bf16 v[32:47], v[132:135], a[144:147], v[32:47]
    ds_read_b128 v[156:159], v11 offset:39936
    s_waitcnt vmcnt(9)
    ds_read_b64_tr_b16 a[152:153], v8 offset:6144
    ds_read_b64_tr_b16 a[154:155], v8 offset:6400
    s_waitcnt lgkmcnt(8)
    v_mfma_f32_32x32x16_bf16 v[16:31], v[136:139], a[148:151], v[16:31]
    s_waitcnt vmcnt(4)
    s_barrier
    ds_read_b128 v[128:131], v10 offset:0
    ds_read_b64_tr_b16 a[156:157], v8 offset:7168
    s_add_u32 s56, s18, 106496
    s_add_u32 m0, s19, 106496
    s_nop 0
    buffer_load_dwordx4 v4, s[4:7], s56 offen offset:0 sc1 lds
    v_mfma_f32_32x32x16_bf16 v[32:47], v[140:143], a[148:151], v[32:47]
    ds_read_b128 v[132:135], v10 offset:1024
    ds_read_b64_tr_b16 a[158:159], v8 offset:7424
    ds_read_b64_tr_b16 v[160:161], v9 offset:4096
    s_waitcnt lgkmcnt(11)
    v_mfma_f32_16x16x32_bf16 v[176:179], v[168:171], v[168:171], v[176:179]
    ds_read_b64_tr_b16 v[162:163], v9 offset:5120
    s_waitcnt lgkmcnt(9)
    v_mfma_f32_16x16x32_bf16 v[180:183], v[172:175], v[172:175], v[180:183]
    ds_read_b64_tr_b16 v[164:165], v9 offset:4128
    s_waitcnt lgkmcnt(7)
    v_mfma_f32_32x32x16_bf16 v[16:31], v[144:147], a[152:155], v[16:31]
    ds_read_b128 v[136:139], v10 offset:2048
    ds_read_b64_tr_b16 v[166:167], v9 offset:5152
    s_add_u32 s56, s18, 122880
    s_add_u32 m0, s19, 122880
    s_nop 0
    buffer_load_dwordx4 v4, s[4:7], s56 offen offset:0 sc1 lds
    v_mfma_f32_32x32x16_bf16 v[32:47], v[148:151], a[152:155], v[32:47]
    ds_read_b128 v[140:143], v10 offset:3072
    ds_read_b64_tr_b16 v[168:169], v9 offset:6144
    ds_read_b64_tr_b16 v[170:171], v9 offset:7168
    s_waitcnt lgkmcnt(8)
    v_mfma_f32_32x32x16_bf16 v[16:31], v[152:155], a[156:159], v[16:31]
    ds_read_b128 v[144:147], v10 offset:4096
    ds_read_b64_tr_b16 v[172:173], v9 offset:6176
    buffer_load_dwordx4 v4, s[4:7], s56 offen offset:1024 sc1 lds
    v_mfma_f32_32x32x16_bf16 v[32:47], v[156:159], a[156:159], v[32:47]
    ds_read_b128 v[148:151], v10 offset:5120
    ds_read_b64_tr_b16 v[174:175], v9 offset:7200
    s_waitcnt lgkmcnt(10)
    v_mfma_f32_16x16x32_bf16 v[176:179], v[160:163], v[160:163], v[176:179]
    s_waitcnt lgkmcnt(7)
    v_mfma_f32_16x16x32_bf16 v[180:183], v[164:167], v[164:167], v[180:183]
    v_mfma_f32_32x32x16_bf16 v[48:63], v[128:131], a[0:3], 0
    ds_read_b128 v[152:155], v10 offset:6144
    buffer_load_dwordx4 v4, s[4:7], s56 offen offset:2048 sc1 lds
    v_mfma_f32_32x32x16_bf16 v[48:63], v[132:135], a[4:7], v[48:63]
    ds_read_b128 v[156:159], v10 offset:7168
    v_mfma_f32_32x32x16_bf16 v[48:63], v[136:139], a[8:11], v[48:63]
    ds_read_b128 v[128:131], v10 offset:8192
    buffer_load_dwordx4 v4, s[4:7], s56 offen offset:3072 sc1 lds
    s_waitcnt lgkmcnt(7)
    v_mfma_f32_16x16x32_bf16 v[176:179], v[168:171], v[168:171], v[176:179]
    s_waitcnt lgkmcnt(3)
    v_mfma_f32_16x16x32_bf16 v[180:183], v[172:175], v[172:175], v[180:183]
    v_mfma_f32_32x32x16_bf16 v[48:63], v[140:143], a[12:15], v[48:63]
    ds_read_b128 v[132:135], v10 offset:9216
    v_mfma_f32_32x32x16_bf16 v[48:63], v[144:147], a[16:19], v[48:63]
    ds_read_b128 v[136:139], v10 offset:10240
    s_add_u32 s56, s18, 126976
    s_add_u32 m0, s19, 126976
    s_nop 0
    buffer_load_dwordx4 v4, s[4:7], s56 offen offset:0 sc1 lds
    v_mfma_f32_32x32x16_bf16 v[48:63], v[148:151], a[20:23], v[48:63]
    ds_read_b128 v[140:143], v10 offset:11264
    v_cndmask_b32 v192, v176, v177, s[28:29]
    v_cndmask_b32 v192, v192, v178, s[30:31]
    v_cndmask_b32 v192, v192, v179, s[32:33]
    ds_bpermute_b32 v194, v12, v192
    s_waitcnt lgkmcnt(4)
    v_mfma_f32_32x32x16_bf16 v[48:63], v[152:155], a[24:27], v[48:63]
    ds_read_b128 v[144:147], v10 offset:12288
    v_cndmask_b32 v193, v180, v181, s[28:29]
    v_cndmask_b32 v193, v193, v182, s[30:31]
    v_cndmask_b32 v193, v193, v183, s[32:33]
    ds_bpermute_b32 v195, v12, v193
    v_mfma_f32_32x32x16_bf16 v[48:63], v[156:159], a[28:31], v[48:63]
    ds_read_b128 v[148:151], v10 offset:13312
    v_mov_b32 v196, v20
    v_mov_b32 v197, v20
    v_lshlrev_b32 v199, 2, v1
    v_mfma_f32_32x32x16_bf16 v[48:63], v[128:131], a[32:35], v[48:63]
    ds_read_b128 v[152:155], v10 offset:14336
    v_and_b32 v199, 0x7f, v199
    v_permlane32_swap_b32 v196, v197
    v_mul_f32 v197, 0x3acccccd, v197
    s_waitcnt lgkmcnt(2)
    v_cndmask_b32 v194, v194, v195, s[34:35]
    v_mfma_f32_32x32x16_bf16 v[48:63], v[132:135], a[36:39], v[48:63]
    ds_read_b128 v[156:159], v10 offset:15360
    v_mul_f32 v194, 0x3acccccd, v194
    v_fma_f32 v194, -v197, v197, v194
    v_max_f32 v194, 0, v194
    v_cvt_pk_bf16_f32 v194, v194, v194
    v_cvt_pk_bf16_f32 v185, -v197, -v197
    v_mfma_f32_32x32x16_bf16 v[48:63], v[136:139], a[40:43], v[48:63]
    ds_read_b128 v[128:131], v10 offset:16384
    v_lshlrev_b32 v194, 16, v194
    v_add_f32 v194, 0x3727c5ac, v194
    v_cvt_pk_bf16_f32 v194, v194, v194
    v_lshlrev_b32 v194, 16, v194
    v_sqrt_f32 v194, v194
    v_mfma_f32_32x32x16_bf16 v[48:63], v[140:143], a[44:47], v[48:63]
    ds_read_b128 v[132:135], v10 offset:17408
    v_mov_b32 v186, 0
    v_cvt_pk_bf16_f32 v184, v194, v194
    v_mov_b32 v187, 0
    v_lshlrev_b32 v194, 16, v184
    v_mfma_f32_32x32x16_bf16 v[48:63], v[144:147], a[48:51], v[48:63]
    ds_read_b128 v[136:139], v10 offset:18432
    v_rcp_f32 v194, v194
    s_mov_b32 exec_lo, 0
    v_mov_b32 v184, 0
    v_mov_b32 v185, 0
    s_mov_b32 exec_lo, -1
    s_waitcnt lgkmcnt(3)
    v_mfma_f32_32x32x16_bf16 v[48:63], v[148:151], a[52:55], v[48:63]
    ds_read_b128 v[140:143], v10 offset:19456
    v_mul_f32 v188, 0xc0135761, v194
    v_mul_f32 v195, v194, v194
    v_mul_f32 v189, 0x3d372713, v195
    v_mul_f32 v189, v189, v188
    s_mov_b32 exec_hi, 0
    buffer_store_dword v195, v199, s[4:7], s41 offen sc1
    s_mov_b32 exec_hi, -1
    v_mfma_f32_32x32x16_bf16 v[48:63], v[152:155], a[56:59], v[48:63]
    ds_read_b128 v[144:147], v13 offset:3072
    buffer_load_dwordx4 v[160:163], v4, s[4:7], s59 offen offset:2048 sc1
    v_mfma_f32_32x32x16_bf16 v[48:63], v[156:159], a[60:63], v[48:63]
    ds_read_b128 v[148:151], v13 offset:0
    s_waitcnt lgkmcnt(3)
    v_mfma_f32_32x32x16_bf16 v[48:63], v[128:131], a[64:67], v[48:63]
    s_waitcnt vmcnt(7)
    s_barrier
    ds_read_b128 v[152:155], v10 offset:20480
    s_add_u32 s56, s18, 143360
    s_add_u32 m0, s19, 143360
    s_nop 0
    buffer_load_dwordx4 v4, s[4:7], s56 offen offset:0 sc1 lds
    v_mfma_f32_32x32x16_bf16 v[48:63], v[132:135], a[68:71], v[48:63]
    ds_read_b128 v[156:159], v10 offset:21504
    v_mfma_f32_32x32x16_bf16 v[48:63], v[136:139], a[72:75], v[48:63]
    ds_read_b128 v[128:131], v10 offset:22528
    buffer_load_dwordx4 v4, s[4:7], s56 offen offset:1024 sc1 lds
    s_waitcnt lgkmcnt(3)
    v_mfma_f32_32x32x16_bf16 v[48:63], v[140:143], a[76:79], v[48:63]
    ds_read_b128 v[132:135], v10 offset:23552
    v_mfma_f32_32x32x16_bf16 v[16:31], v[144:147], v[184:187], v[16:31]
    ds_read_b128 v[136:139], v10 offset:24576
    buffer_load_dwordx4 v4, s[4:7], s56 offen offset:2048 sc1 lds
    v_mfma_f32_32x32x16_bf16 v[32:47], v[148:151], v[184:187], v[32:47]
    ds_read_b128 v[140:143], v10 offset:25600
    s_waitcnt lgkmcnt(3)
    v_mfma_f32_32x32x16_bf16 v[48:63], v[152:155], a[80:83], v[48:63]
    ds_read_b128 v[144:147], v10 offset:26624
    buffer_load_dwordx4 v4, s[4:7], s56 offen offset:3072 sc1 lds
    v_mfma_f32_32x32x16_bf16 v[48:63], v[156:159], a[84:87], v[48:63]
    ds_read_b128 v[148:151], v10 offset:27648
    v_mfma_f32_32x32x16_bf16 v[48:63], v[128:131], a[88:91], v[48:63]
    ds_read_b128 v[152:155], v10 offset:28672
    s_add_u32 s56, s18, 147456
    s_add_u32 m0, s19, 147456
    s_nop 0
    buffer_load_dwordx4 v4, s[4:7], s56 offen offset:0 sc1 lds
    v_mul_f32 v192, v16, v16
    v_mul_f32 v193, v17, v17
    s_waitcnt lgkmcnt(3)
    v_mfma_f32_32x32x16_bf16 v[48:63], v[132:135], a[92:95], v[48:63]
    ds_read_b128 v[156:159], v10 offset:29696
    v_mul_f32 v194, v18, v18
    v_mul_f32 v195, v19, v19
    v_mul_f32 v196, v20, v20
    v_mul_f32 v197, v21, v21
    v_mul_f32 v198, v22, v22
    v_mfma_f32_32x32x16_bf16 v[48:63], v[136:139], a[96:99], v[48:63]
    ds_read_b128 v[128:131], v10 offset:30720
    buffer_load_dwordx4 v[164:167], v4, s[4:7], s59 offen offset:3072 sc1
    v_mul_f32 v199, v23, v23
    v_fma_f32 v192, v192, v189, v188
    v_fma_f32 v193, v193, v189, v188
    v_fma_f32 v194, v194, v189, v188
    v_mfma_f32_32x32x16_bf16 v[48:63], v[140:143], a[100:103], v[48:63]
    ds_read_b128 v[132:135], v10 offset:31744
    v_fma_f32 v195, v195, v189, v188
    v_fma_f32 v196, v196, v189, v188
    v_fma_f32 v197, v197, v189, v188
    v_fma_f32 v198, v198, v189, v188
    v_fma_f32 v199, v199, v189, v188
    s_waitcnt lgkmcnt(3)
    v_mfma_f32_32x32x16_bf16 v[48:63], v[144:147], a[104:107], v[48:63]
    ds_read_b128 v[136:139], v10 offset:32768
    s_add_u32 s59, s36, 4096
    buffer_load_dwordx4 v[168:171], v4, s[4:7], s59 offen offset:0 sc1
    v_mul_f32 v192, v192, v16
    v_mul_f32 v193, v193, v17
    v_mul_f32 v194, v194, v18
    v_mfma_f32_32x32x16_bf16 v[48:63], v[148:151], a[108:111], v[48:63]
    ds_read_b128 v[140:143], v10 offset:33792
    v_mul_f32 v195, v195, v19
    v_mul_f32 v196, v196, v20
    v_mul_f32 v197, v197, v21
    v_mul_f32 v198, v198, v22
    v_mul_f32 v199, v199, v23
    v_mfma_f32_32x32x16_bf16 v[48:63], v[152:155], a[112:115], v[48:63]
    ds_read_b128 v[144:147], v10 offset:34816
    buffer_load_dwordx4 v[172:175], v4, s[4:7], s59 offen offset:1024 sc1
    v_exp_f32 v192, v192
    v_mul_f32 v24, v16, v24
    v_exp_f32 v193, v193
    s_waitcnt lgkmcnt(3)
    v_mfma_f32_32x32x16_bf16 v[48:63], v[156:159], a[116:119], v[48:63]
    ds_read_b128 v[148:151], v10 offset:35840
    v_mul_f32 v25, v17, v25
    v_exp_f32 v194, v194
    v_mul_f32 v26, v18, v26
    v_mfma_f32_32x32x16_bf16 v[48:63], v[128:131], a[120:123], v[48:63]
    ds_read_b128 v[152:155], v10 offset:36864
    buffer_load_dwordx4 v[176:179], v4, s[4:7], s59 offen offset:2048 sc1
    v_exp_f32 v195, v195
    v_mul_f32 v27, v19, v27
    v_exp_f32 v196, v196
    v_mfma_f32_32x32x16_bf16 v[48:63], v[132:135], a[124:127], v[48:63]
    ds_read_b128 v[156:159], v10 offset:37888
    v_mul_f32 v28, v20, v28
    v_exp_f32 v197, v197
    v_mul_f32 v29, v21, v29
    s_waitcnt lgkmcnt(3)
    v_mfma_f32_32x32x16_bf16 v[48:63], v[136:139], a[128:131], v[48:63]
    ds_read_b128 v[128:131], v10 offset:38912
    buffer_load_dwordx4 v[180:183], v4, s[4:7], s59 offen offset:3072 sc1
    v_exp_f32 v198, v198
    v_mul_f32 v30, v22, v30
    v_exp_f32 v199, v199
    v_mfma_f32_32x32x16_bf16 v[48:63], v[140:143], a[132:135], v[48:63]
    ds_read_b128 v[132:135], v10 offset:39936
    v_mul_f32 v31, v23, v31
    v_add_f32 v192, 1.0, v192
    v_add_f32 v193, 1.0, v193
    v_add_f32 v194, 1.0, v194
    v_mfma_f32_32x32x16_bf16 v[48:63], v[144:147], a[136:139], v[48:63]
    ds_read_b128 v[136:139], v13 offset:512
    v_add_f32 v195, 1.0, v195
    v_add_f32 v196, 1.0, v196
    v_add_f32 v197, 1.0, v197
    v_add_f32 v198, 1.0, v198
    v_add_f32 v199, 1.0, v199
    s_waitcnt lgkmcnt(3)
    v_mfma_f32_32x32x16_bf16 v[48:63], v[148:151], a[140:143], v[48:63]
    s_waitcnt vmcnt(12)
    s_barrier
    ds_read_b128 v[140:143], v11 offset:0
    s_add_u32 s56, s18, 163840
    s_add_u32 m0, s19, 81920
    s_nop 0
    buffer_load_dwordx4 v4, s[4:7], s56 offen offset:0 sc1 lds
    v_mfma_f32_32x32x16_bf16 v[48:63], v[152:155], a[144:147], v[48:63]
    ds_read_b128 v[144:147], v11 offset:1024
    v_rcp_f32 v192, v192
    v_rcp_f32 v193, v193
    v_rcp_f32 v194, v194
    v_mfma_f32_32x32x16_bf16 v[48:63], v[156:159], a[148:151], v[48:63]
    ds_read_b128 v[148:151], v11 offset:2048
    buffer_load_dwordx4 v4, s[4:7], s56 offen offset:1024 sc1 lds
    v_rcp_f32 v195, v195
    v_rcp_f32 v196, v196
    s_waitcnt lgkmcnt(3)
    v_mfma_f32_32x32x16_bf16 v[48:63], v[128:131], a[152:155], v[48:63]
    ds_read_b128 v[152:155], v11 offset:3072
    v_rcp_f32 v197, v197
    v_rcp_f32 v198, v198
    v_mfma_f32_32x32x16_bf16 v[48:63], v[132:135], a[156:159], v[48:63]
    ds_read_b128 v[156:159], v11 offset:4096
    buffer_load_dwordx4 v4, s[4:7], s56 offen offset:2048 sc1 lds
    v_rcp_f32 v199, v199
    v_mul_f32 v24, v24, v192
    v_mul_f32 v25, v25, v193
    v_mfma_f32_32x32x16_bf16 v[48:63], v[136:139], v[184:187], v[48:63]
    ds_read_b128 v[128:131], v11 offset:5120
    v_mul_f32 v26, v26, v194
    v_mul_f32 v27, v27, v195
    v_mul_f32 v28, v28, v196
    v_mul_f32 v29, v29, v197
    v_mul_f32 v30, v30, v198
    s_waitcnt lgkmcnt(3)
    v_mfma_f32_32x32x16_bf16 v[64:79], v[140:143], a[0:3], 0
    ds_read_b128 v[132:135], v11 offset:6144
    buffer_load_dwordx4 v4, s[4:7], s56 offen offset:3072 sc1 lds
    v_mul_f32 v31, v31, v199
    v_cvt_pk_bf16_f32 v208, v24, v25
    v_cvt_pk_bf16_f32 v209, v26, v27
    v_cvt_pk_bf16_f32 v210, v28, v29
    v_mfma_f32_32x32x16_bf16 v[64:79], v[144:147], a[4:7], v[64:79]
    ds_read_b128 v[136:139], v11 offset:7168
    v_cvt_pk_bf16_f32 v211, v30, v31
    s_mov_b32 exec_lo, 0
    v_mov_b32 v210, 0
    v_mov_b32 v211, 0
    s_mov_b32 exec_lo, -1
    v_mfma_f32_32x32x16_bf16 v[64:79], v[148:151], a[8:11], v[64:79]
    ds_read_b128 v[140:143], v11 offset:8192
    s_add_u32 s56, s18, 167936
    s_add_u32 m0, s19, 86016
    s_nop 0
    buffer_load_dwordx4 v4, s[4:7], s56 offen offset:0 sc1 lds
    buffer_store_dwordx4 v[208:211], v14, s[4:7], s20 offen offset:1024 sc1
    v_mul_f32 v192, v32, v32
    s_waitcnt lgkmcnt(3)
    v_mfma_f32_32x32x16_bf16 v[64:79], v[152:155], a[12:15], v[64:79]
    ds_read_b128 v[144:147], v11 offset:9216
    v_mul_f32 v193, v33, v33
    v_mul_f32 v194, v34, v34
    v_mul_f32 v195, v35, v35
    v_mul_f32 v196, v36, v36
    v_mul_f32 v197, v37, v37
    v_mfma_f32_32x32x16_bf16 v[64:79], v[156:159], a[16:19], v[64:79]
    ds_read_b128 v[148:151], v11 offset:10240
    s_add_u32 s59, s36, 8192
    buffer_load_dwordx4 v[16:19], v4, s[4:7], s59 offen offset:0 sc1
    v_mul_f32 v198, v38, v38
    v_mul_f32 v199, v39, v39
    v_fma_f32 v192, v192, v189, v188
    v_mfma_f32_32x32x16_bf16 v[64:79], v[128:131], a[20:23], v[64:79]
    ds_read_b128 v[152:155], v11 offset:11264
    v_fma_f32 v193, v193, v189, v188
    v_fma_f32 v194, v194, v189, v188
    v_fma_f32 v195, v195, v189, v188
    v_fma_f32 v196, v196, v189, v188
    v_fma_f32 v197, v197, v189, v188
    s_waitcnt lgkmcnt(3)
    v_mfma_f32_32x32x16_bf16 v[64:79], v[132:135], a[24:27], v[64:79]
    ds_read_b128 v[156:159], v11 offset:12288
    buffer_load_dwordx4 v[20:23], v4, s[4:7], s59 offen offset:1024 sc1
    v_fma_f32 v198, v198, v189, v188
    v_fma_f32 v199, v199, v189, v188
    v_mul_f32 v192, v192, v32
    v_mul_f32 v193, v193, v33
    v_mfma_f32_32x32x16_bf16 v[64:79], v[136:139], a[28:31], v[64:79]
    ds_read_b128 v[128:131], v11 offset:13312
    v_mul_f32 v194, v194, v34
    v_mul_f32 v195, v195, v35
    v_mul_f32 v196, v196, v36
    v_mul_f32 v197, v197, v37
    v_mul_f32 v198, v198, v38
    v_mfma_f32_32x32x16_bf16 v[64:79], v[140:143], a[32:35], v[64:79]
    ds_read_b128 v[132:135], v11 offset:14336
    buffer_load_dwordx4 v[24:27], v4, s[4:7], s59 offen offset:2048 sc1
    v_mul_f32 v199, v199, v39
    v_exp_f32 v192, v192
    v_mul_f32 v40, v32, v40
    s_waitcnt lgkmcnt(3)
    v_mfma_f32_32x32x16_bf16 v[64:79], v[144:147], a[36:39], v[64:79]
    ds_read_b128 v[136:139], v11 offset:15360
    v_exp_f32 v193, v193
    v_mul_f32 v41, v33, v41
    v_exp_f32 v194, v194
    v_mfma_f32_32x32x16_bf16 v[64:79], v[148:151], a[40:43], v[64:79]
    ds_read_b128 v[140:143], v11 offset:16384
    buffer_load_dwordx4 v[28:31], v4, s[4:7], s59 offen offset:3072 sc1
    v_mul_f32 v42, v34, v42
    v_exp_f32 v195, v195
    v_mul_f32 v43, v35, v43
    v_mfma_f32_32x32x16_bf16 v[64:79], v[152:155], a[44:47], v[64:79]
    ds_read_b128 v[144:147], v11 offset:17408
    v_exp_f32 v196, v196
    v_mul_f32 v44, v36, v44
    v_exp_f32 v197, v197
    s_waitcnt lgkmcnt(3)
    v_mfma_f32_32x32x16_bf16 v[64:79], v[156:159], a[48:51], v[64:79]
    ds_read_b128 v[148:151], v11 offset:18432
    v_mul_f32 v45, v37, v45
    v_exp_f32 v198, v198
    v_mul_f32 v46, v38, v46
    v_exp_f32 v199, v199
    v_mfma_f32_32x32x16_bf16 v[64:79], v[128:131], a[52:55], v[64:79]
    ds_read_b128 v[152:155], v11 offset:19456
    v_mul_f32 v47, v39, v47
    v_add_f32 v192, 1.0, v192
    v_add_f32 v193, 1.0, v193
    v_add_f32 v194, 1.0, v194
    v_mfma_f32_32x32x16_bf16 v[64:79], v[132:135], a[56:59], v[64:79]
    s_waitcnt vmcnt(15)
    s_barrier
    ds_read_b128 v[156:159], v11 offset:20480
    s_add_u32 s56, s18, 184320
    s_add_u32 m0, s19, 102400
    s_nop 0
    buffer_load_dwordx4 v4, s[4:7], s56 offen offset:0 sc1 lds
    s_waitcnt lgkmcnt(3)
    v_mfma_f32_32x32x16_bf16 v[64:79], v[136:139], a[60:63], v[64:79]
    ds_read_b128 v[128:131], v11 offset:21504
    v_add_f32 v195, 1.0, v195
    v_add_f32 v196, 1.0, v196
    v_add_f32 v197, 1.0, v197
    v_add_f32 v198, 1.0, v198
    v_add_f32 v199, 1.0, v199
    v_mfma_f32_32x32x16_bf16 v[64:79], v[140:143], a[64:67], v[64:79]
    ds_read_b128 v[132:135], v11 offset:22528
    buffer_load_dwordx4 v4, s[4:7], s56 offen offset:1024 sc1 lds
    v_rcp_f32 v192, v192
    v_rcp_f32 v193, v193
    v_mfma_f32_32x32x16_bf16 v[64:79], v[144:147], a[68:71], v[64:79]
    ds_read_b128 v[136:139], v11 offset:23552
    v_rcp_f32 v194, v194
    v_rcp_f32 v195, v195
    v_rcp_f32 v196, v196
    s_waitcnt lgkmcnt(3)
    v_mfma_f32_32x32x16_bf16 v[64:79], v[148:151], a[72:75], v[64:79]
    ds_read_b128 v[140:143], v11 offset:24576
    buffer_load_dwordx4 v4, s[4:7], s56 offen offset:2048 sc1 lds
    v_rcp_f32 v197, v197
    v_rcp_f32 v198, v198
    v_mfma_f32_32x32x16_bf16 v[64:79], v[152:155], a[76:79], v[64:79]
    ds_read_b128 v[144:147], v11 offset:25600
    v_rcp_f32 v199, v199
    v_mul_f32 v40, v40, v192
    v_mul_f32 v41, v41, v193
    v_mfma_f32_32x32x16_bf16 v[64:79], v[156:159], a[80:83], v[64:79]
    ds_read_b128 v[148:151], v11 offset:26624
    buffer_load_dwordx4 v4, s[4:7], s56 offen offset:3072 sc1 lds
    v_mul_f32 v42, v42, v194
    v_mul_f32 v43, v43, v195
    v_mul_f32 v44, v44, v196
    v_mul_f32 v45, v45, v197
    s_waitcnt lgkmcnt(3)
    v_mfma_f32_32x32x16_bf16 v[64:79], v[128:131], a[84:87], v[64:79]
    ds_read_b128 v[152:155], v11 offset:27648
    v_mul_f32 v46, v46, v198
    v_mul_f32 v47, v47, v199
    v_cvt_pk_bf16_f32 v212, v40, v41
    v_cvt_pk_bf16_f32 v213, v42, v43
    v_cvt_pk_bf16_f32 v214, v44, v45
    v_mfma_f32_32x32x16_bf16 v[64:79], v[132:135], a[88:91], v[64:79]
    ds_read_b128 v[156:159], v11 offset:28672
    s_add_u32 s56, s18, 188416
    s_add_u32 m0, s19, 106496
    s_nop 0
    buffer_load_dwordx4 v4, s[4:7], s56 offen offset:0 sc1 lds
    v_cvt_pk_bf16_f32 v215, v46, v47
    buffer_store_dwordx4 v[212:215], v14, s[4:7], s20 offen offset:0 sc1
    v_mfma_f32_32x32x16_bf16 v[64:79], v[136:139], a[92:95], v[64:79]
    ds_read_b128 v[128:131], v11 offset:29696
    v_mul_f32 v192, v48, v48
    v_mul_f32 v193, v49, v49
    v_mul_f32 v194, v50, v50
    v_mul_f32 v195, v51, v51
    v_mul_f32 v196, v52, v52
    s_waitcnt lgkmcnt(3)
    v_mfma_f32_32x32x16_bf16 v[64:79], v[140:143], a[96:99], v[64:79]
    ds_read_b128 v[132:135], v11 offset:30720
    s_add_u32 s59, s36, 12288
    buffer_load_dwordx4 v[32:35], v4, s[4:7], s59 offen offset:0 sc1
    v_mul_f32 v197, v53, v53
    v_mul_f32 v198, v54, v54
    v_mul_f32 v199, v55, v55
    v_mfma_f32_32x32x16_bf16 v[64:79], v[144:147], a[100:103], v[64:79]
    ds_read_b128 v[136:139], v11 offset:31744
    v_fma_f32 v192, v192, v189, v188
    v_fma_f32 v193, v193, v189, v188
    v_fma_f32 v194, v194, v189, v188
    v_fma_f32 v195, v195, v189, v188
    v_fma_f32 v196, v196, v189, v188
    v_mfma_f32_32x32x16_bf16 v[64:79], v[148:151], a[104:107], v[64:79]
    ds_read_b128 v[140:143], v11 offset:32768
    buffer_load_dwordx4 v[36:39], v4, s[4:7], s59 offen offset:1024 sc1
    v_fma_f32 v197, v197, v189, v188
    v_fma_f32 v198, v198, v189, v188
    v_fma_f32 v199, v199, v189, v188
    v_mul_f32 v192, v192, v48
    s_waitcnt lgkmcnt(3)
    v_mfma_f32_32x32x16_bf16 v[64:79], v[152:155], a[108:111], v[64:79]
    ds_read_b128 v[144:147], v11 offset:33792
    v_mul_f32 v193, v193, v49
    v_mul_f32 v194, v194, v50
    v_mul_f32 v195, v195, v51
    v_mul_f32 v196, v196, v52
    v_mul_f32 v197, v197, v53
    v_mfma_f32_32x32x16_bf16 v[64:79], v[156:159], a[112:115], v[64:79]
    ds_read_b128 v[148:151], v11 offset:34816
    buffer_load_dwordx4 v[40:43], v4, s[4:7], s59 offen offset:2048 sc1
    v_mul_f32 v198, v198, v54
    v_mul_f32 v199, v199, v55
    v_exp_f32 v192, v192
    v_mfma_f32_32x32x16_bf16 v[64:79], v[128:131], a[116:119], v[64:79]
    ds_read_b128 v[152:155], v11 offset:35840
    v_mul_f32 v56, v48, v56
    v_exp_f32 v193, v193
    v_mul_f32 v57, v49, v57
    v_exp_f32 v194, v194
    s_waitcnt lgkmcnt(3)
    v_mfma_f32_32x32x16_bf16 v[64:79], v[132:135], a[120:123], v[64:79]
    ds_read_b128 v[156:159], v11 offset:36864
    buffer_load_dwordx4 v[44:47], v4, s[4:7], s59 offen offset:3072 sc1
    v_mul_f32 v58, v50, v58
    v_exp_f32 v195, v195
    v_mfma_f32_32x32x16_bf16 v[64:79], v[136:139], a[124:127], v[64:79]
    ds_read_b128 v[128:131], v11 offset:37888
    v_mul_f32 v59, v51, v59
    v_exp_f32 v196, v196
    v_mul_f32 v60, v52, v60
    v_exp_f32 v197, v197
    v_mfma_f32_32x32x16_bf16 v[64:79], v[140:143], a[128:131], v[64:79]
    ds_read_b128 v[132:135], v11 offset:38912
    v_mul_f32 v61, v53, v61
    v_exp_f32 v198, v198
    v_mul_f32 v62, v54, v62
    s_waitcnt lgkmcnt(3)
    v_mfma_f32_32x32x16_bf16 v[64:79], v[144:147], a[132:135], v[64:79]
    ds_read_b128 v[136:139], v11 offset:39936
    v_exp_f32 v199, v199
    v_mul_f32 v63, v55, v63
    v_add_f32 v192, 1.0, v192
    v_add_f32 v193, 1.0, v193
    v_mfma_f32_32x32x16_bf16 v[64:79], v[148:151], a[136:139], v[64:79]
    ds_read_b128 v[140:143], v13 offset:1024
    v_add_f32 v194, 1.0, v194
    v_add_f32 v195, 1.0, v195
    v_add_f32 v196, 1.0, v196
    v_add_f32 v197, 1.0, v197
    v_add_f32 v198, 1.0, v198
    v_mfma_f32_32x32x16_bf16 v[64:79], v[152:155], a[140:143], v[64:79]
    s_waitcnt vmcnt(15)
    s_barrier
    ds_read_b128 v[144:147], v10 offset:0
    s_add_u32 s56, s18, 204800
    s_add_u32 m0, s19, 122880
    s_nop 0
    buffer_load_dwordx4 v4, s[4:7], s56 offen offset:0 sc1 lds
    s_waitcnt lgkmcnt(3)
    v_mfma_f32_32x32x16_bf16 v[64:79], v[156:159], a[144:147], v[64:79]
    ds_read_b128 v[148:151], v10 offset:1024
    v_add_f32 v199, 1.0, v199
    v_rcp_f32 v192, v192
    v_rcp_f32 v193, v193
    v_mfma_f32_32x32x16_bf16 v[64:79], v[128:131], a[148:151], v[64:79]
    ds_read_b128 v[152:155], v10 offset:2048
    buffer_load_dwordx4 v4, s[4:7], s56 offen offset:1024 sc1 lds
    v_rcp_f32 v194, v194
    v_rcp_f32 v195, v195
    v_mfma_f32_32x32x16_bf16 v[64:79], v[132:135], a[152:155], v[64:79]
    ds_read_b128 v[156:159], v10 offset:3072
    v_rcp_f32 v196, v196
    v_rcp_f32 v197, v197
    v_rcp_f32 v198, v198
    s_waitcnt lgkmcnt(3)
    v_mfma_f32_32x32x16_bf16 v[64:79], v[136:139], a[156:159], v[64:79]
    ds_read_b128 v[128:131], v10 offset:4096
    buffer_load_dwordx4 v4, s[4:7], s56 offen offset:2048 sc1 lds
    v_rcp_f32 v199, v199
    v_mul_f32 v56, v56, v192
    v_mfma_f32_32x32x16_bf16 v[64:79], v[140:143], v[184:187], v[64:79]
    ds_read_b128 v[132:135], v10 offset:5120
    v_mul_f32 v57, v57, v193
    v_mul_f32 v58, v58, v194
    v_mul_f32 v59, v59, v195
    v_mul_f32 v60, v60, v196
    v_mul_f32 v61, v61, v197
    v_mfma_f32_32x32x16_bf16 v[80:95], v[144:147], a[0:3], 0
    ds_read_b128 v[136:139], v10 offset:6144
    buffer_load_dwordx4 v4, s[4:7], s56 offen offset:3072 sc1 lds
    v_mul_f32 v62, v62, v198
    v_mul_f32 v63, v63, v199
    v_cvt_pk_bf16_f32 v208, v56, v57
    v_cvt_pk_bf16_f32 v209, v58, v59
    s_waitcnt lgkmcnt(3)
    v_mfma_f32_32x32x16_bf16 v[80:95], v[148:151], a[4:7], v[80:95]
    ds_read_b128 v[140:143], v10 offset:7168
    v_cvt_pk_bf16_f32 v210, v60, v61
    v_cvt_pk_bf16_f32 v211, v62, v63
    buffer_store_dwordx4 v[208:211], v14, s[4:7], s20 offen offset:512 sc1
    v_mfma_f32_32x32x16_bf16 v[80:95], v[152:155], a[8:11], v[80:95]
    ds_read_b128 v[144:147], v10 offset:8192
    s_add_u32 s56, s18, 208896
    s_add_u32 m0, s19, 126976
    s_nop 0
    buffer_load_dwordx4 v4, s[4:7], s56 offen offset:0 sc1 lds
    v_mfma_f32_32x32x16_bf16 v[80:95], v[156:159], a[12:15], v[80:95]
    ds_read_b128 v[148:151], v10 offset:9216
    v_mul_f32 v192, v64, v64
    v_mul_f32 v193, v65, v65
    v_mul_f32 v194, v66, v66
    v_mul_f32 v195, v67, v67
    v_mul_f32 v196, v68, v68
    s_waitcnt lgkmcnt(3)
    v_mfma_f32_32x32x16_bf16 v[80:95], v[128:131], a[16:19], v[80:95]
    ds_read_b128 v[152:155], v10 offset:10240
    s_add_u32 s59, s36, 16384
    buffer_load_dwordx4 v[48:51], v4, s[4:7], s59 offen offset:0 sc1
    v_mul_f32 v197, v69, v69
    v_mul_f32 v198, v70, v70
    v_mul_f32 v199, v71, v71
    v_mfma_f32_32x32x16_bf16 v[80:95], v[132:135], a[20:23], v[80:95]
    ds_read_b128 v[156:159], v10 offset:11264
    v_fma_f32 v192, v192, v189, v188
    v_fma_f32 v193, v193, v189, v188
    v_fma_f32 v194, v194, v189, v188
    v_fma_f32 v195, v195, v189, v188
    v_fma_f32 v196, v196, v189, v188
    v_mfma_f32_32x32x16_bf16 v[80:95], v[136:139], a[24:27], v[80:95]
    ds_read_b128 v[128:131], v10 offset:12288
    buffer_load_dwordx4 v[52:55], v4, s[4:7], s59 offen offset:1024 sc1
    v_fma_f32 v197, v197, v189, v188
    v_fma_f32 v198, v198, v189, v188
    v_fma_f32 v199, v199, v189, v188
    v_mul_f32 v192, v192, v64
    s_waitcnt lgkmcnt(3)
    v_mfma_f32_32x32x16_bf16 v[80:95], v[140:143], a[28:31], v[80:95]
    ds_read_b128 v[132:135], v10 offset:13312
    v_mul_f32 v193, v193, v65
    v_mul_f32 v194, v194, v66
    v_mul_f32 v195, v195, v67
    v_mul_f32 v196, v196, v68
    v_mul_f32 v197, v197, v69
    v_mfma_f32_32x32x16_bf16 v[80:95], v[144:147], a[32:35], v[80:95]
    ds_read_b128 v[136:139], v10 offset:14336
    buffer_load_dwordx4 v[56:59], v4, s[4:7], s59 offen offset:2048 sc1
    v_mul_f32 v198, v198, v70
    v_mul_f32 v199, v199, v71
    v_exp_f32 v192, v192
    v_mfma_f32_32x32x16_bf16 v[80:95], v[148:151], a[36:39], v[80:95]
    ds_read_b128 v[140:143], v10 offset:15360
    v_mul_f32 v72, v64, v72
    v_exp_f32 v193, v193
    v_mul_f32 v73, v65, v73
    v_exp_f32 v194, v194
    s_waitcnt lgkmcnt(3)
    v_mfma_f32_32x32x16_bf16 v[80:95], v[152:155], a[40:43], v[80:95]
    ds_read_b128 v[144:147], v10 offset:16384
    buffer_load_dwordx4 v[60:63], v4, s[4:7], s59 offen offset:3072 sc1
    v_mul_f32 v74, v66, v74
    v_exp_f32 v195, v195
    v_mfma_f32_32x32x16_bf16 v[80:95], v[156:159], a[44:47], v[80:95]
    ds_read_b128 v[148:151], v10 offset:17408
    v_mul_f32 v75, v67, v75
    v_exp_f32 v196, v196
    v_mul_f32 v76, v68, v76
    v_exp_f32 v197, v197
    v_mfma_f32_32x32x16_bf16 v[80:95], v[128:131], a[48:51], v[80:95]
    ds_read_b128 v[152:155], v10 offset:18432
    v_mul_f32 v77, v69, v77
    v_exp_f32 v198, v198
    v_mul_f32 v78, v70, v78
    s_waitcnt lgkmcnt(3)
    v_mfma_f32_32x32x16_bf16 v[80:95], v[132:135], a[52:55], v[80:95]
    ds_read_b128 v[156:159], v10 offset:19456
    v_exp_f32 v199, v199
    v_mul_f32 v79, v71, v79
    v_add_f32 v192, 1.0, v192
    v_add_f32 v193, 1.0, v193
    v_mfma_f32_32x32x16_bf16 v[80:95], v[136:139], a[56:59], v[80:95]
    s_waitcnt vmcnt(15)
    s_barrier
    ds_read_b128 v[128:131], v10 offset:20480
    s_add_u32 s56, s18, 225280
    s_add_u32 m0, s19, 143360
    s_nop 0
    buffer_load_dwordx4 v4, s[4:7], s56 offen offset:0 sc1 lds
    v_mfma_f32_32x32x16_bf16 v[80:95], v[140:143], a[60:63], v[80:95]
    ds_read_b128 v[132:135], v10 offset:21504
    v_add_f32 v194, 1.0, v194
    v_add_f32 v195, 1.0, v195
    v_add_f32 v196, 1.0, v196
    v_add_f32 v197, 1.0, v197
    v_add_f32 v198, 1.0, v198
    s_waitcnt lgkmcnt(3)
    v_mfma_f32_32x32x16_bf16 v[80:95], v[144:147], a[64:67], v[80:95]
    ds_read_b128 v[136:139], v10 offset:22528
    buffer_load_dwordx4 v4, s[4:7], s56 offen offset:1024 sc1 lds
    v_add_f32 v199, 1.0, v199
    v_rcp_f32 v192, v192
    v_rcp_f32 v193, v193
    v_mfma_f32_32x32x16_bf16 v[80:95], v[148:151], a[68:71], v[80:95]
    ds_read_b128 v[140:143], v10 offset:23552
    v_rcp_f32 v194, v194
    v_rcp_f32 v195, v195
    v_mfma_f32_32x32x16_bf16 v[80:95], v[152:155], a[72:75], v[80:95]
    ds_read_b128 v[144:147], v10 offset:24576
    buffer_load_dwordx4 v4, s[4:7], s56 offen offset:2048 sc1 lds
    v_rcp_f32 v196, v196
    v_rcp_f32 v197, v197
    s_waitcnt lgkmcnt(3)
    v_mfma_f32_32x32x16_bf16 v[80:95], v[156:159], a[76:79], v[80:95]
    ds_read_b128 v[148:151], v10 offset:25600
    v_rcp_f32 v198, v198
    v_rcp_f32 v199, v199
    v_mul_f32 v72, v72, v192
    v_mfma_f32_32x32x16_bf16 v[80:95], v[128:131], a[80:83], v[80:95]
    ds_read_b128 v[152:155], v10 offset:26624
    buffer_load_dwordx4 v4, s[4:7], s56 offen offset:3072 sc1 lds
    v_mul_f32 v73, v73, v193
    v_mul_f32 v74, v74, v194
    v_mul_f32 v75, v75, v195
    v_mul_f32 v76, v76, v196
    v_mfma_f32_32x32x16_bf16 v[80:95], v[132:135], a[84:87], v[80:95]
    ds_read_b128 v[156:159], v10 offset:27648
    v_mul_f32 v77, v77, v197
    v_mul_f32 v78, v78, v198
    v_mul_f32 v79, v79, v199
    v_cvt_pk_bf16_f32 v212, v72, v73
    v_cvt_pk_bf16_f32 v213, v74, v75
    s_waitcnt lgkmcnt(3)
    v_mfma_f32_32x32x16_bf16 v[80:95], v[136:139], a[88:91], v[80:95]
    ds_read_b128 v[128:131], v10 offset:28672
    s_add_u32 s56, s18, 229376
    s_add_u32 m0, s19, 147456
    s_nop 0
    buffer_load_dwordx4 v4, s[4:7], s56 offen offset:0 sc1 lds
    v_cvt_pk_bf16_f32 v214, v76, v77
    v_cvt_pk_bf16_f32 v215, v78, v79
    v_mfma_f32_32x32x16_bf16 v[80:95], v[140:143], a[92:95], v[80:95]
    ds_read_b128 v[132:135], v10 offset:29696
    buffer_store_dwordx4 v[212:215], v15, s[4:7], s22 offen offset:0 sc1
    v_mfma_f32_32x32x16_bf16 v[80:95], v[144:147], a[96:99], v[80:95]
    ds_read_b128 v[136:139], v10 offset:30720
    s_add_u32 s59, s36, 81920
    buffer_load_dwordx4 v[64:67], v4, s[4:7], s59 offen offset:0 sc1
    s_waitcnt lgkmcnt(3)
    v_mfma_f32_32x32x16_bf16 v[80:95], v[148:151], a[100:103], v[80:95]
    ds_read_b128 v[140:143], v10 offset:31744
    v_mfma_f32_32x32x16_bf16 v[80:95], v[152:155], a[104:107], v[80:95]
    ds_read_b128 v[144:147], v10 offset:32768
    buffer_load_dwordx4 v[68:71], v4, s[4:7], s59 offen offset:1024 sc1
    v_mfma_f32_32x32x16_bf16 v[80:95], v[156:159], a[108:111], v[80:95]
    ds_read_b128 v[148:151], v10 offset:33792
    s_waitcnt lgkmcnt(3)
    v_mfma_f32_32x32x16_bf16 v[80:95], v[128:131], a[112:115], v[80:95]
    ds_read_b128 v[152:155], v10 offset:34816
    buffer_load_dwordx4 v[72:75], v4, s[4:7], s59 offen offset:2048 sc1
    v_mfma_f32_32x32x16_bf16 v[80:95], v[132:135], a[116:119], v[80:95]
    ds_read_b128 v[156:159], v10 offset:35840
    v_mfma_f32_32x32x16_bf16 v[80:95], v[136:139], a[120:123], v[80:95]
    ds_read_b128 v[128:131], v10 offset:36864
    buffer_load_dwordx4 v[76:79], v4, s[4:7], s59 offen offset:3072 sc1
    s_waitcnt lgkmcnt(3)
    v_mfma_f32_32x32x16_bf16 v[80:95], v[140:143], a[124:127], v[80:95]
    ds_read_b128 v[132:135], v10 offset:37888
    v_mfma_f32_32x32x16_bf16 v[80:95], v[144:147], a[128:131], v[80:95]
    ds_read_b128 v[136:139], v10 offset:38912
    v_mfma_f32_32x32x16_bf16 v[80:95], v[148:151], a[132:135], v[80:95]
    ds_read_b128 v[140:143], v10 offset:39936
    s_waitcnt lgkmcnt(3)
    v_mfma_f32_32x32x16_bf16 v[80:95], v[152:155], a[136:139], v[80:95]
    ds_read_b128 v[144:147], v13 offset:1536
    v_mfma_f32_32x32x16_bf16 v[80:95], v[156:159], a[140:143], v[80:95]
    s_waitcnt vmcnt(14)
    s_barrier
    s_cmp_lg_u32 s3, 0
    s_cbranch_scc1 ws_31
    s_mov_b64 exec, 1
    buffer_atomic_add v216, v217, s[4:7], s37 offen offset:0 sc1
    s_mov_b64 exec, -1
ws_31:
    ds_read_b128 v[148:151], v11 offset:0
    s_add_u32 s56, s18, 245760
    s_add_u32 m0, s19, 81920
    s_nop 0
    buffer_load_dwordx4 v4, s[4:7], s56 offen offset:0 sc1 lds
    v_mfma_f32_32x32x16_bf16 v[80:95], v[128:131], a[144:147], v[80:95]
    ds_read_b128 v[152:155], v11 offset:1024
    s_waitcnt lgkmcnt(3)
    v_mfma_f32_32x32x16_bf16 v[80:95], v[132:135], a[148:151], v[80:95]
    ds_read_b128 v[156:159], v11 offset:2048
    buffer_load_dwordx4 v4, s[4:7], s56 offen offset:1024 sc1 lds
    v_mfma_f32_32x32x16_bf16 v[80:95], v[136:139], a[152:155], v[80:95]
    ds_read_b128 v[128:131], v11 offset:3072
    v_mfma_f32_32x32x16_bf16 v[80:95], v[140:143], a[156:159], v[80:95]
    ds_read_b128 v[132:135], v11 offset:4096
    buffer_load_dwordx4 v4, s[4:7], s56 offen offset:2048 sc1 lds
    s_waitcnt lgkmcnt(3)
    v_mfma_f32_32x32x16_bf16 v[80:95], v[144:147], v[184:187], v[80:95]
    ds_read_b128 v[136:139], v11 offset:5120
    v_mfma_f32_32x32x16_bf16 v[96:111], v[148:151], a[0:3], 0
    ds_read_b128 v[140:143], v11 offset:6144
    buffer_load_dwordx4 v4, s[4:7], s56 offen offset:3072 sc1 lds
    v_mfma_f32_32x32x16_bf16 v[96:111], v[152:155], a[4:7], v[96:111]
    ds_read_b128 v[144:147], v11 offset:7168
    s_waitcnt lgkmcnt(3)
    v_mfma_f32_32x32x16_bf16 v[96:111], v[156:159], a[8:11], v[96:111]
    ds_read_b128 v[148:151], v11 offset:8192
    s_add_u32 s56, s18, 249856
    s_add_u32 m0, s19, 86016
    s_nop 0
    buffer_load_dwordx4 v4, s[4:7], s56 offen offset:0 sc1 lds
    v_mfma_f32_32x32x16_bf16 v[96:111], v[128:131], a[12:15], v[96:111]
    ds_read_b128 v[152:155], v11 offset:9216
    v_mul_f32 v192, v80, v80
    v_mul_f32 v193, v81, v81
    v_mul_f32 v194, v82, v82
    v_mul_f32 v195, v83, v83
    v_mul_f32 v196, v84, v84
    v_mfma_f32_32x32x16_bf16 v[96:111], v[132:135], a[16:19], v[96:111]
    ds_read_b128 v[156:159], v11 offset:10240
    v_mul_f32 v197, v85, v85
    v_mul_f32 v198, v86, v86
    v_mul_f32 v199, v87, v87
    v_fma_f32 v192, v192, v189, v188
    v_fma_f32 v193, v193, v189, v188
    s_waitcnt lgkmcnt(3)
    v_mfma_f32_32x32x16_bf16 v[96:111], v[136:139], a[20:23], v[96:111]
    ds_read_b128 v[128:131], v11 offset:11264
    v_fma_f32 v194, v194, v189, v188
    v_fma_f32 v195, v195, v189, v188
    v_fma_f32 v196, v196, v189, v188
    v_fma_f32 v197, v197, v189, v188
    v_fma_f32 v198, v198, v189, v188
    v_mfma_f32_32x32x16_bf16 v[96:111], v[140:143], a[24:27], v[96:111]
    ds_read_b128 v[132:135], v11 offset:12288
    v_fma_f32 v199, v199, v189, v188
    v_mul_f32 v192, v192, v80
    v_mul_f32 v193, v193, v81
    v_mul_f32 v194, v194, v82
    v_mul_f32 v195, v195, v83
    v_mfma_f32_32x32x16_bf16 v[96:111], v[144:147], a[28:31], v[96:111]
    ds_read_b128 v[136:139], v11 offset:13312
    v_mul_f32 v196, v196, v84
    v_mul_f32 v197, v197, v85
    v_mul_f32 v198, v198, v86
    v_mul_f32 v199, v199, v87
    v_exp_f32 v192, v192
    s_waitcnt lgkmcnt(3)
    v_mfma_f32_32x32x16_bf16 v[96:111], v[148:151], a[32:35], v[96:111]
    ds_read_b128 v[140:143], v11 offset:14336
    v_mul_f32 v88, v80, v88
    v_exp_f32 v193, v193
    v_mul_f32 v89, v81, v89
    v_mfma_f32_32x32x16_bf16 v[96:111], v[152:155], a[36:39], v[96:111]
    ds_read_b128 v[144:147], v11 offset:15360
    v_exp_f32 v194, v194
    v_mul_f32 v90, v82, v90
    v_exp_f32 v195, v195
    v_mfma_f32_32x32x16_bf16 v[96:111], v[156:159], a[40:43], v[96:111]
    ds_read_b128 v[148:151], v11 offset:16384
    v_mul_f32 v91, v83, v91
    v_exp_f32 v196, v196
    v_mul_f32 v92, v84, v92
    v_exp_f32 v197, v197
    s_waitcnt lgkmcnt(3)
    v_mfma_f32_32x32x16_bf16 v[96:111], v[128:131], a[44:47], v[96:111]
    ds_read_b128 v[152:155], v11 offset:17408
    v_mul_f32 v93, v85, v93
    v_exp_f32 v198, v198
    v_mul_f32 v94, v86, v94
    v_mfma_f32_32x32x16_bf16 v[96:111], v[132:135], a[48:51], v[96:111]
    ds_read_b128 v[156:159], v11 offset:18432
    v_exp_f32 v199, v199
    v_mul_f32 v95, v87, v95
    v_add_f32 v192, 1.0, v192
    v_add_f32 v193, 1.0, v193
    v_mfma_f32_32x32x16_bf16 v[96:111], v[136:139], a[52:55], v[96:111]
    ds_read_b128 v[128:131], v11 offset:19456
    v_add_f32 v194, 1.0, v194
    v_add_f32 v195, 1.0, v195
    v_add_f32 v196, 1.0, v196
    v_add_f32 v197, 1.0, v197
    v_add_f32 v198, 1.0, v198
    s_waitcnt lgkmcnt(3)
    v_mfma_f32_32x32x16_bf16 v[96:111], v[140:143], a[56:59], v[96:111]
    s_waitcnt vmcnt(10)
    s_barrier
    ds_read_b128 v[132:135], v11 offset:20480
    s_add_u32 s56, s18, 266240
    s_add_u32 m0, s19, 102400
    s_nop 0
    buffer_load_dwordx4 v4, s[4:7], s56 offen offset:0 sc1 lds
    v_mfma_f32_32x32x16_bf16 v[96:111], v[144:147], a[60:63], v[96:111]
    ds_read_b128 v[136:139], v11 offset:21504
    v_add_f32 v199, 1.0, v199
    v_rcp_f32 v192, v192
    v_rcp_f32 v193, v193
    v_mfma_f32_32x32x16_bf16 v[96:111], v[148:151], a[64:67], v[96:111]
    ds_read_b128 v[140:143], v11 offset:22528
    buffer_load_dwordx4 v4, s[4:7], s56 offen offset:1024 sc1 lds
    v_rcp_f32 v194, v194
    v_rcp_f32 v195, v195
    s_waitcnt lgkmcnt(3)
    v_mfma_f32_32x32x16_bf16 v[96:111], v[152:155], a[68:71], v[96:111]
    ds_read_b128 v[144:147], v11 offset:23552
    v_rcp_f32 v196, v196
    v_rcp_f32 v197, v197
    v_rcp_f32 v198, v198
    v_mfma_f32_32x32x16_bf16 v[96:111], v[156:159], a[72:75], v[96:111]
    ds_read_b128 v[148:151], v11 offset:24576
    buffer_load_dwordx4 v4, s[4:7], s56 offen offset:2048 sc1 lds
    v_rcp_f32 v199, v199
    v_mul_f32 v88, v88, v192
    v_mfma_f32_32x32x16_bf16 v[96:111], v[128:131], a[76:79], v[96:111]
    ds_read_b128 v[152:155], v11 offset:25600
    v_mul_f32 v89, v89, v193
    v_mul_f32 v90, v90, v194
    v_mul_f32 v91, v91, v195
    v_mul_f32 v92, v92, v196
    v_mul_f32 v93, v93, v197
    s_waitcnt lgkmcnt(3)
    v_mfma_f32_32x32x16_bf16 v[96:111], v[132:135], a[80:83], v[96:111]
    ds_read_b128 v[156:159], v11 offset:26624
    s_cmp_lg_u32 s3, 0
    s_cbranch_scc1 wp_32
    buffer_load_dword v218, v217, s[4:7], s40 offen offset:0 sc1
wp_32:
    v_mul_f32 v94, v94, v198
    v_mul_f32 v95, v95, v199
    v_mfma_f32_32x32x16_bf16 v[96:111], v[136:139], a[84:87], v[96:111]
    ds_read_b128 v[128:131], v11 offset:27648
    v_cvt_pk_bf16_f32 v208, v88, v89
    v_cvt_pk_bf16_f32 v209, v90, v91
    v_cvt_pk_bf16_f32 v210, v92, v93
    v_cvt_pk_bf16_f32 v211, v94, v95
    buffer_store_dwordx4 v[208:211], v15, s[4:7], s22 offen offset:512 sc1
    v_mfma_f32_32x32x16_bf16 v[96:111], v[140:143], a[88:91], v[96:111]
    ds_read_b128 v[132:135], v11 offset:28672
    buffer_load_dwordx4 v4, s[4:7], s56 offen offset:3072 sc1 lds
    s_waitcnt lgkmcnt(3)
    v_mfma_f32_32x32x16_bf16 v[96:111], v[144:147], a[92:95], v[96:111]
    ds_read_b128 v[136:139], v11 offset:29696
    v_mfma_f32_32x32x16_bf16 v[96:111], v[148:151], a[96:99], v[96:111]
    ds_read_b128 v[140:143], v11 offset:30720
    s_add_u32 s56, s18, 270336
    s_add_u32 m0, s19, 106496
    s_nop 0
    buffer_load_dwordx4 v4, s[4:7], s56 offen offset:0 sc1 lds
    v_mfma_f32_32x32x16_bf16 v[96:111], v[152:155], a[100:103], v[96:111]
    ds_read_b128 v[144:147], v11 offset:31744
    s_waitcnt lgkmcnt(3)
    v_mfma_f32_32x32x16_bf16 v[96:111], v[156:159], a[104:107], v[96:111]
    ds_read_b128 v[148:151], v11 offset:32768
    s_add_u32 s59, s36, 86016
    buffer_load_dwordx4 v[80:83], v4, s[4:7], s59 offen offset:0 sc1
    v_mfma_f32_32x32x16_bf16 v[96:111], v[128:131], a[108:111], v[96:111]
    ds_read_b128 v[152:155], v11 offset:33792
    v_mfma_f32_32x32x16_bf16 v[96:111], v[132:135], a[112:115], v[96:111]
    ds_read_b128 v[156:159], v11 offset:34816
    buffer_load_dwordx4 v[84:87], v4, s[4:7], s59 offen offset:1024 sc1
    s_waitcnt lgkmcnt(3)
    v_mfma_f32_32x32x16_bf16 v[96:111], v[136:139], a[116:119], v[96:111]
    ds_read_b128 v[128:131], v11 offset:35840
    v_mfma_f32_32x32x16_bf16 v[96:111], v[140:143], a[120:123], v[96:111]
    ds_read_b128 v[132:135], v11 offset:36864
    buffer_load_dwordx4 v[88:91], v4, s[4:7], s59 offen offset:2048 sc1
    v_mfma_f32_32x32x16_bf16 v[96:111], v[144:147], a[124:127], v[96:111]
    ds_read_b128 v[136:139], v11 offset:37888
    s_waitcnt lgkmcnt(3)
    v_mfma_f32_32x32x16_bf16 v[96:111], v[148:151], a[128:131], v[96:111]
    ds_read_b128 v[140:143], v11 offset:38912
    buffer_load_dwordx4 v[92:95], v4, s[4:7], s59 offen offset:3072 sc1
    v_mfma_f32_32x32x16_bf16 v[96:111], v[152:155], a[132:135], v[96:111]
    ds_read_b128 v[144:147], v11 offset:39936
    v_mfma_f32_32x32x16_bf16 v[96:111], v[156:159], a[136:139], v[96:111]
    ds_read_b128 v[148:151], v13 offset:2048
    s_waitcnt lgkmcnt(3)
    v_mfma_f32_32x32x16_bf16 v[96:111], v[128:131], a[140:143], v[96:111]
    s_waitcnt vmcnt(10)
    s_cmp_lg_u32 s3, 0
    s_cbranch_scc1 gpd_34
    s_waitcnt vmcnt(7)
    s_mov_b32 s57, 0
gp_33:
    v_cmp_gt_u32 vcc, 16, v218
    s_cbranch_vccz gpd_34
    s_sleep 2
    buffer_load_dword v218, v217, s[4:7], s40 offen offset:0 sc1
    s_add_u32 s57, s57, 1
    s_cmp_ge_u32 s57, 100000
    s_waitcnt vmcnt(0)
    s_cbranch_scc0 gp_33
gpd_34:
    s_barrier
    ds_read_b128 v[152:155], v10 offset:0
    v_mfma_f32_32x32x16_bf16 v[96:111], v[132:135], a[144:147], v[96:111]
    ds_read_b128 v[156:159], v10 offset:1024
    v_mfma_f32_32x32x16_bf16 v[96:111], v[136:139], a[148:151], v[96:111]
    ds_read_b128 v[128:131], v10 offset:2048
    s_waitcnt lgkmcnt(3)
    v_mfma_f32_32x32x16_bf16 v[96:111], v[140:143], a[152:155], v[96:111]
    ds_read_b128 v[132:135], v10 offset:3072
    v_mfma_f32_32x32x16_bf16 v[96:111], v[144:147], a[156:159], v[96:111]
    ds_read_b128 v[136:139], v10 offset:4096
    v_mfma_f32_32x32x16_bf16 v[96:111], v[148:151], v[184:187], v[96:111]
    ds_read_b128 v[140:143], v10 offset:5120
    s_waitcnt lgkmcnt(3)
    v_mfma_f32_32x32x16_bf16 v[112:127], v[152:155], a[0:3], 0
    ds_read_b128 v[144:147], v10 offset:6144
    v_mfma_f32_32x32x16_bf16 v[112:127], v[156:159], a[4:7], v[112:127]
    ds_read_b128 v[148:151], v10 offset:7168
    v_mfma_f32_32x32x16_bf16 v[112:127], v[128:131], a[8:11], v[112:127]
    ds_read_b128 v[152:155], v10 offset:8192
    buffer_load_dwordx4 a[0:3], v4, s[4:7], s24 offen offset:0 sc1
    s_waitcnt lgkmcnt(3)
    v_mfma_f32_32x32x16_bf16 v[112:127], v[132:135], a[12:15], v[112:127]
    ds_read_b128 v[156:159], v10 offset:9216
    v_mul_f32 v192, v96, v96
    v_mul_f32 v193, v97, v97
    v_mul_f32 v194, v98, v98
    v_mul_f32 v195, v99, v99
    v_mul_f32 v196, v100, v100
    v_mfma_f32_32x32x16_bf16 v[112:127], v[136:139], a[16:19], v[112:127]
    ds_read_b128 v[128:131], v10 offset:10240
    buffer_load_dwordx4 a[4:7], v4, s[4:7], s25 offen offset:0 sc1
    v_mul_f32 v197, v101, v101
    v_mul_f32 v198, v102, v102
    v_mul_f32 v199, v103, v103
    v_fma_f32 v192, v192, v189, v188
    v_mfma_f32_32x32x16_bf16 v[112:127], v[140:143], a[20:23], v[112:127]
    ds_read_b128 v[132:135], v10 offset:11264
    v_fma_f32 v193, v193, v189, v188
    v_fma_f32 v194, v194, v189, v188
    v_fma_f32 v195, v195, v189, v188
    v_fma_f32 v196, v196, v189, v188
    v_fma_f32 v197, v197, v189, v188
    s_waitcnt lgkmcnt(3)
    v_mfma_f32_32x32x16_bf16 v[112:127], v[144:147], a[24:27], v[112:127]
    ds_read_b128 v[136:139], v10 offset:12288
    buffer_load_dwordx4 a[8:11], v4, s[4:7], s26 offen offset:0 sc1
    v_fma_f32 v198, v198, v189, v188
    v_fma_f32 v199, v199, v189, v188
    v_mul_f32 v192, v192, v96
    v_mul_f32 v193, v193, v97
    v_mfma_f32_32x32x16_bf16 v[112:127], v[148:151], a[28:31], v[112:127]
    ds_read_b128 v[140:143], v10 offset:13312
    v_mul_f32 v194, v194, v98
    v_mul_f32 v195, v195, v99
    v_mul_f32 v196, v196, v100
    v_mul_f32 v197, v197, v101
    v_mul_f32 v198, v198, v102
    v_mfma_f32_32x32x16_bf16 v[112:127], v[152:155], a[32:35], v[112:127]
    ds_read_b128 v[144:147], v10 offset:14336
    buffer_load_dwordx4 a[12:15], v4, s[4:7], s27 offen offset:0 sc1
    v_mul_f32 v199, v199, v103
    v_exp_f32 v192, v192
    v_mul_f32 v104, v96, v104
    s_waitcnt lgkmcnt(3)
    v_mfma_f32_32x32x16_bf16 v[112:127], v[156:159], a[36:39], v[112:127]
    ds_read_b128 v[148:151], v10 offset:15360
    v_exp_f32 v193, v193
    v_mul_f32 v105, v97, v105
    v_exp_f32 v194, v194
    v_mfma_f32_32x32x16_bf16 v[112:127], v[128:131], a[40:43], v[112:127]
    ds_read_b128 v[152:155], v10 offset:16384
    buffer_load_dwordx4 a[16:19], v4, s[4:7], s24 offen offset:1024 sc1
    v_mul_f32 v106, v98, v106
    v_exp_f32 v195, v195
    v_mul_f32 v107, v99, v107
    v_mfma_f32_32x32x16_bf16 v[112:127], v[132:135], a[44:47], v[112:127]
    ds_read_b128 v[156:159], v10 offset:17408
    v_exp_f32 v196, v196
    v_mul_f32 v108, v100, v108
    v_exp_f32 v197, v197
    s_waitcnt lgkmcnt(3)
    v_mfma_f32_32x32x16_bf16 v[112:127], v[136:139], a[48:51], v[112:127]
    ds_read_b128 v[128:131], v10 offset:18432
    buffer_load_dwordx4 a[20:23], v4, s[4:7], s25 offen offset:1024 sc1
    v_mul_f32 v109, v101, v109
    v_exp_f32 v198, v198
    v_mul_f32 v110, v102, v110
    v_mfma_f32_32x32x16_bf16 v[112:127], v[140:143], a[52:55], v[112:127]
    ds_read_b128 v[132:135], v10 offset:19456
    v_exp_f32 v199, v199
    v_mul_f32 v111, v103, v111
    v_add_f32 v192, 1.0, v192
    v_add_f32 v193, 1.0, v193
    v_mfma_f32_32x32x16_bf16 v[112:127], v[144:147], a[56:59], v[112:127]
    s_waitcnt vmcnt(10)
    s_barrier
    s_cmp_lg_u32 s3, 0
    s_cbranch_scc1 ws_35
    s_mov_b64 exec, 1
    buffer_atomic_add v216, v217, s[4:7], s37 offen offset:128 sc1
    s_mov_b64 exec, -1
ws_35:
    ds_read_b128 v[136:139], v10 offset:20480
    buffer_load_dwordx4 a[24:27], v4, s[4:7], s26 offen offset:1024 sc1
    s_waitcnt lgkmcnt(3)
    v_mfma_f32_32x32x16_bf16 v[112:127], v[148:151], a[60:63], v[112:127]
    ds_read_b128 v[140:143], v10 offset:21504
    v_add_f32 v194, 1.0, v194
    v_add_f32 v195, 1.0, v195
    v_add_f32 v196, 1.0, v196
    v_add_f32 v197, 1.0, v197
    v_mfma_f32_32x32x16_bf16 v[112:127], v[152:155], a[64:67], v[112:127]
    ds_read_b128 v[144:147], v10 offset:22528
    buffer_load_dwordx4 a[28:31], v4, s[4:7], s27 offen offset:1024 sc1
    v_add_f32 v198, 1.0, v198
    v_add_f32 v199, 1.0, v199
    v_rcp_f32 v192, v192
    v_mfma_f32_32x32x16_bf16 v[112:127], v[156:159], a[68:71], v[112:127]
    ds_read_b128 v[148:151], v10 offset:23552
    v_rcp_f32 v193, v193
    v_rcp_f32 v194, v194
    v_rcp_f32 v195, v195
    s_waitcnt lgkmcnt(3)
    v_mfma_f32_32x32x16_bf16 v[112:127], v[128:131], a[72:75], v[112:127]
    ds_read_b128 v[152:155], v10 offset:24576
    buffer_load_dwordx4 a[32:35], v4, s[4:7], s24 offen offset:2048 sc1
    v_rcp_f32 v196, v196
    v_rcp_f32 v197, v197
    v_mfma_f32_32x32x16_bf16 v[112:127], v[132:135], a[76:79], v[112:127]
    ds_read_b128 v[156:159], v10 offset:25600
    v_rcp_f32 v198, v198
    v_rcp_f32 v199, v199
    v_mfma_f32_32x32x16_bf16 v[112:127], v[136:139], a[80:83], v[112:127]
    ds_read_b128 v[128:131], v10 offset:26624
    buffer_load_dwordx4 a[36:39], v4, s[4:7], s25 offen offset:2048 sc1
    v_mul_f32 v104, v104, v192
    v_mul_f32 v105, v105, v193
    v_mul_f32 v106, v106, v194
    v_mul_f32 v107, v107, v195
    s_waitcnt lgkmcnt(3)
    v_mfma_f32_32x32x16_bf16 v[112:127], v[140:143], a[84:87], v[112:127]
    ds_read_b128 v[132:135], v10 offset:27648
    v_mul_f32 v108, v108, v196
    v_mul_f32 v109, v109, v197
    v_mul_f32 v110, v110, v198
    v_mul_f32 v111, v111, v199
    v_cvt_pk_bf16_f32 v212, v104, v105
    v_mfma_f32_32x32x16_bf16 v[112:127], v[144:147], a[88:91], v[112:127]
    ds_read_b128 v[136:139], v10 offset:28672
    buffer_load_dwordx4 a[40:43], v4, s[4:7], s26 offen offset:2048 sc1
    v_cvt_pk_bf16_f32 v213, v106, v107
    v_cvt_pk_bf16_f32 v214, v108, v109
    v_cvt_pk_bf16_f32 v215, v110, v111
    buffer_store_dwordx4 v[212:215], v15, s[4:7], s39 offen offset:0 sc1
    v_mfma_f32_32x32x16_bf16 v[112:127], v[148:151], a[92:95], v[112:127]
    ds_read_b128 v[140:143], v10 offset:29696
    s_waitcnt lgkmcnt(3)
    v_mfma_f32_32x32x16_bf16 v[112:127], v[152:155], a[96:99], v[112:127]
    ds_read_b128 v[144:147], v10 offset:30720
    buffer_load_dwordx4 a[44:47], v4, s[4:7], s27 offen offset:2048 sc1
    v_mfma_f32_32x32x16_bf16 v[112:127], v[156:159], a[100:103], v[112:127]
    ds_read_b128 v[148:151], v10 offset:31744
    v_mfma_f32_32x32x16_bf16 v[112:127], v[128:131], a[104:107], v[112:127]
    ds_read_b128 v[152:155], v10 offset:32768
    buffer_load_dwordx4 a[48:51], v4, s[4:7], s24 offen offset:3072 sc1
    s_waitcnt lgkmcnt(3)
    v_mfma_f32_32x32x16_bf16 v[112:127], v[132:135], a[108:111], v[112:127]
    ds_read_b128 v[156:159], v10 offset:33792
    v_mfma_f32_32x32x16_bf16 v[112:127], v[136:139], a[112:115], v[112:127]
    ds_read_b128 v[128:131], v10 offset:34816
    buffer_load_dwordx4 a[52:55], v4, s[4:7], s25 offen offset:3072 sc1
    v_mfma_f32_32x32x16_bf16 v[112:127], v[140:143], a[116:119], v[112:127]
    ds_read_b128 v[132:135], v10 offset:35840
    s_waitcnt lgkmcnt(3)
    v_mfma_f32_32x32x16_bf16 v[112:127], v[144:147], a[120:123], v[112:127]
    ds_read_b128 v[136:139], v10 offset:36864
    buffer_load_dwordx4 a[56:59], v4, s[4:7], s26 offen offset:3072 sc1
    v_mfma_f32_32x32x16_bf16 v[112:127], v[148:151], a[124:127], v[112:127]
    ds_read_b128 v[140:143], v10 offset:37888
    v_mfma_f32_32x32x16_bf16 v[112:127], v[152:155], a[128:131], v[112:127]
    ds_read_b128 v[144:147], v10 offset:38912
    buffer_load_dwordx4 a[60:63], v4, s[4:7], s27 offen offset:3072 sc1
    s_waitcnt lgkmcnt(3)
    v_mfma_f32_32x32x16_bf16 v[112:127], v[156:159], a[132:135], v[112:127]
    ds_read_b128 v[148:151], v10 offset:39936
    v_mfma_f32_32x32x16_bf16 v[112:127], v[128:131], a[136:139], v[112:127]
    ds_read_b128 v[152:155], v13 offset:2560
    s_add_u32 s60, s24, 4096
    buffer_load_dwordx4 a[64:67], v4, s[4:7], s60 offen offset:0 sc1
    v_mfma_f32_32x32x16_bf16 v[112:127], v[132:135], a[140:143], v[112:127]
    s_waitcnt lgkmcnt(2)
    v_mfma_f32_32x32x16_bf16 v[112:127], v[136:139], a[144:147], v[112:127]
    s_add_u32 s60, s25, 4096
    buffer_load_dwordx4 a[68:71], v4, s[4:7], s60 offen offset:0 sc1
    v_mfma_f32_32x32x16_bf16 v[112:127], v[140:143], a[148:151], v[112:127]
    v_mfma_f32_32x32x16_bf16 v[112:127], v[144:147], a[152:155], v[112:127]
    s_add_u32 s60, s26, 4096
    buffer_load_dwordx4 a[72:75], v4, s[4:7], s60 offen offset:0 sc1
    s_waitcnt lgkmcnt(0)
    v_mfma_f32_32x32x16_bf16 v[112:127], v[148:151], a[156:159], v[112:127]
    v_mfma_f32_32x32x16_bf16 v[112:127], v[152:155], v[184:187], v[112:127]
    s_add_u32 s60, s27, 4096
    buffer_load_dwordx4 a[76:79], v4, s[4:7], s60 offen offset:0 sc1
    s_nop 9
    v_mul_f32 v192, v112, v112
    v_mul_f32 v193, v113, v113
    v_mul_f32 v194, v114, v114
    v_mul_f32 v195, v115, v115
    v_mul_f32 v196, v116, v116
    v_mul_f32 v197, v117, v117
    v_mul_f32 v198, v118, v118
    v_mul_f32 v199, v119, v119
    v_fma_f32 v192, v192, v189, v188
    v_fma_f32 v193, v193, v189, v188
    s_add_u32 s60, s24, 4096
    buffer_load_dwordx4 a[80:83], v4, s[4:7], s60 offen offset:1024 sc1
    v_fma_f32 v194, v194, v189, v188
    v_fma_f32 v195, v195, v189, v188
    v_fma_f32 v196, v196, v189, v188
    v_fma_f32 v197, v197, v189, v188
    v_fma_f32 v198, v198, v189, v188
    v_fma_f32 v199, v199, v189, v188
    v_mul_f32 v192, v192, v112
    v_mul_f32 v193, v193, v113
    v_mul_f32 v194, v194, v114
    v_mul_f32 v195, v195, v115
    s_add_u32 s60, s25, 4096
    buffer_load_dwordx4 a[84:87], v4, s[4:7], s60 offen offset:1024 sc1
    v_mul_f32 v196, v196, v116
    v_mul_f32 v197, v197, v117
    v_mul_f32 v198, v198, v118
    v_mul_f32 v199, v199, v119
    v_exp_f32 v192, v192
    v_mul_f32 v120, v112, v120
    v_exp_f32 v193, v193
    v_mul_f32 v121, v113, v121
    s_add_u32 s60, s26, 4096
    buffer_load_dwordx4 a[88:91], v4, s[4:7], s60 offen offset:1024 sc1
    v_exp_f32 v194, v194
    v_mul_f32 v122, v114, v122
    v_exp_f32 v195, v195
    v_mul_f32 v123, v115, v123
    v_exp_f32 v196, v196
    v_mul_f32 v124, v116, v124
    v_exp_f32 v197, v197
    s_add_u32 s60, s27, 4096
    buffer_load_dwordx4 a[92:95], v4, s[4:7], s60 offen offset:1024 sc1
    v_mul_f32 v125, v117, v125
    v_exp_f32 v198, v198
    v_mul_f32 v126, v118, v126
    v_exp_f32 v199, v199
    v_mul_f32 v127, v119, v127
    v_add_f32 v192, 1.0, v192
    v_add_f32 v193, 1.0, v193
    v_add_f32 v194, 1.0, v194
    s_add_u32 s59, s36, 90112
    buffer_load_dwordx4 v[96:99], v4, s[4:7], s59 offen offset:0 sc1
    v_add_f32 v195, 1.0, v195
    v_add_f32 v196, 1.0, v196
    v_add_f32 v197, 1.0, v197
    v_add_f32 v198, 1.0, v198
    v_add_f32 v199, 1.0, v199
    v_rcp_f32 v192, v192
    v_rcp_f32 v193, v193
    v_rcp_f32 v194, v194
    buffer_load_dwordx4 v[100:103], v4, s[4:7], s59 offen offset:1024 sc1
    v_rcp_f32 v195, v195
    v_rcp_f32 v196, v196
    v_rcp_f32 v197, v197
    v_rcp_f32 v198, v198
    v_rcp_f32 v199, v199
    buffer_load_dwordx4 v[104:107], v4, s[4:7], s59 offen offset:2048 sc1
    v_mul_f32 v120, v120, v192
    v_mul_f32 v121, v121, v193
    v_mul_f32 v122, v122, v194
    v_mul_f32 v123, v123, v195
    v_mul_f32 v124, v124, v196
    v_mul_f32 v125, v125, v197
    v_mul_f32 v126, v126, v198
    v_mul_f32 v127, v127, v199
    v_cvt_pk_bf16_f32 v208, v120, v121
    v_cvt_pk_bf16_f32 v209, v122, v123
    buffer_load_dwordx4 v[108:111], v4, s[4:7], s59 offen offset:3072 sc1
    v_cvt_pk_bf16_f32 v210, v124, v125
    v_cvt_pk_bf16_f32 v211, v126, v127
    buffer_store_dwordx4 v[208:211], v15, s[4:7], s39 offen offset:512 sc1
    v_lshrrev_b32 v2, 2, v6
    v_and_b32 v3, 3, v6
    v_lshl_add_u32 v2, v2, 3, v3
    v_lshlrev_b32 v2, 6, v2
    v_lshl_add_u32 v8, v7, 4, v2
    v_lshlrev_b32 v2, 6, v6
    v_lshl_add_u32 v9, v7, 4, v2
    s_lshl_b32 s56, s98, 2
    s_lshl_b32 s57, s54, 1
    s_add_u32 s56, s56, s57
    s_lshr_b32 s57, s3, 1
    s_add_u32 s63, s56, s57
    s_mul_i32 s56, s63, 40960
    s_mul_i32 s57, s55, 5120
    s_add_u32 s56, s56, s57
    s_add_u32 s16, s56, 3670016
    s_add_u32 s17, s16, 4096
    s_and_b32 s61, s3, 1
    s_lshl_b32 s62, s61, 4
    s_mov_b32 s8, s42
    s_mov_b32 s9, s43
    s_mov_b32 s10, 2621440
    s_mov_b32 s11, 0x20000
    s_waitcnt vmcnt(29)
    v_mfma_f32_16x16x32_bf16 v[192:195], a[160:163], a[0:3], 0
    v_lshlrev_b32 v2, 3, v7
    v_sub_u32 v2, v6, v2
    v_mfma_f32_16x16x32_bf16 v[196:199], a[164:167], a[0:3], 0
    s_add_u32 s59, s36, 94208
    buffer_load_dwordx4 v[112:115], v4, s[4:7], s59 offen offset:0 sc1
    v_mfma_f32_16x16x32_bf16 v[200:203], a[168:171], a[0:3], 0
    v_add_u32 v2, s62, v2
    v_mov_b32 v3, 0x3f80
    v_mfma_f32_16x16x32_bf16 v[204:207], a[172:175], a[0:3], 0
    v_mov_b32 v5, 0x3f800000
    v_mov_b32 v10, 0
    v_mfma_f32_16x16x32_bf16 v[208:211], a[176:179], a[0:3], 0
    v_cmp_eq_u32 vcc, 0, v2
    s_nop 1
    v_cndmask_b32 v184, 0, v3, vcc
    s_waitcnt vmcnt(29)
    v_mfma_f32_16x16x32_bf16 a[100:103], a[160:163], a[4:7], 0
    v_cmp_eq_u32 vcc, 1, v2
    s_nop 1
    v_cndmask_b32 v184, v184, v5, vcc
    v_mfma_f32_16x16x32_bf16 a[104:107], a[164:167], a[4:7], 0
    buffer_load_dwordx4 v[116:119], v4, s[4:7], s59 offen offset:1024 sc1
    v_mfma_f32_16x16x32_bf16 a[108:111], a[168:171], a[4:7], 0
    v_cmp_eq_u32 vcc, 2, v2
    s_nop 1
    v_cndmask_b32 v185, 0, v3, vcc
    v_mfma_f32_16x16x32_bf16 a[112:115], a[172:175], a[4:7], 0
    v_cmp_eq_u32 vcc, 3, v2
    s_nop 1
    v_cndmask_b32 v185, v185, v5, vcc
    v_mfma_f32_16x16x32_bf16 a[116:119], a[176:179], a[4:7], 0
    v_cmp_eq_u32 vcc, 4, v2
    s_nop 1
    v_cndmask_b32 v186, 0, v3, vcc
    s_waitcnt vmcnt(29)
    v_mfma_f32_16x16x32_bf16 a[120:123], a[160:163], a[8:11], 0
    v_cmp_eq_u32 vcc, 5, v2
    s_nop 1
    v_cndmask_b32 v186, v186, v5, vcc
    v_mfma_f32_16x16x32_bf16 a[124:127], a[164:167], a[8:11], 0
    buffer_load_dwordx4 v[120:123], v4, s[4:7], s59 offen offset:2048 sc1
    v_mfma_f32_16x16x32_bf16 a[128:131], a[168:171], a[8:11], 0
    v_cmp_eq_u32 vcc, 6, v2
    s_nop 1
    v_cndmask_b32 v187, 0, v3, vcc
    v_mfma_f32_16x16x32_bf16 a[132:135], a[172:175], a[8:11], 0
    v_cmp_eq_u32 vcc, 7, v2
    s_nop 1
    v_cndmask_b32 v187, v187, v5, vcc
    v_mfma_f32_16x16x32_bf16 a[136:139], a[176:179], a[8:11], 0
    s_lshl_b32 s56, s63, 5
    s_add_u32 s56, s56, s62
    s_waitcnt vmcnt(29)
    v_mfma_f32_16x16x32_bf16 a[140:143], a[160:163], a[12:15], 0
    s_lshl_b32 s56, s56, 2
    s_add_u32 s41, s56, 253952
    v_mfma_f32_16x16x32_bf16 a[144:147], a[164:167], a[12:15], 0
    buffer_load_dwordx4 v[124:127], v4, s[4:7], s59 offen offset:3072 sc1
    v_mfma_f32_16x16x32_bf16 a[148:151], a[168:171], a[12:15], 0
    v_lshlrev_b32 v220, 2, v6
    v_mov_b32 v2, 0
    v_mfma_f32_16x16x32_bf16 a[152:155], a[172:175], a[12:15], 0
    v_lshrrev_b32 v2, 3, v6
    v_and_b32 v3, 3, v6
    v_mfma_f32_16x16x32_bf16 a[156:159], a[176:179], a[12:15], 0
    v_lshl_add_u32 v2, v3, 1, v2
    v_bfe_u32 v3, v6, 2, 1
    s_waitcnt vmcnt(29)
    v_mfma_f32_16x16x32_bf16 v[192:195], a[180:183], a[16:19], v[192:195]
    s_cmp_lg_u32 s3, 0
    s_cbranch_scc1 wp_36
    buffer_load_dword v219, v217, s[4:7], s40 offen offset:128 sc1
wp_36:
    v_mfma_f32_16x16x32_bf16 v[196:199], a[184:187], a[16:19], v[196:199]
    s_add_u32 s59, s36, 98304
    buffer_load_dwordx4 v[128:131], v4, s[4:7], s59 offen offset:0 sc1
    v_mfma_f32_16x16x32_bf16 v[200:203], a[188:191], a[16:19], v[200:203]
    v_lshl_add_u32 v2, v3, 3, v2
    v_add_u32 v2, s62, v2
    v_mfma_f32_16x16x32_bf16 v[204:207], a[192:195], a[16:19], v[204:207]
    s_lshl_b32 s56, s63, 5
    v_add_u32 v2, s56, v2
    v_mfma_f32_16x16x32_bf16 v[208:211], a[196:199], a[16:19], v[208:211]
    v_mul_u32_u24 v2, 1280, v2
    s_mul_i32 s56, s55, 160
    s_waitcnt vmcnt(29)
    v_mfma_f32_16x16x32_bf16 a[100:103], a[180:183], a[20:23], a[100:103]
    v_add_u32 v2, s56, v2
    v_lshl_add_u32 v221, v7, 4, v2
    v_mfma_f32_16x16x32_bf16 a[104:107], a[184:187], a[20:23], a[104:107]
    buffer_load_dwordx4 v[132:135], v4, s[4:7], s59 offen offset:1024 sc1
    v_mfma_f32_16x16x32_bf16 a[108:111], a[188:191], a[20:23], a[108:111]
    v_lshl_add_u32 v222, v7, 3, v2
    v_lshlrev_b32 v10, 5, v7
    v_mfma_f32_16x16x32_bf16 a[112:115], a[192:195], a[20:23], a[112:115]
    v_add_u32 v10, 75776, v10
    v_lshlrev_b32 v11, 4, v7
    v_mfma_f32_16x16x32_bf16 a[116:119], a[196:199], a[20:23], a[116:119]
    v_add_u32 v11, 76032, v11
    s_add_u32 s56, s3, 1
    s_waitcnt vmcnt(29)
    v_mfma_f32_16x16x32_bf16 a[120:123], a[180:183], a[24:27], a[120:123]
    s_and_b32 s56, s56, 3
    s_mul_i32 s56, s56, 15360
    v_mfma_f32_16x16x32_bf16 a[124:127], a[184:187], a[24:27], a[124:127]
    buffer_load_dwordx4 v[136:139], v4, s[4:7], s59 offen offset:2048 sc1
    v_mfma_f32_16x16x32_bf16 a[128:131], a[188:191], a[24:27], a[128:131]
    s_add_u32 s56, s56, 81920
    v_add_u32 v12, s56, v4
    v_mfma_f32_16x16x32_bf16 a[132:135], a[192:195], a[24:27], a[132:135]
    s_add_u32 s56, s3, 2
    s_and_b32 s56, s56, 3
    v_mfma_f32_16x16x32_bf16 a[136:139], a[196:199], a[24:27], a[136:139]
    s_mul_i32 s56, s56, 15360
    s_add_u32 s56, s56, 87040
    s_waitcnt vmcnt(29)
    v_mfma_f32_16x16x32_bf16 a[140:143], a[180:183], a[28:31], a[140:143]
    v_add_u32 v13, s56, v4
    s_add_u32 s56, s3, 3
    v_mfma_f32_16x16x32_bf16 a[144:147], a[184:187], a[28:31], a[144:147]
    buffer_load_dwordx4 v[140:143], v4, s[4:7], s59 offen offset:3072 sc1
    v_mfma_f32_16x16x32_bf16 a[148:151], a[188:191], a[28:31], a[148:151]
    s_and_b32 s56, s56, 3
    s_mul_i32 s56, s56, 15360
    v_mfma_f32_16x16x32_bf16 a[152:155], a[192:195], a[28:31], a[152:155]
    s_add_u32 s56, s56, 92160
    v_add_u32 v14, s56, v4
    v_mfma_f32_16x16x32_bf16 a[156:159], a[196:199], a[28:31], a[156:159]
    s_mul_i32 s56, s3, 15360
    s_add_u32 s56, s56, 81920
    s_waitcnt vmcnt(29)
    v_mfma_f32_16x16x32_bf16 v[192:195], a[200:203], a[32:35], v[192:195]
    v_add_u32 v15, s56, v4
    v_mfma_f32_16x16x32_bf16 v[196:199], a[204:207], a[32:35], v[196:199]
    buffer_load_dwordx4 a[160:163], v8, s[4:7], s16 offen offset:0 sc1
    v_mfma_f32_16x16x32_bf16 v[200:203], a[208:211], a[32:35], v[200:203]
    v_mfma_f32_16x16x32_bf16 v[204:207], a[212:215], a[32:35], v[204:207]
    v_mfma_f32_16x16x32_bf16 v[208:211], a[216:219], a[32:35], v[208:211]
    s_waitcnt vmcnt(29)
    v_mfma_f32_16x16x32_bf16 a[100:103], a[200:203], a[36:39], a[100:103]
    v_mfma_f32_16x16x32_bf16 a[104:107], a[204:207], a[36:39], a[104:107]
    buffer_load_dwordx4 a[164:167], v8, s[4:7], s16 offen offset:256 sc1
    v_mfma_f32_16x16x32_bf16 a[108:111], a[208:211], a[36:39], a[108:111]
    v_mfma_f32_16x16x32_bf16 a[112:115], a[212:215], a[36:39], a[112:115]
    v_mfma_f32_16x16x32_bf16 a[116:119], a[216:219], a[36:39], a[116:119]
    s_waitcnt vmcnt(29)
    v_mfma_f32_16x16x32_bf16 a[120:123], a[200:203], a[40:43], a[120:123]
    v_mfma_f32_16x16x32_bf16 a[124:127], a[204:207], a[40:43], a[124:127]
    buffer_load_dwordx4 a[168:171], v8, s[4:7], s16 offen offset:2048 sc1
    v_mfma_f32_16x16x32_bf16 a[128:131], a[208:211], a[40:43], a[128:131]
    v_mfma_f32_16x16x32_bf16 a[132:135], a[212:215], a[40:43], a[132:135]
    v_mfma_f32_16x16x32_bf16 a[136:139], a[216:219], a[40:43], a[136:139]
    s_waitcnt vmcnt(28)
    v_mfma_f32_16x16x32_bf16 a[140:143], a[200:203], a[44:47], a[140:143]
    v_mfma_f32_16x16x32_bf16 a[144:147], a[204:207], a[44:47], a[144:147]
    buffer_load_dwordx4 a[172:175], v8, s[4:7], s16 offen offset:2304 sc1
    v_mfma_f32_16x16x32_bf16 a[148:151], a[208:211], a[44:47], a[148:151]
    v_mfma_f32_16x16x32_bf16 a[152:155], a[212:215], a[44:47], a[152:155]
    v_mfma_f32_16x16x32_bf16 a[156:159], a[216:219], a[44:47], a[156:159]
    s_waitcnt vmcnt(12)
    s_cmp_lg_u32 s3, 0
    s_cbranch_scc1 gpd_38
    s_waitcnt vmcnt(8)
    s_mov_b32 s57, 0
gp_37:
    v_cmp_gt_u32 vcc, 16, v219
    s_cbranch_vccz gpd_38
    s_sleep 2
    buffer_load_dword v219, v217, s[4:7], s40 offen offset:128 sc1
    s_add_u32 s57, s57, 1
    s_cmp_ge_u32 s57, 100000
    s_waitcnt vmcnt(0)
    s_cbranch_scc0 gp_37
gpd_38:
    s_barrier
    s_cmp_lg_u32 s3, 0
    s_cbranch_scc1 ws_39
    s_mov_b64 exec, 1
    buffer_atomic_add v216, v217, s[4:7], s37 offen offset:256 sc1
    s_mov_b64 exec, -1
ws_39:
    v_mfma_f32_16x16x32_bf16 v[192:195], a[220:223], a[48:51], v[192:195]
    v_mfma_f32_16x16x32_bf16 v[196:199], a[224:227], a[48:51], v[196:199]
    s_mov_b32 s24, s12
    buffer_load_dwordx4 a[0:3], v4, s[4:7], s24 offen offset:0 sc1
    v_mfma_f32_16x16x32_bf16 v[200:203], a[228:231], a[48:51], v[200:203]
    v_mfma_f32_16x16x32_bf16 v[204:207], a[232:235], a[48:51], v[204:207]
    v_mfma_f32_16x16x32_bf16 v[208:211], a[236:239], a[48:51], v[208:211]
    v_mfma_f32_16x16x32_bf16 a[100:103], a[220:223], a[52:55], a[100:103]
    v_mfma_f32_16x16x32_bf16 a[104:107], a[224:227], a[52:55], a[104:107]
    s_mov_b32 s25, s13
    buffer_load_dwordx4 a[4:7], v4, s[4:7], s25 offen offset:0 sc1
    v_mfma_f32_16x16x32_bf16 a[108:111], a[228:231], a[52:55], a[108:111]
    v_mfma_f32_16x16x32_bf16 a[112:115], a[232:235], a[52:55], a[112:115]
    v_mfma_f32_16x16x32_bf16 a[116:119], a[236:239], a[52:55], a[116:119]
    v_mfma_f32_16x16x32_bf16 a[120:123], a[220:223], a[56:59], a[120:123]
    v_mfma_f32_16x16x32_bf16 a[124:127], a[224:227], a[56:59], a[124:127]
    s_mov_b32 s26, s14
    buffer_load_dwordx4 a[8:11], v4, s[4:7], s26 offen offset:0 sc1
    v_mfma_f32_16x16x32_bf16 a[128:131], a[228:231], a[56:59], a[128:131]
    v_mfma_f32_16x16x32_bf16 a[132:135], a[232:235], a[56:59], a[132:135]
    v_mfma_f32_16x16x32_bf16 a[136:139], a[236:239], a[56:59], a[136:139]
    v_mfma_f32_16x16x32_bf16 a[140:143], a[220:223], a[60:63], a[140:143]
    v_mfma_f32_16x16x32_bf16 a[144:147], a[224:227], a[60:63], a[144:147]
    s_mov_b32 s27, s15
    buffer_load_dwordx4 a[12:15], v4, s[4:7], s27 offen offset:0 sc1
    v_mfma_f32_16x16x32_bf16 a[148:151], a[228:231], a[60:63], a[148:151]
    v_mfma_f32_16x16x32_bf16 a[152:155], a[232:235], a[60:63], a[152:155]
    v_mfma_f32_16x16x32_bf16 a[156:159], a[236:239], a[60:63], a[156:159]
    v_mfma_f32_16x16x32_bf16 v[192:195], a[240:243], a[64:67], v[192:195]
    v_mfma_f32_16x16x32_bf16 v[196:199], a[244:247], a[64:67], v[196:199]
    buffer_load_dwordx4 a[16:19], v4, s[4:7], s24 offen offset:1024 sc1
    v_mfma_f32_16x16x32_bf16 v[200:203], a[248:251], a[64:67], v[200:203]
    v_mfma_f32_16x16x32_bf16 v[204:207], a[252:255], a[64:67], v[204:207]
    v_mfma_f32_16x16x32_bf16 v[208:211], v[224:227], a[64:67], v[208:211]
    v_mfma_f32_16x16x32_bf16 a[100:103], a[240:243], a[68:71], a[100:103]
    v_mfma_f32_16x16x32_bf16 a[104:107], a[244:247], a[68:71], a[104:107]
    buffer_load_dwordx4 a[20:23], v4, s[4:7], s25 offen offset:1024 sc1
    v_mfma_f32_16x16x32_bf16 a[108:111], a[248:251], a[68:71], a[108:111]
    v_mfma_f32_16x16x32_bf16 a[112:115], a[252:255], a[68:71], a[112:115]
    v_mfma_f32_16x16x32_bf16 a[116:119], v[224:227], a[68:71], a[116:119]
    v_mfma_f32_16x16x32_bf16 a[120:123], a[240:243], a[72:75], a[120:123]
    v_mfma_f32_16x16x32_bf16 a[124:127], a[244:247], a[72:75], a[124:127]
    buffer_load_dwordx4 a[24:27], v4, s[4:7], s26 offen offset:1024 sc1
    v_mfma_f32_16x16x32_bf16 a[128:131], a[248:251], a[72:75], a[128:131]
    v_mfma_f32_16x16x32_bf16 a[132:135], a[252:255], a[72:75], a[132:135]
    v_mfma_f32_16x16x32_bf16 a[136:139], v[224:227], a[72:75], a[136:139]
    v_mfma_f32_16x16x32_bf16 a[140:143], a[240:243], a[76:79], a[140:143]
    v_mfma_f32_16x16x32_bf16 a[144:147], a[244:247], a[76:79], a[144:147]
    buffer_load_dwordx4 a[28:31], v4, s[4:7], s27 offen offset:1024 sc1
    v_mfma_f32_16x16x32_bf16 a[148:151], a[248:251], a[76:79], a[148:151]
    v_mfma_f32_16x16x32_bf16 a[152:155], a[252:255], a[76:79], a[152:155]
    v_mfma_f32_16x16x32_bf16 a[156:159], v[224:227], a[76:79], a[156:159]
    v_mfma_f32_16x16x32_bf16 v[192:195], v[228:231], a[80:83], v[192:195]
    v_mfma_f32_16x16x32_bf16 v[196:199], v[232:235], a[80:83], v[196:199]
    buffer_load_dwordx4 a[32:35], v4, s[4:7], s24 offen offset:2048 sc1
    v_mfma_f32_16x16x32_bf16 v[200:203], v[236:239], a[80:83], v[200:203]
    v_mfma_f32_16x16x32_bf16 v[204:207], v[240:243], a[80:83], v[204:207]
    v_mfma_f32_16x16x32_bf16 v[208:211], v[244:247], a[80:83], v[208:211]
    v_mfma_f32_16x16x32_bf16 a[100:103], v[228:231], a[84:87], a[100:103]
    v_mfma_f32_16x16x32_bf16 a[104:107], v[232:235], a[84:87], a[104:107]
    buffer_load_dwordx4 a[36:39], v4, s[4:7], s25 offen offset:2048 sc1
    v_mfma_f32_16x16x32_bf16 a[108:111], v[236:239], a[84:87], a[108:111]
    v_mfma_f32_16x16x32_bf16 a[112:115], v[240:243], a[84:87], a[112:115]
    v_mfma_f32_16x16x32_bf16 a[116:119], v[244:247], a[84:87], a[116:119]
    v_mfma_f32_16x16x32_bf16 a[120:123], v[228:231], a[88:91], a[120:123]
    v_mfma_f32_16x16x32_bf16 a[124:127], v[232:235], a[88:91], a[124:127]
    buffer_load_dwordx4 a[40:43], v4, s[4:7], s26 offen offset:2048 sc1
    v_mfma_f32_16x16x32_bf16 a[128:131], v[236:239], a[88:91], a[128:131]
    v_mfma_f32_16x16x32_bf16 a[132:135], v[240:243], a[88:91], a[132:135]
    v_mfma_f32_16x16x32_bf16 a[136:139], v[244:247], a[88:91], a[136:139]
    v_mfma_f32_16x16x32_bf16 a[140:143], v[228:231], a[92:95], a[140:143]
    v_mfma_f32_16x16x32_bf16 a[144:147], v[232:235], a[92:95], a[144:147]
    buffer_load_dwordx4 a[44:47], v4, s[4:7], s27 offen offset:2048 sc1
    v_mfma_f32_16x16x32_bf16 a[148:151], v[236:239], a[92:95], a[148:151]
    v_mfma_f32_16x16x32_bf16 a[152:155], v[240:243], a[92:95], a[152:155]
    v_mfma_f32_16x16x32_bf16 a[156:159], v[244:247], a[92:95], a[156:159]
    s_waitcnt vmcnt(11)
    v_mfma_f32_16x16x32_bf16 v[192:195], v[248:251], a[0:3], v[192:195]
    s_cmp_lg_u32 s3, 0
    s_cbranch_scc1 wp_40
    buffer_load_dword v223, v217, s[4:7], s40 offen offset:256 sc1
wp_40:
    v_mfma_f32_16x16x32_bf16 v[196:199], v[252:255], a[0:3], v[196:199]
    buffer_load_dwordx4 a[48:51], v4, s[4:7], s24 offen offset:3072 sc1
    v_mfma_f32_16x16x32_bf16 v[200:203], v[160:163], a[0:3], v[200:203]
    v_mfma_f32_16x16x32_bf16 v[204:207], v[164:167], a[0:3], v[204:207]
    v_mfma_f32_16x16x32_bf16 v[208:211], v[168:171], a[0:3], v[208:211]
    s_waitcnt vmcnt(11)
    v_mfma_f32_16x16x32_bf16 a[100:103], v[248:251], a[4:7], a[100:103]
    v_mfma_f32_16x16x32_bf16 a[104:107], v[252:255], a[4:7], a[104:107]
    buffer_load_dwordx4 a[52:55], v4, s[4:7], s25 offen offset:3072 sc1
    v_mfma_f32_16x16x32_bf16 a[108:111], v[160:163], a[4:7], a[108:111]
    v_mfma_f32_16x16x32_bf16 a[112:115], v[164:167], a[4:7], a[112:115]
    v_mfma_f32_16x16x32_bf16 a[116:119], v[168:171], a[4:7], a[116:119]
    s_waitcnt vmcnt(11)
    v_mfma_f32_16x16x32_bf16 a[120:123], v[248:251], a[8:11], a[120:123]
    v_mfma_f32_16x16x32_bf16 a[124:127], v[252:255], a[8:11], a[124:127]
    buffer_load_dwordx4 a[56:59], v4, s[4:7], s26 offen offset:3072 sc1
    v_mfma_f32_16x16x32_bf16 a[128:131], v[160:163], a[8:11], a[128:131]
    v_mfma_f32_16x16x32_bf16 a[132:135], v[164:167], a[8:11], a[132:135]
    v_mfma_f32_16x16x32_bf16 a[136:139], v[168:171], a[8:11], a[136:139]
    s_waitcnt vmcnt(11)
    v_mfma_f32_16x16x32_bf16 a[140:143], v[248:251], a[12:15], a[140:143]
    v_mfma_f32_16x16x32_bf16 a[144:147], v[252:255], a[12:15], a[144:147]
    buffer_load_dwordx4 a[60:63], v4, s[4:7], s27 offen offset:3072 sc1
    v_mfma_f32_16x16x32_bf16 a[148:151], v[160:163], a[12:15], a[148:151]
    v_mfma_f32_16x16x32_bf16 a[152:155], v[164:167], a[12:15], a[152:155]
    v_mfma_f32_16x16x32_bf16 a[156:159], v[168:171], a[12:15], a[156:159]
    s_waitcnt vmcnt(11)
    v_mfma_f32_16x16x32_bf16 v[192:195], v[172:175], a[16:19], v[192:195]
    v_mfma_f32_16x16x32_bf16 v[196:199], v[176:179], a[16:19], v[196:199]
    buffer_load_dwordx4 a[176:179], v9, s[4:7], s17 offen sc1
    v_mfma_f32_16x16x32_bf16 v[200:203], v[180:183], a[16:19], v[200:203]
    v_mfma_f32_16x16x32_bf16 v[204:207], v[16:19], a[16:19], v[204:207]
    v_mfma_f32_16x16x32_bf16 v[208:211], v[20:23], a[16:19], v[208:211]
    s_waitcnt vmcnt(11)
    v_mfma_f32_16x16x32_bf16 a[100:103], v[172:175], a[20:23], a[100:103]
    v_mfma_f32_16x16x32_bf16 a[104:107], v[176:179], a[20:23], a[104:107]
    buffer_load_dword v220, v220, s[4:7], s41 offen sc1
    v_mfma_f32_16x16x32_bf16 a[108:111], v[180:183], a[20:23], a[108:111]
    v_mfma_f32_16x16x32_bf16 a[112:115], v[16:19], a[20:23], a[112:115]
    v_mfma_f32_16x16x32_bf16 a[116:119], v[20:23], a[20:23], a[116:119]
    s_waitcnt vmcnt(11)
    v_mfma_f32_16x16x32_bf16 a[120:123], v[172:175], a[24:27], a[120:123]
    v_mfma_f32_16x16x32_bf16 a[124:127], v[176:179], a[24:27], a[124:127]
    v_mfma_f32_16x16x32_bf16 a[128:131], v[180:183], a[24:27], a[128:131]
    v_mfma_f32_16x16x32_bf16 a[132:135], v[16:19], a[24:27], a[132:135]
    v_mfma_f32_16x16x32_bf16 a[136:139], v[20:23], a[24:27], a[136:139]
    s_waitcnt vmcnt(10)
    v_mfma_f32_16x16x32_bf16 a[140:143], v[172:175], a[28:31], a[140:143]
    v_mfma_f32_16x16x32_bf16 a[144:147], v[176:179], a[28:31], a[144:147]
    v_mfma_f32_16x16x32_bf16 a[148:151], v[180:183], a[28:31], a[148:151]
    v_mfma_f32_16x16x32_bf16 a[152:155], v[16:19], a[28:31], a[152:155]
    v_mfma_f32_16x16x32_bf16 a[156:159], v[20:23], a[28:31], a[156:159]
    s_cmp_lg_u32 s3, 0
    s_cbranch_scc1 gpd_42
    s_waitcnt vmcnt(6)
    s_mov_b32 s57, 0
gp_41:
    v_cmp_gt_u32 vcc, 16, v223
    s_cbranch_vccz gpd_42
    s_sleep 2
    buffer_load_dword v223, v217, s[4:7], s40 offen offset:256 sc1
    s_add_u32 s57, s57, 1
    s_cmp_ge_u32 s57, 100000
    s_waitcnt vmcnt(0)
    s_cbranch_scc0 gp_41
gpd_42:
    s_barrier
    s_waitcnt vmcnt(9)
    v_mfma_f32_16x16x32_bf16 v[192:195], v[24:27], a[32:35], v[192:195]
    v_mfma_f32_16x16x32_bf16 v[196:199], v[28:31], a[32:35], v[196:199]
    s_add_u32 s24, s24, 16384
    buffer_load_dwordx4 a[64:67], v4, s[4:7], s24 offen offset:0 sc1
    v_mfma_f32_16x16x32_bf16 v[200:203], v[32:35], a[32:35], v[200:203]
    v_mfma_f32_16x16x32_bf16 v[204:207], v[36:39], a[32:35], v[204:207]
    s_add_u32 s25, s25, 16384
    buffer_load_dwordx4 a[68:71], v4, s[4:7], s25 offen offset:0 sc1
    v_mfma_f32_16x16x32_bf16 v[208:211], v[40:43], a[32:35], v[208:211]
    s_waitcnt vmcnt(10)
    v_mfma_f32_16x16x32_bf16 a[100:103], v[24:27], a[36:39], a[100:103]
    v_mfma_f32_16x16x32_bf16 a[104:107], v[28:31], a[36:39], a[104:107]
    s_add_u32 s26, s26, 16384
    buffer_load_dwordx4 a[72:75], v4, s[4:7], s26 offen offset:0 sc1
    v_mfma_f32_16x16x32_bf16 a[108:111], v[32:35], a[36:39], a[108:111]
    v_mfma_f32_16x16x32_bf16 a[112:115], v[36:39], a[36:39], a[112:115]
    s_add_u32 s27, s27, 16384
    buffer_load_dwordx4 a[76:79], v4, s[4:7], s27 offen offset:0 sc1
    v_mfma_f32_16x16x32_bf16 a[116:119], v[40:43], a[36:39], a[116:119]
    s_waitcnt vmcnt(11)
    v_mfma_f32_16x16x32_bf16 a[120:123], v[24:27], a[40:43], a[120:123]
    v_mfma_f32_16x16x32_bf16 a[124:127], v[28:31], a[40:43], a[124:127]
    buffer_load_dwordx4 a[84:87], v4, s[4:7], s25 offen offset:1024 sc1
    v_mfma_f32_16x16x32_bf16 a[128:131], v[32:35], a[40:43], a[128:131]
    v_mfma_f32_16x16x32_bf16 a[132:135], v[36:39], a[40:43], a[132:135]
    v_mfma_f32_16x16x32_bf16 a[136:139], v[40:43], a[40:43], a[136:139]
    s_waitcnt vmcnt(11)
    v_mfma_f32_16x16x32_bf16 a[140:143], v[24:27], a[44:47], a[140:143]
    v_mfma_f32_16x16x32_bf16 a[144:147], v[28:31], a[44:47], a[144:147]
    buffer_load_dwordx4 a[88:91], v4, s[4:7], s26 offen offset:1024 sc1
    v_mfma_f32_16x16x32_bf16 a[148:151], v[32:35], a[44:47], a[148:151]
    v_mfma_f32_16x16x32_bf16 a[152:155], v[36:39], a[44:47], a[152:155]
    v_mfma_f32_16x16x32_bf16 a[156:159], v[40:43], a[44:47], a[156:159]
    s_waitcnt vmcnt(11)
    v_mfma_f32_16x16x32_bf16 v[192:195], v[44:47], a[48:51], v[192:195]
    v_mfma_f32_16x16x32_bf16 v[196:199], v[48:51], a[48:51], v[196:199]
    buffer_load_dwordx4 a[92:95], v4, s[4:7], s27 offen offset:1024 sc1
    v_mfma_f32_16x16x32_bf16 v[200:203], v[52:55], a[48:51], v[200:203]
    v_mfma_f32_16x16x32_bf16 v[204:207], v[56:59], a[48:51], v[204:207]
    v_mfma_f32_16x16x32_bf16 v[208:211], v[60:63], a[48:51], v[208:211]
    s_waitcnt vmcnt(11)
    v_mfma_f32_16x16x32_bf16 a[100:103], v[44:47], a[52:55], a[100:103]
    v_mfma_f32_16x16x32_bf16 a[104:107], v[48:51], a[52:55], a[104:107]
    buffer_load_dwordx4 a[4:7], v4, s[4:7], s25 offen offset:2048 sc1
    v_mfma_f32_16x16x32_bf16 a[108:111], v[52:55], a[52:55], a[108:111]
    v_mfma_f32_16x16x32_bf16 a[112:115], v[56:59], a[52:55], a[112:115]
    v_mfma_f32_16x16x32_bf16 a[116:119], v[60:63], a[52:55], a[116:119]
    s_waitcnt vmcnt(11)
    v_mfma_f32_16x16x32_bf16 a[120:123], v[44:47], a[56:59], a[120:123]
    v_mfma_f32_16x16x32_bf16 a[124:127], v[48:51], a[56:59], a[124:127]
    buffer_load_dwordx4 a[20:23], v4, s[4:7], s25 offen offset:3072 sc1
    v_mfma_f32_16x16x32_bf16 a[128:131], v[52:55], a[56:59], a[128:131]
    v_mfma_f32_16x16x32_bf16 a[132:135], v[56:59], a[56:59], a[132:135]
    v_mfma_f32_16x16x32_bf16 a[136:139], v[60:63], a[56:59], a[136:139]
    s_waitcnt vmcnt(11)
    v_mfma_f32_16x16x32_bf16 a[140:143], v[44:47], a[60:63], a[140:143]
    v_mfma_f32_16x16x32_bf16 a[144:147], v[48:51], a[60:63], a[144:147]
    buffer_load_dwordx4 a[8:11], v4, s[4:7], s26 offen offset:2048 sc1
    v_mfma_f32_16x16x32_bf16 a[148:151], v[52:55], a[60:63], a[148:151]
    v_mfma_f32_16x16x32_bf16 a[152:155], v[56:59], a[60:63], a[152:155]
    v_mfma_f32_16x16x32_bf16 a[156:159], v[60:63], a[60:63], a[156:159]
    s_waitcnt vmcnt(9)
    v_mfma_f32_16x16x32_bf16 v[192:195], v[64:67], a[64:67], v[192:195]
    v_mfma_f32_16x16x32_bf16 v[196:199], v[68:71], a[64:67], v[196:199]
    buffer_load_dwordx4 a[24:27], v4, s[4:7], s26 offen offset:3072 sc1
    v_mfma_f32_16x16x32_bf16 v[200:203], v[72:75], a[64:67], v[200:203]
    v_mfma_f32_16x16x32_bf16 v[204:207], v[76:79], a[64:67], v[204:207]
    v_mfma_f32_16x16x32_bf16 v[208:211], v[80:83], a[64:67], v[208:211]
    s_waitcnt vmcnt(9)
    v_mfma_f32_16x16x32_bf16 a[100:103], v[64:67], a[68:71], a[100:103]
    v_mfma_f32_16x16x32_bf16 a[104:107], v[68:71], a[68:71], a[104:107]
    buffer_load_dwordx4 a[12:15], v4, s[4:7], s27 offen offset:2048 sc1
    v_mfma_f32_16x16x32_bf16 a[108:111], v[72:75], a[68:71], a[108:111]
    v_mfma_f32_16x16x32_bf16 a[112:115], v[76:79], a[68:71], a[112:115]
    v_mfma_f32_16x16x32_bf16 a[116:119], v[80:83], a[68:71], a[116:119]
    s_waitcnt vmcnt(9)
    v_mfma_f32_16x16x32_bf16 a[120:123], v[64:67], a[72:75], a[120:123]
    v_mfma_f32_16x16x32_bf16 a[124:127], v[68:71], a[72:75], a[124:127]
    buffer_load_dwordx4 a[28:31], v4, s[4:7], s27 offen offset:3072 sc1
    v_mfma_f32_16x16x32_bf16 a[128:131], v[72:75], a[72:75], a[128:131]
    v_mfma_f32_16x16x32_bf16 a[132:135], v[76:79], a[72:75], a[132:135]
    v_mfma_f32_16x16x32_bf16 a[136:139], v[80:83], a[72:75], a[136:139]
    s_waitcnt vmcnt(9)
    v_mfma_f32_16x16x32_bf16 a[140:143], v[64:67], a[76:79], a[140:143]
    v_mfma_f32_16x16x32_bf16 a[144:147], v[68:71], a[76:79], a[144:147]
    buffer_load_dwordx4 a[80:83], v4, s[4:7], s24 offen offset:1024 sc1
    v_mfma_f32_16x16x32_bf16 a[148:151], v[72:75], a[76:79], a[148:151]
    v_mfma_f32_16x16x32_bf16 a[152:155], v[76:79], a[76:79], a[152:155]
    v_mfma_f32_16x16x32_bf16 a[156:159], v[80:83], a[76:79], a[156:159]
    s_waitcnt vmcnt(9)
    v_mfma_f32_16x16x32_bf16 a[100:103], v[84:87], a[84:87], a[100:103]
    v_mfma_f32_16x16x32_bf16 a[104:107], v[88:91], a[84:87], a[104:107]
    buffer_load_dwordx4 a[0:3], v4, s[4:7], s24 offen offset:2048 sc1
    v_mfma_f32_16x16x32_bf16 a[108:111], v[92:95], a[84:87], a[108:111]
    v_mfma_f32_16x16x32_bf16 a[112:115], v[96:99], a[84:87], a[112:115]
    v_mfma_f32_16x16x32_bf16 a[116:119], v[100:103], a[84:87], a[116:119]
    s_waitcnt vmcnt(9)
    v_mfma_f32_16x16x32_bf16 a[120:123], v[84:87], a[88:91], a[120:123]
    v_mfma_f32_16x16x32_bf16 a[124:127], v[88:91], a[88:91], a[124:127]
    buffer_load_dwordx4 a[16:19], v4, s[4:7], s24 offen offset:3072 sc1
    v_mfma_f32_16x16x32_bf16 a[128:131], v[92:95], a[88:91], a[128:131]
    v_mfma_f32_16x16x32_bf16 a[132:135], v[96:99], a[88:91], a[132:135]
    v_mfma_f32_16x16x32_bf16 a[136:139], v[100:103], a[88:91], a[136:139]
    s_waitcnt vmcnt(9)
    v_mfma_f32_16x16x32_bf16 a[140:143], v[84:87], a[92:95], a[140:143]
    v_mfma_f32_16x16x32_bf16 a[144:147], v[88:91], a[92:95], a[144:147]
    v_mfma_f32_16x16x32_bf16 a[148:151], v[92:95], a[92:95], a[148:151]
    v_mfma_f32_16x16x32_bf16 a[152:155], v[96:99], a[92:95], a[152:155]
    v_mfma_f32_16x16x32_bf16 a[156:159], v[100:103], a[92:95], a[156:159]
    s_waitcnt vmcnt(8)
    v_mfma_f32_16x16x32_bf16 a[100:103], v[104:107], a[4:7], a[100:103]
    v_mfma_f32_16x16x32_bf16 a[104:107], v[108:111], a[4:7], a[104:107]
    v_mfma_f32_16x16x32_bf16 a[108:111], v[112:115], a[4:7], a[108:111]
    v_mfma_f32_16x16x32_bf16 a[112:115], v[116:119], a[4:7], a[112:115]
    v_mfma_f32_16x16x32_bf16 a[116:119], v[120:123], a[4:7], a[116:119]
    s_waitcnt vmcnt(7)
    v_mfma_f32_16x16x32_bf16 a[100:103], v[124:127], a[20:23], a[100:103]
    v_mfma_f32_16x16x32_bf16 a[104:107], v[128:131], a[20:23], a[104:107]
    v_mfma_f32_16x16x32_bf16 a[108:111], v[132:135], a[20:23], a[108:111]
    v_mfma_f32_16x16x32_bf16 a[112:115], v[136:139], a[20:23], a[112:115]
    v_mfma_f32_16x16x32_bf16 a[116:119], v[140:143], a[20:23], a[116:119]
    s_waitcnt vmcnt(6)
    v_mfma_f32_16x16x32_bf16 a[120:123], v[104:107], a[8:11], a[120:123]
    v_mfma_f32_16x16x32_bf16 a[124:127], v[108:111], a[8:11], a[124:127]
    s_nop 0
    ds_write_b128 v12, a[100:103] offset:0
    v_mfma_f32_16x16x32_bf16 a[128:131], v[112:115], a[8:11], a[128:131]
    ds_write_b128 v12, a[104:107] offset:1024
    v_mfma_f32_16x16x32_bf16 a[132:135], v[116:119], a[8:11], a[132:135]
    ds_write_b128 v12, a[108:111] offset:2048
    v_mfma_f32_16x16x32_bf16 a[136:139], v[120:123], a[8:11], a[136:139]
    ds_write_b128 v12, a[112:115] offset:3072
    s_waitcnt vmcnt(5)
    v_mfma_f32_16x16x32_bf16 a[120:123], v[124:127], a[24:27], a[120:123]
    v_mfma_f32_16x16x32_bf16 a[124:127], v[128:131], a[24:27], a[124:127]
    ds_write_b128 v12, a[116:119] offset:4096
    v_mfma_f32_16x16x32_bf16 a[128:131], v[132:135], a[24:27], a[128:131]
    v_mfma_f32_16x16x32_bf16 a[132:135], v[136:139], a[24:27], a[132:135]
    v_mfma_f32_16x16x32_bf16 a[136:139], v[140:143], a[24:27], a[136:139]
    s_waitcnt vmcnt(4)
    v_mfma_f32_16x16x32_bf16 a[140:143], v[104:107], a[12:15], a[140:143]
    v_mfma_f32_16x16x32_bf16 a[144:147], v[108:111], a[12:15], a[144:147]
    ds_write_b128 v13, a[120:123] offset:0
    v_mfma_f32_16x16x32_bf16 a[148:151], v[112:115], a[12:15], a[148:151]
    ds_write_b128 v13, a[124:127] offset:1024
    v_mfma_f32_16x16x32_bf16 a[152:155], v[116:119], a[12:15], a[152:155]
    ds_write_b128 v13, a[128:131] offset:2048
    v_mfma_f32_16x16x32_bf16 a[156:159], v[120:123], a[12:15], a[156:159]
    ds_write_b128 v13, a[132:135] offset:3072
    s_waitcnt vmcnt(3)
    v_mfma_f32_16x16x32_bf16 a[140:143], v[124:127], a[28:31], a[140:143]
    v_mfma_f32_16x16x32_bf16 a[144:147], v[128:131], a[28:31], a[144:147]
    ds_write_b128 v13, a[136:139] offset:4096
    v_mfma_f32_16x16x32_bf16 a[148:151], v[132:135], a[28:31], a[148:151]
    v_mfma_f32_16x16x32_bf16 a[152:155], v[136:139], a[28:31], a[152:155]
    v_mfma_f32_16x16x32_bf16 a[156:159], v[140:143], a[28:31], a[156:159]
    s_waitcnt vmcnt(2)
    v_mfma_f32_16x16x32_bf16 v[192:195], v[84:87], a[80:83], v[192:195]
    v_mfma_f32_16x16x32_bf16 v[40:43], a[160:163], v[184:187], 0
    v_mfma_f32_16x16x32_bf16 v[44:47], a[164:167], v[184:187], 0
    v_mfma_f32_16x16x32_bf16 v[196:199], v[88:91], a[80:83], v[196:199]
    ds_write_b128 v14, a[140:143] offset:0
    v_mfma_f32_16x16x32_bf16 v[200:203], v[92:95], a[80:83], v[200:203]
    ds_write_b128 v14, a[144:147] offset:1024
    v_mfma_f32_16x16x32_bf16 v[204:207], v[96:99], a[80:83], v[204:207]
    ds_write_b128 v14, a[148:151] offset:2048
    v_mfma_f32_16x16x32_bf16 v[208:211], v[100:103], a[80:83], v[208:211]
    ds_write_b128 v14, a[152:155] offset:3072
    ds_write_b128 v14, a[156:159] offset:4096
    v_mfma_f32_16x16x32_bf16 v[48:51], a[168:171], v[184:187], 0
    v_mfma_f32_16x16x32_bf16 v[52:55], a[172:175], v[184:187], 0
    v_mfma_f32_16x16x32_bf16 v[56:59], a[176:179], v[184:187], 0
    ds_read_b128 v[16:19], v10 offset:0
    ds_read_b128 v[20:23], v10 offset:16
    ds_read_b128 v[24:27], v10 offset:128
    ds_read_b128 v[28:31], v10 offset:144
    ds_read_b128 v[32:35], v11
    s_waitcnt lgkmcnt(0)
    s_barrier
    s_waitcnt vmcnt(1)
    v_mfma_f32_16x16x32_bf16 v[192:195], v[104:107], a[0:3], v[192:195]
    ds_read_b128 v[64:67], v15 offset:0
    ds_read_b128 v[68:71], v15 offset:5120
    v_mfma_f32_16x16x32_bf16 v[196:199], v[108:111], a[0:3], v[196:199]
    ds_read_b128 v[72:75], v15 offset:10240
    ds_read_b128 v[76:79], v15 offset:1024
    v_mfma_f32_16x16x32_bf16 v[200:203], v[112:115], a[0:3], v[200:203]
    ds_read_b128 v[80:83], v15 offset:6144
    ds_read_b128 v[84:87], v15 offset:11264
    v_mfma_f32_16x16x32_bf16 v[204:207], v[116:119], a[0:3], v[204:207]
    ds_read_b128 v[88:91], v15 offset:2048
    ds_read_b128 v[92:95], v15 offset:7168
    v_mfma_f32_16x16x32_bf16 v[208:211], v[120:123], a[0:3], v[208:211]
    ds_read_b128 v[96:99], v15 offset:12288
    ds_read_b128 v[144:147], v15 offset:3072
    s_waitcnt vmcnt(0)
    v_mfma_f32_16x16x32_bf16 v[192:195], v[124:127], a[16:19], v[192:195]
    ds_read_b128 v[148:151], v15 offset:8192
    ds_read_b128 v[152:155], v15 offset:13312
    v_mfma_f32_16x16x32_bf16 v[196:199], v[128:131], a[16:19], v[196:199]
    ds_read_b128 v[156:159], v15 offset:4096
    ds_read_b128 v[160:163], v15 offset:9216
    v_mfma_f32_16x16x32_bf16 v[200:203], v[132:135], a[16:19], v[200:203]
    ds_read_b128 v[164:167], v15 offset:14336
    v_mfma_f32_16x16x32_bf16 v[204:207], v[136:139], a[16:19], v[204:207]
    v_mfma_f32_16x16x32_bf16 v[208:211], v[140:143], a[16:19], v[208:211]
    v_pk_mul_f32 v[16:17], v[16:17], v[220:221] op_sel_hi:[1,0]
    v_pk_mul_f32 v[18:19], v[18:19], v[220:221] op_sel_hi:[1,0]
    v_pk_mul_f32 v[20:21], v[20:21], v[220:221] op_sel_hi:[1,0]
    v_pk_mul_f32 v[22:23], v[22:23], v[220:221] op_sel_hi:[1,0]
    v_pk_mul_f32 v[24:25], v[24:25], v[220:221] op_sel_hi:[1,0]
    v_pk_mul_f32 v[26:27], v[26:27], v[220:221] op_sel_hi:[1,0]
    v_pk_mul_f32 v[28:29], v[28:29], v[220:221] op_sel_hi:[1,0]
    v_pk_mul_f32 v[30:31], v[30:31], v[220:221] op_sel_hi:[1,0]
    v_pk_mul_f32 v[32:33], v[32:33], v[220:221] op_sel_hi:[1,0]
    v_pk_mul_f32 v[34:35], v[34:35], v[220:221] op_sel_hi:[1,0]
    s_waitcnt lgkmcnt(12)
    v_pk_add_f32 v[192:193], v[192:193], v[64:65]
    v_pk_add_f32 v[68:69], v[68:69], v[72:73]
    v_pk_add_f32 v[192:193], v[192:193], v[68:69]
    v_pk_fma_f32 v[192:193], v[192:193], v[16:17], v[40:41]
    v_cvt_pk_bf16_f32 v224, v192, v193
    v_pk_add_f32 v[194:195], v[194:195], v[66:67]
    v_pk_add_f32 v[70:71], v[70:71], v[74:75]
    v_pk_add_f32 v[194:195], v[194:195], v[70:71]
    v_pk_fma_f32 v[194:195], v[194:195], v[18:19], v[42:43]
    v_cvt_pk_bf16_f32 v225, v194, v195
    s_waitcnt lgkmcnt(9)
    v_pk_add_f32 v[196:197], v[196:197], v[76:77]
    v_pk_add_f32 v[80:81], v[80:81], v[84:85]
    v_pk_add_f32 v[196:197], v[196:197], v[80:81]
    v_pk_fma_f32 v[196:197], v[196:197], v[20:21], v[44:45]
    v_cvt_pk_bf16_f32 v226, v196, v197
    v_pk_add_f32 v[198:199], v[198:199], v[78:79]
    v_pk_add_f32 v[82:83], v[82:83], v[86:87]
    v_pk_add_f32 v[198:199], v[198:199], v[82:83]
    v_pk_fma_f32 v[198:199], v[198:199], v[22:23], v[46:47]
    v_cvt_pk_bf16_f32 v227, v198, v199
    buffer_store_dwordx4 v[224:227], v221, s[8:11], 0 offen offset:0
    s_waitcnt lgkmcnt(6)
    v_pk_add_f32 v[200:201], v[200:201], v[88:89]
    v_pk_add_f32 v[92:93], v[92:93], v[96:97]
    v_pk_add_f32 v[200:201], v[200:201], v[92:93]
    v_pk_fma_f32 v[200:201], v[200:201], v[24:25], v[48:49]
    v_cvt_pk_bf16_f32 v228, v200, v201
    v_pk_add_f32 v[202:203], v[202:203], v[90:91]
    v_pk_add_f32 v[94:95], v[94:95], v[98:99]
    v_pk_add_f32 v[202:203], v[202:203], v[94:95]
    v_pk_fma_f32 v[202:203], v[202:203], v[26:27], v[50:51]
    v_cvt_pk_bf16_f32 v229, v202, v203
    s_waitcnt lgkmcnt(3)
    v_pk_add_f32 v[204:205], v[204:205], v[144:145]
    v_pk_add_f32 v[148:149], v[148:149], v[152:153]
    v_pk_add_f32 v[204:205], v[204:205], v[148:149]
    v_pk_fma_f32 v[204:205], v[204:205], v[28:29], v[52:53]
    v_cvt_pk_bf16_f32 v230, v204, v205
    v_pk_add_f32 v[206:207], v[206:207], v[146:147]
    v_pk_add_f32 v[150:151], v[150:151], v[154:155]
    v_pk_add_f32 v[206:207], v[206:207], v[150:151]
    v_pk_fma_f32 v[206:207], v[206:207], v[30:31], v[54:55]
    v_cvt_pk_bf16_f32 v231, v206, v207
    buffer_store_dwordx4 v[228:231], v221, s[8:11], 0 offen offset:64
    s_waitcnt lgkmcnt(0)
    v_pk_add_f32 v[208:209], v[208:209], v[156:157]
    v_pk_add_f32 v[160:161], v[160:161], v[164:165]
    v_pk_add_f32 v[208:209], v[208:209], v[160:161]
    v_pk_fma_f32 v[208:209], v[208:209], v[32:33], v[56:57]
    v_cvt_pk_bf16_f32 v232, v208, v209
    v_pk_add_f32 v[210:211], v[210:211], v[158:159]
    v_pk_add_f32 v[162:163], v[162:163], v[166:167]
    v_pk_add_f32 v[210:211], v[210:211], v[162:163]
    v_pk_fma_f32 v[210:211], v[210:211], v[34:35], v[58:59]
    v_cvt_pk_bf16_f32 v233, v210, v211
    buffer_store_dwordx2 v[232:233], v222, s[8:11], 0 offen offset:128
    s_endpgm
.p2align 8
.fill (66560 - (. - adaLN_cond__ssm_conv_s4d__geglu_ffn__prompt_kernel)) / 4, 4, 0xbf800000
.section .rodata,"a"
.p2align 6
.amdhsa_kernel adaLN_cond__ssm_conv_s4d__geglu_ffn__prompt_kernel
  .amdhsa_next_free_vgpr 512
  .amdhsa_next_free_sgpr 102
  .amdhsa_accum_offset 256
  .amdhsa_group_segment_fixed_size 0
  .amdhsa_kernarg_size 128
  .amdhsa_user_sgpr_count 2
  .amdhsa_user_sgpr_kernarg_segment_ptr 1
  .amdhsa_system_sgpr_workgroup_id_x 1
  .amdhsa_float_denorm_mode_32 3
  .amdhsa_float_denorm_mode_16_64 3
.end_amdhsa_kernel
```
